```python
import torch

def _softmax(x, axis=-1):
    return torch.softmax(x, dim=axis)
def _gelu(x):
    return torch.nn.functional.gelu(x, approximate="tanh")
def _silu(x):
    return torch.nn.functional.silu(x)
def _sigmoid(x):
    return torch.sigmoid(x)
def _layernorm(x, axis=-1, eps=1e-5):
    m = x.mean(dim=axis, keepdim=True)
    v = x.var(dim=axis, keepdim=True, unbiased=False)
    return (x - m) / torch.sqrt(v + eps)
def _scatter_add(tgt, idx, src, axis=0):
    return tgt.clone().index_add_(axis, idx, src)
def _segment_sum(src, seg, n):
    out = torch.zeros((n,) + src.shape[1:], dtype=src.dtype)
    return out.index_add_(0, seg, src)
def _pad(x, pw):
    flat = tuple(v for pair in reversed(pw) for v in pair)
    return torch.nn.functional.pad(x, flat)

kernel_name = 'recurrent_scan__gqa_block_cached__mixer_token_mlp__decode'

def setup_inputs():

    _w = (lambda a: (lambda t: t.to(torch.bfloat16) if t.is_floating_point() else t)(torch.as_tensor(a)))
    def _A_setup():
        B, Sq, D = 8, 1, 640
        Hq, Hkv, Sk, Dh = 32, 32, 4096, 128
        assert Hq % Hkv == 0, (Hq, Hkv)
        return {
            "x": _w((lambda *s: torch.randn(*s, dtype=torch.bfloat16) * 0.4)(B, Sq, D)),
            "k_cache": _w((lambda *s: torch.randn(*s, dtype=torch.bfloat16) * 1.6)(B, Hkv, Sk, Dh)),
            "v_cache": _w((lambda *s: torch.randn(*s, dtype=torch.bfloat16) * 1.6)(B, Hkv, Sk, Dh)),
            "wq": _w((lambda *s: torch.randn(*s, dtype=torch.bfloat16) * 1.6)(D, Hq * Dh) * (D ** -0.5)),
            "wo": _w((lambda *s: torch.randn(*s, dtype=torch.bfloat16) * 1.6)(Hq * Dh, D) * ((Hq * Dh) ** -0.5)),
        }
    _A_in = _A_setup()

    def _B_setup():
        B, S, D, F = 8, 1, 640, 1728
        return {
            "x": _w((lambda *s: torch.randn(*s, dtype=torch.bfloat16) * 0.4)(B, S, D)),
            "w1": _w((lambda *s: torch.randn(*s, dtype=torch.bfloat16) * 1.6)(S, F) * (S ** -0.5)),
            "b1": _w((lambda *s: torch.randn(*s, dtype=torch.bfloat16) * 1.6)(F) * 0.02),
            "w2": _w((lambda *s: torch.randn(*s, dtype=torch.bfloat16) * 1.6)(F, S) * (F ** -0.5)),
            "b2": _w((lambda *s: torch.randn(*s, dtype=torch.bfloat16) * 1.6)(S) * 0.02),
        }
    _B_in = _B_setup()

    return {
        "A_x": _A_in["x"],
        "A_k_cache": _A_in["k_cache"],
        "A_v_cache": _A_in["v_cache"],
        "A_wq": _A_in["wq"],
        "A_wo": _A_in["wo"],
        "B_x": _B_in["x"],
        "B_w1": _B_in["w1"],
        "B_b1": _B_in["b1"],
        "B_w2": _B_in["w2"],
        "B_b2": _B_in["b2"],
    }

def reference(A_x, A_k_cache, A_v_cache, A_wq, A_wo, B_x, B_w1, B_b1, B_w2, B_b2):
    def _A_ref(x, k_cache, v_cache, wq, wo):
        B, Sq, D = x.shape
        Hq, Dh = 32, 128
        Hkv = k_cache.shape[1]
        rep = Hq // Hkv
        q = (lambda x, *d: x.permute(*d))((x @ wq).reshape(B, Sq, Hq, Dh), 0, 2, 1, 3)
        k = (lambda x, n, axis: torch.repeat_interleave(x, n, dim=axis))(k_cache, rep, axis=1)
        v = (lambda x, n, axis: torch.repeat_interleave(x, n, dim=axis))(v_cache, rep, axis=1)
        scores = torch.einsum("bhqd,bhkd->bhqk", q, k) * (Dh ** -0.5)
        p = _softmax(scores, axis=-1)
        o = torch.einsum("bhqk,bhkd->bhqd", p, v)
        return (lambda x, *d: x.permute(*d))(o, 0, 2, 1, 3).reshape(B, Sq, Hq * Dh) @ wo

    def _B_ref(x, w1, b1, w2, b2):
        B, S, D = x.shape
        h = _layernorm(x, axis=-1)
        u = torch.einsum("bsd,sf->bdf", h, w1) + b1
        u = _gelu(u)
        y = torch.einsum("bdf,fs->bds", u, w2) + b2
        return (lambda x, *d: x.permute(*d))(y, 0, 2, 1)

    x = A_x
    xn = _layernorm(x, axis=-1)
    s = _A_ref(xn, A_k_cache, A_v_cache, A_wq, A_wo)
    g = _silu(_B_ref(xn, B_w1, B_b1, B_w2, B_b2))
    return x + s * g
```

```asm
; @launch grid=(256,1,1) block=(512,1,1) lds=161280
.amdgcn_target "amdgcn-amd-amdhsa--gfx950"
.text
.globl recurrent_scan__gqa_block_cached__mixer_token_mlp__decode_kernel
.p2align 8
.type recurrent_scan__gqa_block_cached__mixer_token_mlp__decode_kernel,@function
recurrent_scan__gqa_block_cached__mixer_token_mlp__decode_kernel:
    s_load_dwordx16 s[64:79], s[0:1], 0
    s_load_dwordx8 s[80:87], s[0:1], 64
    s_load_dwordx2 s[88:89], s[0:1], 96
    s_cmp_ge_u32 s2, 256
    s_cbranch_scc1 L_end
    v_lshrrev_b32 v2, 6, v0
    v_and_b32 v1, 63, v0
    v_readfirstlane_b32 s3, v2
    s_and_b32 s54, s2, 7
    s_lshr_b32 s55, s2, 3
    s_and_b32 s53, s54, 7
    s_lshl_b32 s53, s53, 2
    s_and_b32 s52, s55, 3
    s_or_b32 s53, s53, s52
    s_lshr_b32 s52, s55, 2
    s_mul_i32 s94, s52, 81920
    s_mov_b32 s50, 81920
    s_mov_b32 s51, 0x00020000
    s_mov_b32 s46, 256
    s_mov_b32 s47, 0x00020000
    s_cmp_ge_u32 s3, 4
    s_cbranch_scc1 L_helper
    s_setprio 1
    s_lshl_b32 s61, s52, 5
    s_add_u32 s61, s61, s53
    s_lshl_b32 s61, s61, 20
    s_mov_b32 s10, 1048576
    s_mov_b32 s11, 0x00020000
    s_mov_b32 s14, 1048576
    s_mov_b32 s15, 0x00020000
    s_lshl_b32 s63, s52, 17
    s_mul_i32 s55, s3, 4096
    v_lshlrev_b32 v2, 4, v1
    v_add_u32 v2, s55, v2
    s_waitcnt lgkmcnt(0)
    s_add_u32 s8, s66, s61
    s_addc_u32 s9, s67, 0
    s_xor_b32 s60, s63, 0
    buffer_load_dwordx4 v[64:67], v2, s[8:11], s60 offen offset:0 nt
    buffer_load_dwordx4 v[68:71], v2, s[8:11], s60 offen offset:1024 nt
    buffer_load_dwordx4 v[72:75], v2, s[8:11], s60 offen offset:2048 nt
    buffer_load_dwordx4 v[76:79], v2, s[8:11], s60 offen offset:3072 nt
    s_xor_b32 s60, s63, 16384
    buffer_load_dwordx4 v[80:83], v2, s[8:11], s60 offen offset:0 nt
    buffer_load_dwordx4 v[84:87], v2, s[8:11], s60 offen offset:1024 nt
    s_branch L_smain
L_helper:
    s_sub_u32 s97, s3, 4
    s_mul_i32 s60, s52, 1280
    s_lshl_b32 s62, s53, 8
    s_mov_b32 s6, 1280
    s_mov_b32 s7, 0x00020000
    s_sub_u32 s18, 5242880, s62
    s_mov_b32 s19, 0x00020000
    v_lshrrev_b32 v53, 4, v1
    v_and_b32 v54, 15, v1
    v_lshlrev_b32 v50, 2, v1
    s_mul_i32 s54, s97, 160
    s_mul_i32 s55, s52, 20
    s_add_u32 s63, s54, s55
    v_lshlrev_b32 v51, 2, v54
    v_add_u32 v51, s63, v51
    v_add_u32 v45, 0, v51
    v_subrev_u32 v39, 640, v45
    v_min_u32 v45, v45, v39
    v_add_lshl_u32 v45, v45, v53, 1
    v_add_u32 v46, 64, v51
    v_subrev_u32 v39, 640, v46
    v_min_u32 v46, v46, v39
    v_add_lshl_u32 v46, v46, v53, 1
    v_add_u32 v47, 128, v51
    v_subrev_u32 v39, 640, v47
    v_min_u32 v47, v47, v39
    v_add_lshl_u32 v47, v47, v53, 1
    v_lshlrev_b32 v2, 13, v53
    v_lshl_add_u32 v2, v54, 4, v2
    v_lshlrev_b32 v48, 1, v1
    s_mul_i32 s54, s53, 40
    s_lshl_b32 s63, s63, 13
    s_waitcnt lgkmcnt(0)
    s_add_u32 s4, s64, s60
    s_addc_u32 s5, s65, 0
    s_add_u32 s16, s70, s62
    s_addc_u32 s17, s71, 0
    s_add_u32 s48, s88, s94
    s_addc_u32 s49, s89, 0
    s_mul_i32 s95, s53, 2560
    s_and_b32 s96, s53, 7
    s_cmp_lg_u32 s96, 0
    s_cbranch_scc1 L_noclear
    v_mov_b32 v72, -1
    v_mov_b32 v73, -1
    v_mov_b32 v74, -1
    v_mov_b32 v75, -1
    v_lshlrev_b32 v76, 4, v1
    s_mul_i32 s96, s97, 5120
    s_add_u32 s96, s96, s95
    buffer_store_dwordx4 v[72:75], v76, s[48:51], s96 offen offset:0 sc1
    buffer_store_dwordx4 v[72:75], v76, s[48:51], s96 offen offset:1024 sc1
    buffer_store_dwordx4 v[72:75], v76, s[48:51], s96 offen offset:2048 sc1
    buffer_store_dwordx4 v[72:75], v76, s[48:51], s96 offen offset:3072 sc1
    s_add_u32 s96, s96, 4096
    buffer_store_dwordx4 v[72:75], v76, s[48:51], s96 offen offset:0 sc1
    s_nop 1
L_noclear:
    v_lshlrev_b32 v3, 4, v1
    buffer_load_dwordx4 v[24:27], v3, s[4:7], 0 offen
    buffer_load_dword v28, v50, s[4:7], 0 offen offset:1024
    s_mul_i32 s55, s97, 2560
    v_add_u32 v3, s55, v3
    v_add_u32 v68, s55, v50
    v_add_u32 v45, s55, v45
    v_add_u32 v46, s55, v46
    v_add_u32 v47, s55, v47
    s_add_u32 s54, s54, s55
    v_add_u32 v48, s54, v48
    buffer_load_dwordx4 v[96:99], v2, s[16:19], s63 offen
    s_add_u32 s63, s63, 32768
    s_cmp_ge_u32 s63, 5242880
    s_cselect_b32 s63, 0, s63
    buffer_load_dwordx4 v[100:103], v2, s[16:19], s63 offen
    s_add_u32 s63, s63, 32768
    s_cmp_ge_u32 s63, 5242880
    s_cselect_b32 s63, 0, s63
    buffer_load_dwordx4 v[104:107], v2, s[16:19], s63 offen
    s_add_u32 s63, s63, 32768
    s_cmp_ge_u32 s63, 5242880
    s_cselect_b32 s63, 0, s63
    buffer_load_dwordx4 v[108:111], v2, s[16:19], s63 offen
    s_add_u32 s63, s63, 32768
    s_cmp_ge_u32 s63, 5242880
    s_cselect_b32 s63, 0, s63
    s_add_u32 s40, s84, s60
    s_addc_u32 s41, s85, 0
    s_mov_b32 s42, 1280
    s_mov_b32 s43, 0x00020000
    s_mul_i32 s61, s53, 163840
    s_add_u32 s20, s72, s61
    s_addc_u32 s21, s73, 0
    s_mov_b32 s22, 163840
    s_mov_b32 s23, 0x00020000
    s_mov_b64 s[24:25], s[76:77]
    s_mov_b32 s26, 3456
    s_mov_b32 s27, 0x00020000
    s_mov_b64 s[28:29], s[78:79]
    s_mov_b32 s30, 3456
    s_mov_b32 s31, 0x00020000
    s_mov_b64 s[32:33], s[80:81]
    s_mov_b32 s34, 3456
    s_mov_b32 s35, 0x00020000
    s_mov_b64 s[36:37], s[82:83]
    s_mov_b32 s38, 2
    s_mov_b32 s39, 0x00020000
    s_mov_b64 s[44:45], s[86:87]
    s_mov_b32 s90, 0xbdd2d3e8
    s_mov_b32 s91, 0x3fb8aa3b
    s_mov_b32 s93, 0x3acccccd
    s_mov_b32 s56, 0xcccccccc
    s_mov_b32 s57, 0xcccccccc
    s_mov_b32 s58, 0xaaaaaaaa
    s_mov_b32 s59, 0xaaaaaaaa
    v_mov_b32 v50, 0xffff
    v_mov_b32 v51, 0xffff0000
    v_cndmask_b32 v50, v50, v51, s[58:59]
    v_lshrrev_b32 v51, 1, v54
    v_cmp_eq_u32 vcc, 0, v51
    s_nop 1
    v_cndmask_b32 v4, 0, v50, vcc
    v_cmp_eq_u32 vcc, 1, v51
    s_nop 1
    v_cndmask_b32 v5, 0, v50, vcc
    v_cmp_eq_u32 vcc, 2, v51
    s_nop 1
    v_cndmask_b32 v6, 0, v50, vcc
    v_cmp_eq_u32 vcc, 3, v51
    s_nop 1
    v_cndmask_b32 v7, 0, v50, vcc
    v_lshlrev_b32 v52, 5, v54
    v_lshl_add_u32 v52, v53, 4, v52
    s_waitcnt vmcnt(4)
    v_lshlrev_b32 v29, 16, v24
    v_and_b32 v30, 0xffff0000, v24
    v_lshlrev_b32 v31, 16, v25
    v_and_b32 v32, 0xffff0000, v25
    v_lshlrev_b32 v33, 16, v26
    v_and_b32 v34, 0xffff0000, v26
    v_lshlrev_b32 v35, 16, v27
    v_and_b32 v36, 0xffff0000, v27
    v_lshlrev_b32 v37, 16, v28
    v_and_b32 v38, 0xffff0000, v28
    v_add_f32 v39, v29, v30
    v_add_f32 v40, v31, v32
    v_add_f32 v39, v39, v33
    v_add_f32 v40, v40, v34
    v_add_f32 v39, v39, v35
    v_add_f32 v40, v40, v36
    v_add_f32 v39, v39, v37
    v_add_f32 v40, v40, v38
    v_add_f32 v39, v39, v40
    s_nop 1
    v_add_f32_dpp v39, v39, v39 row_ror:8 row_mask:0xf bank_mask:0xf
    s_nop 1
    v_add_f32_dpp v39, v39, v39 row_ror:4 row_mask:0xf bank_mask:0xf
    s_nop 1
    v_add_f32_dpp v39, v39, v39 row_ror:2 row_mask:0xf bank_mask:0xf
    s_nop 1
    v_add_f32_dpp v39, v39, v39 row_ror:1 row_mask:0xf bank_mask:0xf
    s_nop 1
    v_add_f32_dpp v39, v39, v39 row_bcast:15 row_mask:0xa bank_mask:0xf
    s_nop 1
    v_add_f32_dpp v39, v39, v39 row_bcast:31 row_mask:0xc bank_mask:0xf
    s_nop 0
    v_readlane_b32 s54, v39, 63
    v_mov_b32 v42, s93
    s_nop 0
    v_mul_f32 v42, s54, v42
    v_sub_f32 v41, v29, v42
    v_mul_f32 v39, v41, v41
    v_sub_f32 v41, v30, v42
    v_mul_f32 v40, v41, v41
    v_sub_f32 v41, v31, v42
    v_fmac_f32 v39, v41, v41
    v_sub_f32 v41, v32, v42
    v_fmac_f32 v40, v41, v41
    v_sub_f32 v41, v33, v42
    v_fmac_f32 v39, v41, v41
    v_sub_f32 v41, v34, v42
    v_fmac_f32 v40, v41, v41
    v_sub_f32 v41, v35, v42
    v_fmac_f32 v39, v41, v41
    v_sub_f32 v41, v36, v42
    v_fmac_f32 v40, v41, v41
    v_sub_f32 v41, v37, v42
    v_fmac_f32 v39, v41, v41
    v_sub_f32 v41, v38, v42
    v_fmac_f32 v40, v41, v41
    v_add_f32 v39, v39, v40
    s_nop 1
    v_add_f32_dpp v39, v39, v39 row_ror:8 row_mask:0xf bank_mask:0xf
    s_nop 1
    v_add_f32_dpp v39, v39, v39 row_ror:4 row_mask:0xf bank_mask:0xf
    s_nop 1
    v_add_f32_dpp v39, v39, v39 row_ror:2 row_mask:0xf bank_mask:0xf
    s_nop 1
    v_add_f32_dpp v39, v39, v39 row_ror:1 row_mask:0xf bank_mask:0xf
    s_nop 1
    v_add_f32_dpp v39, v39, v39 row_bcast:15 row_mask:0xa bank_mask:0xf
    s_nop 1
    v_add_f32_dpp v39, v39, v39 row_bcast:31 row_mask:0xc bank_mask:0xf
    s_nop 0
    v_readlane_b32 s54, v39, 63
    v_mov_b32 v43, s93
    s_nop 0
    v_mul_f32 v43, s54, v43
    v_cvt_pk_bf16_f32 v39, v42, v43
    v_lshlrev_b32 v42, 16, v39
    v_and_b32 v43, 0xffff0000, v39
    v_add_f32 v43, 0x3727c5ac, v43
    v_cvt_pk_bf16_f32 v43, v43, v43
    v_and_b32 v43, 0xffff0000, v43
    v_sqrt_f32 v43, v43
    s_nop 0
    v_cvt_pk_bf16_f32 v43, v43, v43
    v_and_b32 v43, 0xffff0000, v43
    v_rcp_f32 v44, v43
    v_sub_f32 v29, v29, v42
    v_sub_f32 v30, v30, v42
    v_cvt_pk_bf16_f32 v41, v29, v30
    v_lshlrev_b32 v29, 16, v41
    v_and_b32 v30, 0xffff0000, v41
    v_mul_f32 v39, v29, v44
    v_mul_f32 v40, v30, v44
    v_fma_f32 v29, -v39, v43, v29
    v_fma_f32 v30, -v40, v43, v30
    v_fmac_f32 v39, v29, v44
    v_fmac_f32 v40, v30, v44
    v_cvt_pk_bf16_f32 v24, v39, v40
    v_lshlrev_b32 v29, 16, v24
    v_and_b32 v30, 0xffff0000, v24
    v_sub_f32 v31, v31, v42
    v_sub_f32 v32, v32, v42
    v_cvt_pk_bf16_f32 v41, v31, v32
    v_lshlrev_b32 v31, 16, v41
    v_and_b32 v32, 0xffff0000, v41
    v_mul_f32 v39, v31, v44
    v_mul_f32 v40, v32, v44
    v_fma_f32 v31, -v39, v43, v31
    v_fma_f32 v32, -v40, v43, v32
    v_fmac_f32 v39, v31, v44
    v_fmac_f32 v40, v32, v44
    v_cvt_pk_bf16_f32 v25, v39, v40
    v_lshlrev_b32 v31, 16, v25
    v_and_b32 v32, 0xffff0000, v25
    v_sub_f32 v33, v33, v42
    v_sub_f32 v34, v34, v42
    v_cvt_pk_bf16_f32 v41, v33, v34
    v_lshlrev_b32 v33, 16, v41
    v_and_b32 v34, 0xffff0000, v41
    v_mul_f32 v39, v33, v44
    v_mul_f32 v40, v34, v44
    v_fma_f32 v33, -v39, v43, v33
    v_fma_f32 v34, -v40, v43, v34
    v_fmac_f32 v39, v33, v44
    v_fmac_f32 v40, v34, v44
    v_cvt_pk_bf16_f32 v26, v39, v40
    v_lshlrev_b32 v33, 16, v26
    v_and_b32 v34, 0xffff0000, v26
    v_sub_f32 v35, v35, v42
    v_sub_f32 v36, v36, v42
    v_cvt_pk_bf16_f32 v41, v35, v36
    v_lshlrev_b32 v35, 16, v41
    v_and_b32 v36, 0xffff0000, v41
    v_mul_f32 v39, v35, v44
    v_mul_f32 v40, v36, v44
    v_fma_f32 v35, -v39, v43, v35
    v_fma_f32 v36, -v40, v43, v36
    v_fmac_f32 v39, v35, v44
    v_fmac_f32 v40, v36, v44
    v_cvt_pk_bf16_f32 v27, v39, v40
    v_lshlrev_b32 v35, 16, v27
    v_and_b32 v36, 0xffff0000, v27
    v_sub_f32 v37, v37, v42
    v_sub_f32 v38, v38, v42
    v_cvt_pk_bf16_f32 v41, v37, v38
    v_lshlrev_b32 v37, 16, v41
    v_and_b32 v38, 0xffff0000, v41
    v_mul_f32 v39, v37, v44
    v_mul_f32 v40, v38, v44
    v_fma_f32 v37, -v39, v43, v37
    v_fma_f32 v38, -v40, v43, v38
    v_fmac_f32 v39, v37, v44
    v_fmac_f32 v40, v38, v44
    v_cvt_pk_bf16_f32 v28, v39, v40
    v_lshlrev_b32 v37, 16, v28
    v_and_b32 v38, 0xffff0000, v28
    ds_write_b128 v3, v[24:27] offset:3584
    ds_write_b32 v68, v28 offset:4608
    s_waitcnt lgkmcnt(0)
    ds_read_u16 v45, v45 offset:3584
    ds_read_u16 v46, v46 offset:3584
    ds_read_u16 v47, v47 offset:3584
    ds_read_u16 v48, v48 offset:3584
    s_waitcnt lgkmcnt(0)
    v_lshl_or_b32 v45, v45, 16, v45
    v_lshl_or_b32 v46, v46, 16, v46
    v_lshl_or_b32 v47, v47, 16, v47
    v_lshlrev_b32 v48, 16, v48
    v_and_b32_dpp v16, v45, v4 row_newbcast:0 row_mask:0xf bank_mask:0xf
    v_and_b32_dpp v17, v45, v5 row_newbcast:0 row_mask:0xf bank_mask:0xf
    v_and_b32_dpp v18, v45, v6 row_newbcast:0 row_mask:0xf bank_mask:0xf
    v_and_b32_dpp v19, v45, v7 row_newbcast:0 row_mask:0xf bank_mask:0xf
    v_and_b32_dpp v20, v45, v4 row_newbcast:1 row_mask:0xf bank_mask:0xf
    v_and_b32_dpp v21, v45, v5 row_newbcast:1 row_mask:0xf bank_mask:0xf
    v_and_b32_dpp v22, v45, v6 row_newbcast:1 row_mask:0xf bank_mask:0xf
    v_and_b32_dpp v23, v45, v7 row_newbcast:1 row_mask:0xf bank_mask:0xf
    s_waitcnt vmcnt(3)
    v_mfma_f32_16x16x32_bf16 v[12:15], v[16:19], v[96:99], 0
    buffer_load_dwordx4 v[112:115], v2, s[16:19], s63 offen
    s_add_u32 s63, s63, 32768
    s_cmp_ge_u32 s63, 5242880
    s_cselect_b32 s63, 0, s63
    v_and_b32_dpp v16, v45, v4 row_newbcast:2 row_mask:0xf bank_mask:0xf
    v_and_b32_dpp v17, v45, v5 row_newbcast:2 row_mask:0xf bank_mask:0xf
    v_and_b32_dpp v18, v45, v6 row_newbcast:2 row_mask:0xf bank_mask:0xf
    v_and_b32_dpp v19, v45, v7 row_newbcast:2 row_mask:0xf bank_mask:0xf
    s_waitcnt vmcnt(3)
    v_mfma_f32_16x16x32_bf16 v[12:15], v[20:23], v[100:103], v[12:15]
    buffer_load_dwordx4 v[116:119], v2, s[16:19], s63 offen
    s_add_u32 s63, s63, 32768
    s_cmp_ge_u32 s63, 5242880
    s_cselect_b32 s63, 0, s63
    v_and_b32_dpp v20, v45, v4 row_newbcast:3 row_mask:0xf bank_mask:0xf
    v_and_b32_dpp v21, v45, v5 row_newbcast:3 row_mask:0xf bank_mask:0xf
    v_and_b32_dpp v22, v45, v6 row_newbcast:3 row_mask:0xf bank_mask:0xf
    v_and_b32_dpp v23, v45, v7 row_newbcast:3 row_mask:0xf bank_mask:0xf
    s_waitcnt vmcnt(3)
    v_mfma_f32_16x16x32_bf16 v[12:15], v[16:19], v[104:107], v[12:15]
    buffer_load_dwordx4 v[120:123], v2, s[16:19], s63 offen
    s_add_u32 s63, s63, 32768
    s_cmp_ge_u32 s63, 5242880
    s_cselect_b32 s63, 0, s63
    v_and_b32_dpp v16, v45, v4 row_newbcast:4 row_mask:0xf bank_mask:0xf
    v_and_b32_dpp v17, v45, v5 row_newbcast:4 row_mask:0xf bank_mask:0xf
    v_and_b32_dpp v18, v45, v6 row_newbcast:4 row_mask:0xf bank_mask:0xf
    v_and_b32_dpp v19, v45, v7 row_newbcast:4 row_mask:0xf bank_mask:0xf
    s_waitcnt vmcnt(3)
    v_mfma_f32_16x16x32_bf16 v[12:15], v[20:23], v[108:111], v[12:15]
    buffer_load_dwordx4 v[124:127], v2, s[16:19], s63 offen
    s_add_u32 s63, s63, 32768
    s_cmp_ge_u32 s63, 5242880
    s_cselect_b32 s63, 0, s63
    v_and_b32_dpp v20, v45, v4 row_newbcast:5 row_mask:0xf bank_mask:0xf
    v_and_b32_dpp v21, v45, v5 row_newbcast:5 row_mask:0xf bank_mask:0xf
    v_and_b32_dpp v22, v45, v6 row_newbcast:5 row_mask:0xf bank_mask:0xf
    v_and_b32_dpp v23, v45, v7 row_newbcast:5 row_mask:0xf bank_mask:0xf
    s_waitcnt vmcnt(3)
    v_mfma_f32_16x16x32_bf16 v[12:15], v[16:19], v[112:115], v[12:15]
    buffer_load_dwordx4 v[128:131], v2, s[16:19], s63 offen
    s_add_u32 s63, s63, 32768
    s_cmp_ge_u32 s63, 5242880
    s_cselect_b32 s63, 0, s63
    v_and_b32_dpp v16, v45, v4 row_newbcast:6 row_mask:0xf bank_mask:0xf
    v_and_b32_dpp v17, v45, v5 row_newbcast:6 row_mask:0xf bank_mask:0xf
    v_and_b32_dpp v18, v45, v6 row_newbcast:6 row_mask:0xf bank_mask:0xf
    v_and_b32_dpp v19, v45, v7 row_newbcast:6 row_mask:0xf bank_mask:0xf
    s_waitcnt vmcnt(3)
    v_mfma_f32_16x16x32_bf16 v[12:15], v[20:23], v[116:119], v[12:15]
    buffer_load_dwordx4 v[132:135], v2, s[16:19], s63 offen
    s_add_u32 s63, s63, 32768
    s_cmp_ge_u32 s63, 5242880
    s_cselect_b32 s63, 0, s63
    v_and_b32_dpp v20, v45, v4 row_newbcast:7 row_mask:0xf bank_mask:0xf
    v_and_b32_dpp v21, v45, v5 row_newbcast:7 row_mask:0xf bank_mask:0xf
    v_and_b32_dpp v22, v45, v6 row_newbcast:7 row_mask:0xf bank_mask:0xf
    v_and_b32_dpp v23, v45, v7 row_newbcast:7 row_mask:0xf bank_mask:0xf
    s_waitcnt vmcnt(3)
    v_mfma_f32_16x16x32_bf16 v[12:15], v[16:19], v[120:123], v[12:15]
    buffer_load_dwordx4 v[136:139], v2, s[16:19], s63 offen
    s_add_u32 s63, s63, 32768
    s_cmp_ge_u32 s63, 5242880
    s_cselect_b32 s63, 0, s63
    v_and_b32_dpp v16, v45, v4 row_newbcast:8 row_mask:0xf bank_mask:0xf
    v_and_b32_dpp v17, v45, v5 row_newbcast:8 row_mask:0xf bank_mask:0xf
    v_and_b32_dpp v18, v45, v6 row_newbcast:8 row_mask:0xf bank_mask:0xf
    v_and_b32_dpp v19, v45, v7 row_newbcast:8 row_mask:0xf bank_mask:0xf
    s_waitcnt vmcnt(3)
    v_mfma_f32_16x16x32_bf16 v[12:15], v[20:23], v[124:127], v[12:15]
    buffer_load_dwordx4 v[140:143], v2, s[16:19], s63 offen
    s_add_u32 s63, s63, 32768
    s_cmp_ge_u32 s63, 5242880
    s_cselect_b32 s63, 0, s63
    v_and_b32_dpp v20, v45, v4 row_newbcast:9 row_mask:0xf bank_mask:0xf
    v_and_b32_dpp v21, v45, v5 row_newbcast:9 row_mask:0xf bank_mask:0xf
    v_and_b32_dpp v22, v45, v6 row_newbcast:9 row_mask:0xf bank_mask:0xf
    v_and_b32_dpp v23, v45, v7 row_newbcast:9 row_mask:0xf bank_mask:0xf
    s_waitcnt vmcnt(3)
    v_mfma_f32_16x16x32_bf16 v[12:15], v[16:19], v[128:131], v[12:15]
    buffer_load_dwordx4 v[144:147], v2, s[16:19], s63 offen
    s_add_u32 s63, s63, 32768
    s_cmp_ge_u32 s63, 5242880
    s_cselect_b32 s63, 0, s63
    v_and_b32_dpp v16, v45, v4 row_newbcast:10 row_mask:0xf bank_mask:0xf
    v_and_b32_dpp v17, v45, v5 row_newbcast:10 row_mask:0xf bank_mask:0xf
    v_and_b32_dpp v18, v45, v6 row_newbcast:10 row_mask:0xf bank_mask:0xf
    v_and_b32_dpp v19, v45, v7 row_newbcast:10 row_mask:0xf bank_mask:0xf
    s_waitcnt vmcnt(3)
    v_mfma_f32_16x16x32_bf16 v[12:15], v[20:23], v[132:135], v[12:15]
    buffer_load_dwordx4 v[148:151], v2, s[16:19], s63 offen
    s_add_u32 s63, s63, 32768
    s_cmp_ge_u32 s63, 5242880
    s_cselect_b32 s63, 0, s63
    v_and_b32_dpp v20, v45, v4 row_newbcast:11 row_mask:0xf bank_mask:0xf
    v_and_b32_dpp v21, v45, v5 row_newbcast:11 row_mask:0xf bank_mask:0xf
    v_and_b32_dpp v22, v45, v6 row_newbcast:11 row_mask:0xf bank_mask:0xf
    v_and_b32_dpp v23, v45, v7 row_newbcast:11 row_mask:0xf bank_mask:0xf
    s_waitcnt vmcnt(3)
    v_mfma_f32_16x16x32_bf16 v[12:15], v[16:19], v[136:139], v[12:15]
    buffer_load_dwordx4 v[152:155], v2, s[16:19], s63 offen
    s_add_u32 s63, s63, 32768
    s_cmp_ge_u32 s63, 5242880
    s_cselect_b32 s63, 0, s63
    v_and_b32_dpp v16, v45, v4 row_newbcast:12 row_mask:0xf bank_mask:0xf
    v_and_b32_dpp v17, v45, v5 row_newbcast:12 row_mask:0xf bank_mask:0xf
    v_and_b32_dpp v18, v45, v6 row_newbcast:12 row_mask:0xf bank_mask:0xf
    v_and_b32_dpp v19, v45, v7 row_newbcast:12 row_mask:0xf bank_mask:0xf
    s_waitcnt vmcnt(3)
    v_mfma_f32_16x16x32_bf16 v[12:15], v[20:23], v[140:143], v[12:15]
    buffer_load_dwordx4 v[156:159], v2, s[16:19], s63 offen
    s_add_u32 s63, s63, 32768
    s_cmp_ge_u32 s63, 5242880
    s_cselect_b32 s63, 0, s63
    v_and_b32_dpp v20, v45, v4 row_newbcast:13 row_mask:0xf bank_mask:0xf
    v_and_b32_dpp v21, v45, v5 row_newbcast:13 row_mask:0xf bank_mask:0xf
    v_and_b32_dpp v22, v45, v6 row_newbcast:13 row_mask:0xf bank_mask:0xf
    v_and_b32_dpp v23, v45, v7 row_newbcast:13 row_mask:0xf bank_mask:0xf
    s_waitcnt vmcnt(3)
    v_mfma_f32_16x16x32_bf16 v[12:15], v[16:19], v[144:147], v[12:15]
    buffer_load_dwordx4 v[160:163], v2, s[16:19], s63 offen
    s_add_u32 s63, s63, 32768
    s_cmp_ge_u32 s63, 5242880
    s_cselect_b32 s63, 0, s63
    v_and_b32_dpp v16, v45, v4 row_newbcast:14 row_mask:0xf bank_mask:0xf
    v_and_b32_dpp v17, v45, v5 row_newbcast:14 row_mask:0xf bank_mask:0xf
    v_and_b32_dpp v18, v45, v6 row_newbcast:14 row_mask:0xf bank_mask:0xf
    v_and_b32_dpp v19, v45, v7 row_newbcast:14 row_mask:0xf bank_mask:0xf
    s_waitcnt vmcnt(3)
    v_mfma_f32_16x16x32_bf16 v[12:15], v[20:23], v[148:151], v[12:15]
    buffer_load_dwordx4 v[164:167], v2, s[16:19], s63 offen
    s_add_u32 s63, s63, 32768
    s_cmp_ge_u32 s63, 5242880
    s_cselect_b32 s63, 0, s63
    v_and_b32_dpp v20, v45, v4 row_newbcast:15 row_mask:0xf bank_mask:0xf
    v_and_b32_dpp v21, v45, v5 row_newbcast:15 row_mask:0xf bank_mask:0xf
    v_and_b32_dpp v22, v45, v6 row_newbcast:15 row_mask:0xf bank_mask:0xf
    v_and_b32_dpp v23, v45, v7 row_newbcast:15 row_mask:0xf bank_mask:0xf
    s_waitcnt vmcnt(3)
    v_mfma_f32_16x16x32_bf16 v[12:15], v[16:19], v[152:155], v[12:15]
    buffer_load_dwordx4 v[168:171], v2, s[16:19], s63 offen
    s_add_u32 s63, s63, 32768
    s_cmp_ge_u32 s63, 5242880
    s_cselect_b32 s63, 0, s63
    v_and_b32_dpp v16, v46, v4 row_newbcast:0 row_mask:0xf bank_mask:0xf
    v_and_b32_dpp v17, v46, v5 row_newbcast:0 row_mask:0xf bank_mask:0xf
    v_and_b32_dpp v18, v46, v6 row_newbcast:0 row_mask:0xf bank_mask:0xf
    v_and_b32_dpp v19, v46, v7 row_newbcast:0 row_mask:0xf bank_mask:0xf
    s_waitcnt vmcnt(3)
    v_mfma_f32_16x16x32_bf16 v[12:15], v[20:23], v[156:159], v[12:15]
    buffer_load_dwordx4 v[172:175], v2, s[16:19], s63 offen
    s_add_u32 s63, s63, 32768
    s_cmp_ge_u32 s63, 5242880
    s_cselect_b32 s63, 0, s63
    v_and_b32_dpp v20, v46, v4 row_newbcast:1 row_mask:0xf bank_mask:0xf
    v_and_b32_dpp v21, v46, v5 row_newbcast:1 row_mask:0xf bank_mask:0xf
    v_and_b32_dpp v22, v46, v6 row_newbcast:1 row_mask:0xf bank_mask:0xf
    v_and_b32_dpp v23, v46, v7 row_newbcast:1 row_mask:0xf bank_mask:0xf
    s_waitcnt vmcnt(3)
    v_mfma_f32_16x16x32_bf16 v[12:15], v[16:19], v[160:163], v[12:15]
    buffer_load_dwordx4 v[176:179], v2, s[16:19], s63 offen
    s_add_u32 s63, s63, 32768
    s_cmp_ge_u32 s63, 5242880
    s_cselect_b32 s63, 0, s63
    v_and_b32_dpp v16, v46, v4 row_newbcast:2 row_mask:0xf bank_mask:0xf
    v_and_b32_dpp v17, v46, v5 row_newbcast:2 row_mask:0xf bank_mask:0xf
    v_and_b32_dpp v18, v46, v6 row_newbcast:2 row_mask:0xf bank_mask:0xf
    v_and_b32_dpp v19, v46, v7 row_newbcast:2 row_mask:0xf bank_mask:0xf
    s_waitcnt vmcnt(3)
    v_mfma_f32_16x16x32_bf16 v[12:15], v[20:23], v[164:167], v[12:15]
    buffer_load_dwordx4 v[180:183], v2, s[16:19], s63 offen
    s_add_u32 s63, s63, 32768
    s_cmp_ge_u32 s63, 5242880
    s_cselect_b32 s63, 0, s63
    v_and_b32_dpp v20, v46, v4 row_newbcast:3 row_mask:0xf bank_mask:0xf
    v_and_b32_dpp v21, v46, v5 row_newbcast:3 row_mask:0xf bank_mask:0xf
    v_and_b32_dpp v22, v46, v6 row_newbcast:3 row_mask:0xf bank_mask:0xf
    v_and_b32_dpp v23, v46, v7 row_newbcast:3 row_mask:0xf bank_mask:0xf
    s_waitcnt vmcnt(3)
    v_mfma_f32_16x16x32_bf16 v[12:15], v[16:19], v[168:171], v[12:15]
    buffer_load_dwordx4 v[184:187], v2, s[16:19], s63 offen
    s_add_u32 s63, s63, 32768
    s_cmp_ge_u32 s63, 5242880
    s_cselect_b32 s63, 0, s63
    v_and_b32_dpp v16, v46, v4 row_newbcast:4 row_mask:0xf bank_mask:0xf
    v_and_b32_dpp v17, v46, v5 row_newbcast:4 row_mask:0xf bank_mask:0xf
    v_and_b32_dpp v18, v46, v6 row_newbcast:4 row_mask:0xf bank_mask:0xf
    v_and_b32_dpp v19, v46, v7 row_newbcast:4 row_mask:0xf bank_mask:0xf
    s_waitcnt vmcnt(3)
    v_mfma_f32_16x16x32_bf16 v[12:15], v[20:23], v[172:175], v[12:15]
    buffer_load_dwordx4 v[188:191], v2, s[16:19], s63 offen
    s_add_u32 s63, s63, 32768
    s_cmp_ge_u32 s63, 5242880
    s_cselect_b32 s63, 0, s63
    v_and_b32_dpp v20, v46, v4 row_newbcast:5 row_mask:0xf bank_mask:0xf
    v_and_b32_dpp v21, v46, v5 row_newbcast:5 row_mask:0xf bank_mask:0xf
    v_and_b32_dpp v22, v46, v6 row_newbcast:5 row_mask:0xf bank_mask:0xf
    v_and_b32_dpp v23, v46, v7 row_newbcast:5 row_mask:0xf bank_mask:0xf
    s_waitcnt vmcnt(3)
    v_mfma_f32_16x16x32_bf16 v[12:15], v[16:19], v[176:179], v[12:15]
    buffer_load_dwordx4 v[192:195], v2, s[16:19], s63 offen
    s_add_u32 s63, s63, 32768
    s_cmp_ge_u32 s63, 5242880
    s_cselect_b32 s63, 0, s63
    v_and_b32_dpp v16, v46, v4 row_newbcast:6 row_mask:0xf bank_mask:0xf
    v_and_b32_dpp v17, v46, v5 row_newbcast:6 row_mask:0xf bank_mask:0xf
    v_and_b32_dpp v18, v46, v6 row_newbcast:6 row_mask:0xf bank_mask:0xf
    v_and_b32_dpp v19, v46, v7 row_newbcast:6 row_mask:0xf bank_mask:0xf
    s_waitcnt vmcnt(3)
    v_mfma_f32_16x16x32_bf16 v[12:15], v[20:23], v[180:183], v[12:15]
    buffer_load_dwordx4 v[196:199], v2, s[16:19], s63 offen
    s_add_u32 s63, s63, 32768
    s_cmp_ge_u32 s63, 5242880
    s_cselect_b32 s63, 0, s63
    v_and_b32_dpp v20, v46, v4 row_newbcast:7 row_mask:0xf bank_mask:0xf
    v_and_b32_dpp v21, v46, v5 row_newbcast:7 row_mask:0xf bank_mask:0xf
    v_and_b32_dpp v22, v46, v6 row_newbcast:7 row_mask:0xf bank_mask:0xf
    v_and_b32_dpp v23, v46, v7 row_newbcast:7 row_mask:0xf bank_mask:0xf
    s_waitcnt vmcnt(3)
    v_mfma_f32_16x16x32_bf16 v[12:15], v[16:19], v[184:187], v[12:15]
    buffer_load_dwordx4 v[200:203], v2, s[16:19], s63 offen
    s_add_u32 s63, s63, 32768
    s_cmp_ge_u32 s63, 5242880
    s_cselect_b32 s63, 0, s63
    v_and_b32_dpp v16, v46, v4 row_newbcast:8 row_mask:0xf bank_mask:0xf
    v_and_b32_dpp v17, v46, v5 row_newbcast:8 row_mask:0xf bank_mask:0xf
    v_and_b32_dpp v18, v46, v6 row_newbcast:8 row_mask:0xf bank_mask:0xf
    v_and_b32_dpp v19, v46, v7 row_newbcast:8 row_mask:0xf bank_mask:0xf
    s_waitcnt vmcnt(3)
    v_mfma_f32_16x16x32_bf16 v[12:15], v[20:23], v[188:191], v[12:15]
    buffer_load_dwordx4 v[204:207], v2, s[16:19], s63 offen
    s_add_u32 s63, s63, 32768
    s_cmp_ge_u32 s63, 5242880
    s_cselect_b32 s63, 0, s63
    v_and_b32_dpp v20, v46, v4 row_newbcast:9 row_mask:0xf bank_mask:0xf
    v_and_b32_dpp v21, v46, v5 row_newbcast:9 row_mask:0xf bank_mask:0xf
    v_and_b32_dpp v22, v46, v6 row_newbcast:9 row_mask:0xf bank_mask:0xf
    v_and_b32_dpp v23, v46, v7 row_newbcast:9 row_mask:0xf bank_mask:0xf
    s_waitcnt vmcnt(3)
    v_mfma_f32_16x16x32_bf16 v[12:15], v[16:19], v[192:195], v[12:15]
    buffer_load_dwordx4 v[208:211], v2, s[16:19], s63 offen
    s_add_u32 s63, s63, 32768
    s_cmp_ge_u32 s63, 5242880
    s_cselect_b32 s63, 0, s63
    v_and_b32_dpp v16, v46, v4 row_newbcast:10 row_mask:0xf bank_mask:0xf
    v_and_b32_dpp v17, v46, v5 row_newbcast:10 row_mask:0xf bank_mask:0xf
    v_and_b32_dpp v18, v46, v6 row_newbcast:10 row_mask:0xf bank_mask:0xf
    v_and_b32_dpp v19, v46, v7 row_newbcast:10 row_mask:0xf bank_mask:0xf
    s_waitcnt vmcnt(3)
    v_mfma_f32_16x16x32_bf16 v[12:15], v[20:23], v[196:199], v[12:15]
    buffer_load_dwordx4 v[212:215], v2, s[16:19], s63 offen
    s_add_u32 s63, s63, 32768
    s_cmp_ge_u32 s63, 5242880
    s_cselect_b32 s63, 0, s63
    v_and_b32_dpp v20, v46, v4 row_newbcast:11 row_mask:0xf bank_mask:0xf
    v_and_b32_dpp v21, v46, v5 row_newbcast:11 row_mask:0xf bank_mask:0xf
    v_and_b32_dpp v22, v46, v6 row_newbcast:11 row_mask:0xf bank_mask:0xf
    v_and_b32_dpp v23, v46, v7 row_newbcast:11 row_mask:0xf bank_mask:0xf
    s_waitcnt vmcnt(3)
    v_mfma_f32_16x16x32_bf16 v[12:15], v[16:19], v[200:203], v[12:15]
    buffer_load_dwordx4 v[216:219], v2, s[16:19], s63 offen
    s_add_u32 s63, s63, 32768
    s_cmp_ge_u32 s63, 5242880
    s_cselect_b32 s63, 0, s63
    v_and_b32_dpp v16, v46, v4 row_newbcast:12 row_mask:0xf bank_mask:0xf
    v_and_b32_dpp v17, v46, v5 row_newbcast:12 row_mask:0xf bank_mask:0xf
    v_and_b32_dpp v18, v46, v6 row_newbcast:12 row_mask:0xf bank_mask:0xf
    v_and_b32_dpp v19, v46, v7 row_newbcast:12 row_mask:0xf bank_mask:0xf
    s_waitcnt vmcnt(3)
    v_mfma_f32_16x16x32_bf16 v[12:15], v[20:23], v[204:207], v[12:15]
    buffer_load_dwordx4 v[220:223], v2, s[16:19], s63 offen
    s_add_u32 s63, s63, 32768
    s_cmp_ge_u32 s63, 5242880
    s_cselect_b32 s63, 0, s63
    v_and_b32_dpp v20, v46, v4 row_newbcast:13 row_mask:0xf bank_mask:0xf
    v_and_b32_dpp v21, v46, v5 row_newbcast:13 row_mask:0xf bank_mask:0xf
    v_and_b32_dpp v22, v46, v6 row_newbcast:13 row_mask:0xf bank_mask:0xf
    v_and_b32_dpp v23, v46, v7 row_newbcast:13 row_mask:0xf bank_mask:0xf
    s_waitcnt vmcnt(3)
    v_mfma_f32_16x16x32_bf16 v[12:15], v[16:19], v[208:211], v[12:15]
    buffer_load_dwordx4 v[224:227], v2, s[16:19], s63 offen
    s_add_u32 s63, s63, 32768
    s_cmp_ge_u32 s63, 5242880
    s_cselect_b32 s63, 0, s63
    v_and_b32_dpp v16, v46, v4 row_newbcast:14 row_mask:0xf bank_mask:0xf
    v_and_b32_dpp v17, v46, v5 row_newbcast:14 row_mask:0xf bank_mask:0xf
    v_and_b32_dpp v18, v46, v6 row_newbcast:14 row_mask:0xf bank_mask:0xf
    v_and_b32_dpp v19, v46, v7 row_newbcast:14 row_mask:0xf bank_mask:0xf
    s_waitcnt vmcnt(3)
    v_mfma_f32_16x16x32_bf16 v[12:15], v[20:23], v[212:215], v[12:15]
    buffer_load_dwordx4 v[228:231], v2, s[16:19], s63 offen
    s_add_u32 s63, s63, 32768
    s_cmp_ge_u32 s63, 5242880
    s_cselect_b32 s63, 0, s63
    v_and_b32_dpp v20, v46, v4 row_newbcast:15 row_mask:0xf bank_mask:0xf
    v_and_b32_dpp v21, v46, v5 row_newbcast:15 row_mask:0xf bank_mask:0xf
    v_and_b32_dpp v22, v46, v6 row_newbcast:15 row_mask:0xf bank_mask:0xf
    v_and_b32_dpp v23, v46, v7 row_newbcast:15 row_mask:0xf bank_mask:0xf
    s_waitcnt vmcnt(3)
    v_mfma_f32_16x16x32_bf16 v[12:15], v[16:19], v[216:219], v[12:15]
    buffer_load_dwordx4 v[232:235], v2, s[16:19], s63 offen
    s_add_u32 s63, s63, 32768
    s_cmp_ge_u32 s63, 5242880
    s_cselect_b32 s63, 0, s63
    v_and_b32_dpp v16, v47, v4 row_newbcast:0 row_mask:0xf bank_mask:0xf
    v_and_b32_dpp v17, v47, v5 row_newbcast:0 row_mask:0xf bank_mask:0xf
    v_and_b32_dpp v18, v47, v6 row_newbcast:0 row_mask:0xf bank_mask:0xf
    v_and_b32_dpp v19, v47, v7 row_newbcast:0 row_mask:0xf bank_mask:0xf
    s_waitcnt vmcnt(3)
    v_mfma_f32_16x16x32_bf16 v[12:15], v[20:23], v[220:223], v[12:15]
    buffer_load_dwordx4 v[236:239], v2, s[16:19], s63 offen
    s_add_u32 s63, s63, 32768
    s_cmp_ge_u32 s63, 5242880
    s_cselect_b32 s63, 0, s63
    v_and_b32_dpp v20, v47, v4 row_newbcast:1 row_mask:0xf bank_mask:0xf
    v_and_b32_dpp v21, v47, v5 row_newbcast:1 row_mask:0xf bank_mask:0xf
    v_and_b32_dpp v22, v47, v6 row_newbcast:1 row_mask:0xf bank_mask:0xf
    v_and_b32_dpp v23, v47, v7 row_newbcast:1 row_mask:0xf bank_mask:0xf
    s_waitcnt vmcnt(3)
    v_mfma_f32_16x16x32_bf16 v[12:15], v[16:19], v[224:227], v[12:15]
    buffer_load_dwordx4 v[240:243], v2, s[16:19], s63 offen
    s_add_u32 s63, s63, 32768
    s_cmp_ge_u32 s63, 5242880
    s_cselect_b32 s63, 0, s63
    v_and_b32_dpp v16, v47, v4 row_newbcast:2 row_mask:0xf bank_mask:0xf
    v_and_b32_dpp v17, v47, v5 row_newbcast:2 row_mask:0xf bank_mask:0xf
    v_and_b32_dpp v18, v47, v6 row_newbcast:2 row_mask:0xf bank_mask:0xf
    v_and_b32_dpp v19, v47, v7 row_newbcast:2 row_mask:0xf bank_mask:0xf
    s_waitcnt vmcnt(3)
    v_mfma_f32_16x16x32_bf16 v[12:15], v[20:23], v[228:231], v[12:15]
    buffer_load_dwordx4 v[244:247], v2, s[16:19], s63 offen
    s_add_u32 s63, s63, 32768
    s_cmp_ge_u32 s63, 5242880
    s_cselect_b32 s63, 0, s63
    v_and_b32_dpp v20, v47, v4 row_newbcast:3 row_mask:0xf bank_mask:0xf
    v_and_b32_dpp v21, v47, v5 row_newbcast:3 row_mask:0xf bank_mask:0xf
    v_and_b32_dpp v22, v47, v6 row_newbcast:3 row_mask:0xf bank_mask:0xf
    v_and_b32_dpp v23, v47, v7 row_newbcast:3 row_mask:0xf bank_mask:0xf
    s_waitcnt vmcnt(3)
    v_mfma_f32_16x16x32_bf16 v[12:15], v[16:19], v[232:235], v[12:15]
    buffer_load_dwordx4 v[248:251], v2, s[16:19], s63 offen
    s_add_u32 s63, s63, 32768
    s_cmp_ge_u32 s63, 5242880
    s_cselect_b32 s63, 0, s63
    v_and_b32_dpp v16, v47, v4 row_newbcast:4 row_mask:0xf bank_mask:0xf
    v_and_b32_dpp v17, v47, v5 row_newbcast:4 row_mask:0xf bank_mask:0xf
    v_and_b32_dpp v18, v47, v6 row_newbcast:4 row_mask:0xf bank_mask:0xf
    v_and_b32_dpp v19, v47, v7 row_newbcast:4 row_mask:0xf bank_mask:0xf
    s_waitcnt vmcnt(3)
    v_mfma_f32_16x16x32_bf16 v[12:15], v[20:23], v[236:239], v[12:15]
    buffer_load_dwordx4 v[252:255], v2, s[16:19], s63 offen
    v_and_b32_dpp v20, v47, v4 row_newbcast:5 row_mask:0xf bank_mask:0xf
    v_and_b32_dpp v21, v47, v5 row_newbcast:5 row_mask:0xf bank_mask:0xf
    v_and_b32_dpp v22, v47, v6 row_newbcast:5 row_mask:0xf bank_mask:0xf
    v_and_b32_dpp v23, v47, v7 row_newbcast:5 row_mask:0xf bank_mask:0xf
    s_waitcnt vmcnt(3)
    v_mfma_f32_16x16x32_bf16 v[12:15], v[16:19], v[240:243], v[12:15]
    v_and_b32_dpp v16, v47, v4 row_newbcast:6 row_mask:0xf bank_mask:0xf
    v_and_b32_dpp v17, v47, v5 row_newbcast:6 row_mask:0xf bank_mask:0xf
    v_and_b32_dpp v18, v47, v6 row_newbcast:6 row_mask:0xf bank_mask:0xf
    v_and_b32_dpp v19, v47, v7 row_newbcast:6 row_mask:0xf bank_mask:0xf
    s_waitcnt vmcnt(2)
    v_mfma_f32_16x16x32_bf16 v[12:15], v[20:23], v[244:247], v[12:15]
    v_and_b32_dpp v20, v47, v4 row_newbcast:7 row_mask:0xf bank_mask:0xf
    v_and_b32_dpp v21, v47, v5 row_newbcast:7 row_mask:0xf bank_mask:0xf
    v_and_b32_dpp v22, v47, v6 row_newbcast:7 row_mask:0xf bank_mask:0xf
    v_and_b32_dpp v23, v47, v7 row_newbcast:7 row_mask:0xf bank_mask:0xf
    s_waitcnt vmcnt(1)
    v_mfma_f32_16x16x32_bf16 v[12:15], v[16:19], v[248:251], v[12:15]
    s_waitcnt vmcnt(0)
    v_mfma_f32_16x16x32_bf16 v[12:15], v[20:23], v[252:255], v[12:15]
    s_mul_i32 s54, s97, 528
    v_add_u32 v50, s54, v52
    s_mov_b32 exec_hi, 0
    s_nop 4
    ds_write_b128 v50, v[12:15] offset:0
    s_mov_b32 exec_hi, -1
    s_waitcnt vmcnt(0) lgkmcnt(0)
    s_barrier
    s_and_b32 s54, s53, 7
    s_xor_b32 s55, s3, 7
    s_or_b32 s54, s54, s55
    s_cmp_lg_u32 s54, 0
    s_cbranch_scc1 L_noready
    s_lshl_b32 s54, s52, 5
    v_mov_b32 v39, 1
    v_mov_b32 v40, 0
    s_mov_b64 exec, 1
    buffer_atomic_add v39, v40, s[44:47], s54 offen sc1
    s_mov_b64 exec, -1
L_noready:
    v_lshlrev_b32 v2, 4, v1
    s_mul_i32 s63, s97, 864
    v_mov_b32 v144, 0
    v_mov_b32 v145, 0
    v_mov_b32 v146, 0
    v_mov_b32 v147, 0
    v_mov_b32 v148, 0
    v_mov_b32 v149, 0
    v_mov_b32 v150, 0
    v_mov_b32 v151, 0
    v_mov_b32 v152, 0
    v_mov_b32 v153, 0
    v_mov_b32 v154, 0
    v_mov_b32 v155, 0
    s_mov_b32 exec_hi, 0x3fffff
    buffer_load_dwordx4 v[144:147], v2, s[24:27], s63 offen
    buffer_load_dwordx4 v[148:151], v2, s[28:31], s63 offen
    buffer_load_dwordx4 v[152:155], v2, s[32:35], s63 offen
    s_mov_b32 exec_hi, -1
    v_add_f32 v39, v29, v30
    v_add_f32 v40, v31, v32
    v_add_f32 v39, v39, v33
    v_add_f32 v40, v40, v34
    v_add_f32 v39, v39, v35
    v_add_f32 v40, v40, v36
    v_add_f32 v39, v39, v37
    v_add_f32 v40, v40, v38
    v_add_f32 v39, v39, v40
    s_nop 1
    v_add_f32_dpp v39, v39, v39 row_ror:8 row_mask:0xf bank_mask:0xf
    s_nop 1
    v_add_f32_dpp v39, v39, v39 row_ror:4 row_mask:0xf bank_mask:0xf
    s_nop 1
    v_add_f32_dpp v39, v39, v39 row_ror:2 row_mask:0xf bank_mask:0xf
    s_nop 1
    v_add_f32_dpp v39, v39, v39 row_ror:1 row_mask:0xf bank_mask:0xf
    s_nop 1
    v_add_f32_dpp v39, v39, v39 row_bcast:15 row_mask:0xa bank_mask:0xf
    s_nop 1
    v_add_f32_dpp v39, v39, v39 row_bcast:31 row_mask:0xc bank_mask:0xf
    s_nop 0
    v_readlane_b32 s54, v39, 63
    v_mov_b32 v42, s93
    s_nop 0
    v_mul_f32 v42, s54, v42
    v_sub_f32 v41, v29, v42
    v_mul_f32 v39, v41, v41
    v_sub_f32 v41, v30, v42
    v_mul_f32 v40, v41, v41
    v_sub_f32 v41, v31, v42
    v_fmac_f32 v39, v41, v41
    v_sub_f32 v41, v32, v42
    v_fmac_f32 v40, v41, v41
    v_sub_f32 v41, v33, v42
    v_fmac_f32 v39, v41, v41
    v_sub_f32 v41, v34, v42
    v_fmac_f32 v40, v41, v41
    v_sub_f32 v41, v35, v42
    v_fmac_f32 v39, v41, v41
    v_sub_f32 v41, v36, v42
    v_fmac_f32 v40, v41, v41
    v_sub_f32 v41, v37, v42
    v_fmac_f32 v39, v41, v41
    v_sub_f32 v41, v38, v42
    v_fmac_f32 v40, v41, v41
    v_add_f32 v39, v39, v40
    s_nop 1
    v_add_f32_dpp v39, v39, v39 row_ror:8 row_mask:0xf bank_mask:0xf
    s_nop 1
    v_add_f32_dpp v39, v39, v39 row_ror:4 row_mask:0xf bank_mask:0xf
    s_nop 1
    v_add_f32_dpp v39, v39, v39 row_ror:2 row_mask:0xf bank_mask:0xf
    s_nop 1
    v_add_f32_dpp v39, v39, v39 row_ror:1 row_mask:0xf bank_mask:0xf
    s_nop 1
    v_add_f32_dpp v39, v39, v39 row_bcast:15 row_mask:0xa bank_mask:0xf
    s_nop 1
    v_add_f32_dpp v39, v39, v39 row_bcast:31 row_mask:0xc bank_mask:0xf
    s_nop 0
    v_readlane_b32 s54, v39, 63
    v_mov_b32 v43, s93
    s_nop 0
    v_mul_f32 v43, s54, v43
    v_cvt_pk_bf16_f32 v39, v42, v43
    v_lshlrev_b32 v42, 16, v39
    v_and_b32 v43, 0xffff0000, v39
    v_add_f32 v43, 0x3727c5ac, v43
    v_cvt_pk_bf16_f32 v43, v43, v43
    v_and_b32 v43, 0xffff0000, v43
    v_sqrt_f32 v43, v43
    s_nop 0
    v_cvt_pk_bf16_f32 v43, v43, v43
    v_and_b32 v43, 0xffff0000, v43
    v_rcp_f32 v44, v43
    v_sub_f32 v48, v48, v42
    v_sub_f32 v29, v29, v42
    v_cvt_pk_bf16_f32 v41, v48, v29
    v_lshlrev_b32 v48, 16, v41
    v_and_b32 v29, 0xffff0000, v41
    v_mul_f32 v39, v48, v44
    v_mul_f32 v40, v29, v44
    v_fma_f32 v48, -v39, v43, v48
    v_fma_f32 v29, -v40, v43, v29
    v_fmac_f32 v39, v48, v44
    v_fmac_f32 v40, v29, v44
    v_cvt_pk_bf16_f32 v41, v39, v40
    v_lshlrev_b32 v48, 16, v41
    v_and_b32 v29, 0xffff0000, v41
    v_readlane_b32 s64, v48, 0
    v_readlane_b32 s65, v48, 1
    v_readlane_b32 s66, v48, 2
    v_readlane_b32 s67, v48, 3
    v_readlane_b32 s68, v48, 4
    v_readlane_b32 s69, v48, 5
    v_readlane_b32 s70, v48, 6
    v_readlane_b32 s71, v48, 7
    v_readlane_b32 s72, v48, 8
    v_readlane_b32 s73, v48, 9
    v_readlane_b32 s74, v48, 10
    v_readlane_b32 s75, v48, 11
    v_readlane_b32 s76, v48, 12
    v_readlane_b32 s77, v48, 13
    v_readlane_b32 s78, v48, 14
    v_readlane_b32 s79, v48, 15
    v_readlane_b32 s80, v48, 16
    v_readlane_b32 s81, v48, 17
    v_readlane_b32 s82, v48, 18
    v_readlane_b32 s83, v48, 19
    v_mov_b32 v105, 0xc0135761
    v_mov_b32 v120, 0
    v_mov_b32 v121, 0
    v_mov_b32 v122, 0
    v_mov_b32 v123, 0
    v_mov_b32 v124, 0
    v_mov_b32 v125, 0
    v_mov_b32 v126, 0
    v_mov_b32 v127, 0
    v_mov_b32 v128, 0
    v_mov_b32 v129, 0
    v_mov_b32 v130, 0
    v_mov_b32 v131, 0
    v_mov_b32 v132, 0
    v_mov_b32 v133, 0
    v_mov_b32 v134, 0
    v_mov_b32 v135, 0
    v_mov_b32 v136, 0
    v_mov_b32 v137, 0
    v_mov_b32 v138, 0
    v_mov_b32 v139, 0
    s_mov_b32 s96, 0
    s_nop 0
L_gate:
    s_waitcnt vmcnt(0)
    v_lshlrev_b32 v100, 16, v144
    v_and_b32 v101, 0xffff0000, v144
    v_lshlrev_b32 v102, 16, v148
    v_and_b32 v103, 0xffff0000, v148
    v_mov_b32 v104, v152
    v_mov_b32 v144, v145
    v_mov_b32 v145, v146
    v_mov_b32 v146, v147
    v_mov_b32 v148, v149
    v_mov_b32 v149, v150
    v_mov_b32 v150, v151
    v_mov_b32 v152, v153
    v_mov_b32 v153, v154
    v_mov_b32 v154, v155
    v_mul_f32 v108, s64, v100
    v_mul_f32 v113, s65, v100
    v_mul_f32 v109, s64, v101
    v_mul_f32 v114, s65, v101
    v_cvt_pk_bf16_f32 v110, v108, v109
    v_cvt_pk_bf16_f32 v115, v113, v114
    v_lshlrev_b32 v108, 16, v110
    v_lshlrev_b32 v113, 16, v115
    v_and_b32 v109, 0xffff0000, v110
    v_and_b32 v114, 0xffff0000, v115
    v_add_f32 v108, v108, v102
    v_add_f32 v113, v113, v102
    v_add_f32 v109, v109, v103
    v_add_f32 v114, v114, v103
    v_cvt_pk_bf16_f32 v110, v108, v109
    v_cvt_pk_bf16_f32 v115, v113, v114
    v_lshlrev_b32 v108, 16, v110
    v_lshlrev_b32 v113, 16, v115
    v_and_b32 v109, 0xffff0000, v110
    v_and_b32 v114, 0xffff0000, v115
    v_mul_f32 v111, v108, v108
    v_mul_f32 v116, v113, v113
    v_mul_f32 v112, v109, v109
    v_mul_f32 v117, v114, v114
    v_fma_f32 v111, v111, s90, v105
    v_fma_f32 v116, v116, s90, v105
    v_fma_f32 v112, v112, s90, v105
    v_fma_f32 v117, v117, s90, v105
    v_mul_f32 v111, v111, v108
    v_mul_f32 v116, v116, v113
    v_mul_f32 v112, v112, v109
    v_mul_f32 v117, v117, v114
    v_exp_f32 v111, v111
    v_exp_f32 v116, v116
    v_exp_f32 v112, v112
    v_exp_f32 v117, v117
    v_add_f32 v111, 1.0, v111
    v_add_f32 v116, 1.0, v116
    v_add_f32 v112, 1.0, v112
    v_add_f32 v117, 1.0, v117
    v_rcp_f32 v111, v111
    v_rcp_f32 v116, v116
    v_rcp_f32 v112, v112
    v_rcp_f32 v117, v117
    v_mul_f32 v108, v108, v111
    v_mul_f32 v113, v113, v116
    v_mul_f32 v109, v109, v112
    v_mul_f32 v114, v114, v117
    v_cvt_pk_bf16_f32 v110, v108, v109
    v_cvt_pk_bf16_f32 v115, v113, v114
    v_dot2_f32_bf16 v120, v110, v104, v120
    v_dot2_f32_bf16 v121, v115, v104, v121
    v_mul_f32 v108, s66, v100
    v_mul_f32 v113, s67, v100
    v_mul_f32 v109, s66, v101
    v_mul_f32 v114, s67, v101
    v_cvt_pk_bf16_f32 v110, v108, v109
    v_cvt_pk_bf16_f32 v115, v113, v114
    v_lshlrev_b32 v108, 16, v110
    v_lshlrev_b32 v113, 16, v115
    v_and_b32 v109, 0xffff0000, v110
    v_and_b32 v114, 0xffff0000, v115
    v_add_f32 v108, v108, v102
    v_add_f32 v113, v113, v102
    v_add_f32 v109, v109, v103
    v_add_f32 v114, v114, v103
    v_cvt_pk_bf16_f32 v110, v108, v109
    v_cvt_pk_bf16_f32 v115, v113, v114
    v_lshlrev_b32 v108, 16, v110
    v_lshlrev_b32 v113, 16, v115
    v_and_b32 v109, 0xffff0000, v110
    v_and_b32 v114, 0xffff0000, v115
    v_mul_f32 v111, v108, v108
    v_mul_f32 v116, v113, v113
    v_mul_f32 v112, v109, v109
    v_mul_f32 v117, v114, v114
    v_fma_f32 v111, v111, s90, v105
    v_fma_f32 v116, v116, s90, v105
    v_fma_f32 v112, v112, s90, v105
    v_fma_f32 v117, v117, s90, v105
    v_mul_f32 v111, v111, v108
    v_mul_f32 v116, v116, v113
    v_mul_f32 v112, v112, v109
    v_mul_f32 v117, v117, v114
    v_exp_f32 v111, v111
    v_exp_f32 v116, v116
    v_exp_f32 v112, v112
    v_exp_f32 v117, v117
    v_add_f32 v111, 1.0, v111
    v_add_f32 v116, 1.0, v116
    v_add_f32 v112, 1.0, v112
    v_add_f32 v117, 1.0, v117
    v_rcp_f32 v111, v111
    v_rcp_f32 v116, v116
    v_rcp_f32 v112, v112
    v_rcp_f32 v117, v117
    v_mul_f32 v108, v108, v111
    v_mul_f32 v113, v113, v116
    v_mul_f32 v109, v109, v112
    v_mul_f32 v114, v114, v117
    v_cvt_pk_bf16_f32 v110, v108, v109
    v_cvt_pk_bf16_f32 v115, v113, v114
    v_dot2_f32_bf16 v122, v110, v104, v122
    v_dot2_f32_bf16 v123, v115, v104, v123
    v_mul_f32 v108, s68, v100
    v_mul_f32 v113, s69, v100
    v_mul_f32 v109, s68, v101
    v_mul_f32 v114, s69, v101
    v_cvt_pk_bf16_f32 v110, v108, v109
    v_cvt_pk_bf16_f32 v115, v113, v114
    v_lshlrev_b32 v108, 16, v110
    v_lshlrev_b32 v113, 16, v115
    v_and_b32 v109, 0xffff0000, v110
    v_and_b32 v114, 0xffff0000, v115
    v_add_f32 v108, v108, v102
    v_add_f32 v113, v113, v102
    v_add_f32 v109, v109, v103
    v_add_f32 v114, v114, v103
    v_cvt_pk_bf16_f32 v110, v108, v109
    v_cvt_pk_bf16_f32 v115, v113, v114
    v_lshlrev_b32 v108, 16, v110
    v_lshlrev_b32 v113, 16, v115
    v_and_b32 v109, 0xffff0000, v110
    v_and_b32 v114, 0xffff0000, v115
    v_mul_f32 v111, v108, v108
    v_mul_f32 v116, v113, v113
    v_mul_f32 v112, v109, v109
    v_mul_f32 v117, v114, v114
    v_fma_f32 v111, v111, s90, v105
    v_fma_f32 v116, v116, s90, v105
    v_fma_f32 v112, v112, s90, v105
    v_fma_f32 v117, v117, s90, v105
    v_mul_f32 v111, v111, v108
    v_mul_f32 v116, v116, v113
    v_mul_f32 v112, v112, v109
    v_mul_f32 v117, v117, v114
    v_exp_f32 v111, v111
    v_exp_f32 v116, v116
    v_exp_f32 v112, v112
    v_exp_f32 v117, v117
    v_add_f32 v111, 1.0, v111
    v_add_f32 v116, 1.0, v116
    v_add_f32 v112, 1.0, v112
    v_add_f32 v117, 1.0, v117
    v_rcp_f32 v111, v111
    v_rcp_f32 v116, v116
    v_rcp_f32 v112, v112
    v_rcp_f32 v117, v117
    v_mul_f32 v108, v108, v111
    v_mul_f32 v113, v113, v116
    v_mul_f32 v109, v109, v112
    v_mul_f32 v114, v114, v117
    v_cvt_pk_bf16_f32 v110, v108, v109
    v_cvt_pk_bf16_f32 v115, v113, v114
    v_dot2_f32_bf16 v124, v110, v104, v124
    v_dot2_f32_bf16 v125, v115, v104, v125
    v_mul_f32 v108, s70, v100
    v_mul_f32 v113, s71, v100
    v_mul_f32 v109, s70, v101
    v_mul_f32 v114, s71, v101
    v_cvt_pk_bf16_f32 v110, v108, v109
    v_cvt_pk_bf16_f32 v115, v113, v114
    v_lshlrev_b32 v108, 16, v110
    v_lshlrev_b32 v113, 16, v115
    v_and_b32 v109, 0xffff0000, v110
    v_and_b32 v114, 0xffff0000, v115
    v_add_f32 v108, v108, v102
    v_add_f32 v113, v113, v102
    v_add_f32 v109, v109, v103
    v_add_f32 v114, v114, v103
    v_cvt_pk_bf16_f32 v110, v108, v109
    v_cvt_pk_bf16_f32 v115, v113, v114
    v_lshlrev_b32 v108, 16, v110
    v_lshlrev_b32 v113, 16, v115
    v_and_b32 v109, 0xffff0000, v110
    v_and_b32 v114, 0xffff0000, v115
    v_mul_f32 v111, v108, v108
    v_mul_f32 v116, v113, v113
    v_mul_f32 v112, v109, v109
    v_mul_f32 v117, v114, v114
    v_fma_f32 v111, v111, s90, v105
    v_fma_f32 v116, v116, s90, v105
    v_fma_f32 v112, v112, s90, v105
    v_fma_f32 v117, v117, s90, v105
    v_mul_f32 v111, v111, v108
    v_mul_f32 v116, v116, v113
    v_mul_f32 v112, v112, v109
    v_mul_f32 v117, v117, v114
    v_exp_f32 v111, v111
    v_exp_f32 v116, v116
    v_exp_f32 v112, v112
    v_exp_f32 v117, v117
    v_add_f32 v111, 1.0, v111
    v_add_f32 v116, 1.0, v116
    v_add_f32 v112, 1.0, v112
    v_add_f32 v117, 1.0, v117
    v_rcp_f32 v111, v111
    v_rcp_f32 v116, v116
    v_rcp_f32 v112, v112
    v_rcp_f32 v117, v117
    v_mul_f32 v108, v108, v111
    v_mul_f32 v113, v113, v116
    v_mul_f32 v109, v109, v112
    v_mul_f32 v114, v114, v117
    v_cvt_pk_bf16_f32 v110, v108, v109
    v_cvt_pk_bf16_f32 v115, v113, v114
    v_dot2_f32_bf16 v126, v110, v104, v126
    v_dot2_f32_bf16 v127, v115, v104, v127
    v_mul_f32 v108, s72, v100
    v_mul_f32 v113, s73, v100
    v_mul_f32 v109, s72, v101
    v_mul_f32 v114, s73, v101
    v_cvt_pk_bf16_f32 v110, v108, v109
    v_cvt_pk_bf16_f32 v115, v113, v114
    v_lshlrev_b32 v108, 16, v110
    v_lshlrev_b32 v113, 16, v115
    v_and_b32 v109, 0xffff0000, v110
    v_and_b32 v114, 0xffff0000, v115
    v_add_f32 v108, v108, v102
    v_add_f32 v113, v113, v102
    v_add_f32 v109, v109, v103
    v_add_f32 v114, v114, v103
    v_cvt_pk_bf16_f32 v110, v108, v109
    v_cvt_pk_bf16_f32 v115, v113, v114
    v_lshlrev_b32 v108, 16, v110
    v_lshlrev_b32 v113, 16, v115
    v_and_b32 v109, 0xffff0000, v110
    v_and_b32 v114, 0xffff0000, v115
    v_mul_f32 v111, v108, v108
    v_mul_f32 v116, v113, v113
    v_mul_f32 v112, v109, v109
    v_mul_f32 v117, v114, v114
    v_fma_f32 v111, v111, s90, v105
    v_fma_f32 v116, v116, s90, v105
    v_fma_f32 v112, v112, s90, v105
    v_fma_f32 v117, v117, s90, v105
    v_mul_f32 v111, v111, v108
    v_mul_f32 v116, v116, v113
    v_mul_f32 v112, v112, v109
    v_mul_f32 v117, v117, v114
    v_exp_f32 v111, v111
    v_exp_f32 v116, v116
    v_exp_f32 v112, v112
    v_exp_f32 v117, v117
    v_add_f32 v111, 1.0, v111
    v_add_f32 v116, 1.0, v116
    v_add_f32 v112, 1.0, v112
    v_add_f32 v117, 1.0, v117
    v_rcp_f32 v111, v111
    v_rcp_f32 v116, v116
    v_rcp_f32 v112, v112
    v_rcp_f32 v117, v117
    v_mul_f32 v108, v108, v111
    v_mul_f32 v113, v113, v116
    v_mul_f32 v109, v109, v112
    v_mul_f32 v114, v114, v117
    v_cvt_pk_bf16_f32 v110, v108, v109
    v_cvt_pk_bf16_f32 v115, v113, v114
    v_dot2_f32_bf16 v128, v110, v104, v128
    v_dot2_f32_bf16 v129, v115, v104, v129
    v_mul_f32 v108, s74, v100
    v_mul_f32 v113, s75, v100
    v_mul_f32 v109, s74, v101
    v_mul_f32 v114, s75, v101
    v_cvt_pk_bf16_f32 v110, v108, v109
    v_cvt_pk_bf16_f32 v115, v113, v114
    v_lshlrev_b32 v108, 16, v110
    v_lshlrev_b32 v113, 16, v115
    v_and_b32 v109, 0xffff0000, v110
    v_and_b32 v114, 0xffff0000, v115
    v_add_f32 v108, v108, v102
    v_add_f32 v113, v113, v102
    v_add_f32 v109, v109, v103
    v_add_f32 v114, v114, v103
    v_cvt_pk_bf16_f32 v110, v108, v109
    v_cvt_pk_bf16_f32 v115, v113, v114
    v_lshlrev_b32 v108, 16, v110
    v_lshlrev_b32 v113, 16, v115
    v_and_b32 v109, 0xffff0000, v110
    v_and_b32 v114, 0xffff0000, v115
    v_mul_f32 v111, v108, v108
    v_mul_f32 v116, v113, v113
    v_mul_f32 v112, v109, v109
    v_mul_f32 v117, v114, v114
    v_fma_f32 v111, v111, s90, v105
    v_fma_f32 v116, v116, s90, v105
    v_fma_f32 v112, v112, s90, v105
    v_fma_f32 v117, v117, s90, v105
    v_mul_f32 v111, v111, v108
    v_mul_f32 v116, v116, v113
    v_mul_f32 v112, v112, v109
    v_mul_f32 v117, v117, v114
    v_exp_f32 v111, v111
    v_exp_f32 v116, v116
    v_exp_f32 v112, v112
    v_exp_f32 v117, v117
    v_add_f32 v111, 1.0, v111
    v_add_f32 v116, 1.0, v116
    v_add_f32 v112, 1.0, v112
    v_add_f32 v117, 1.0, v117
    v_rcp_f32 v111, v111
    v_rcp_f32 v116, v116
    v_rcp_f32 v112, v112
    v_rcp_f32 v117, v117
    v_mul_f32 v108, v108, v111
    v_mul_f32 v113, v113, v116
    v_mul_f32 v109, v109, v112
    v_mul_f32 v114, v114, v117
    v_cvt_pk_bf16_f32 v110, v108, v109
    v_cvt_pk_bf16_f32 v115, v113, v114
    v_dot2_f32_bf16 v130, v110, v104, v130
    v_dot2_f32_bf16 v131, v115, v104, v131
    v_mul_f32 v108, s76, v100
    v_mul_f32 v113, s77, v100
    v_mul_f32 v109, s76, v101
    v_mul_f32 v114, s77, v101
    v_cvt_pk_bf16_f32 v110, v108, v109
    v_cvt_pk_bf16_f32 v115, v113, v114
    v_lshlrev_b32 v108, 16, v110
    v_lshlrev_b32 v113, 16, v115
    v_and_b32 v109, 0xffff0000, v110
    v_and_b32 v114, 0xffff0000, v115
    v_add_f32 v108, v108, v102
    v_add_f32 v113, v113, v102
    v_add_f32 v109, v109, v103
    v_add_f32 v114, v114, v103
    v_cvt_pk_bf16_f32 v110, v108, v109
    v_cvt_pk_bf16_f32 v115, v113, v114
    v_lshlrev_b32 v108, 16, v110
    v_lshlrev_b32 v113, 16, v115
    v_and_b32 v109, 0xffff0000, v110
    v_and_b32 v114, 0xffff0000, v115
    v_mul_f32 v111, v108, v108
    v_mul_f32 v116, v113, v113
    v_mul_f32 v112, v109, v109
    v_mul_f32 v117, v114, v114
    v_fma_f32 v111, v111, s90, v105
    v_fma_f32 v116, v116, s90, v105
    v_fma_f32 v112, v112, s90, v105
    v_fma_f32 v117, v117, s90, v105
    v_mul_f32 v111, v111, v108
    v_mul_f32 v116, v116, v113
    v_mul_f32 v112, v112, v109
    v_mul_f32 v117, v117, v114
    v_exp_f32 v111, v111
    v_exp_f32 v116, v116
    v_exp_f32 v112, v112
    v_exp_f32 v117, v117
    v_add_f32 v111, 1.0, v111
    v_add_f32 v116, 1.0, v116
    v_add_f32 v112, 1.0, v112
    v_add_f32 v117, 1.0, v117
    v_rcp_f32 v111, v111
    v_rcp_f32 v116, v116
    v_rcp_f32 v112, v112
    v_rcp_f32 v117, v117
    v_mul_f32 v108, v108, v111
    v_mul_f32 v113, v113, v116
    v_mul_f32 v109, v109, v112
    v_mul_f32 v114, v114, v117
    v_cvt_pk_bf16_f32 v110, v108, v109
    v_cvt_pk_bf16_f32 v115, v113, v114
    v_dot2_f32_bf16 v132, v110, v104, v132
    v_dot2_f32_bf16 v133, v115, v104, v133
    v_mul_f32 v108, s78, v100
    v_mul_f32 v113, s79, v100
    v_mul_f32 v109, s78, v101
    v_mul_f32 v114, s79, v101
    v_cvt_pk_bf16_f32 v110, v108, v109
    v_cvt_pk_bf16_f32 v115, v113, v114
    v_lshlrev_b32 v108, 16, v110
    v_lshlrev_b32 v113, 16, v115
    v_and_b32 v109, 0xffff0000, v110
    v_and_b32 v114, 0xffff0000, v115
    v_add_f32 v108, v108, v102
    v_add_f32 v113, v113, v102
    v_add_f32 v109, v109, v103
    v_add_f32 v114, v114, v103
    v_cvt_pk_bf16_f32 v110, v108, v109
    v_cvt_pk_bf16_f32 v115, v113, v114
    v_lshlrev_b32 v108, 16, v110
    v_lshlrev_b32 v113, 16, v115
    v_and_b32 v109, 0xffff0000, v110
    v_and_b32 v114, 0xffff0000, v115
    v_mul_f32 v111, v108, v108
    v_mul_f32 v116, v113, v113
    v_mul_f32 v112, v109, v109
    v_mul_f32 v117, v114, v114
    v_fma_f32 v111, v111, s90, v105
    v_fma_f32 v116, v116, s90, v105
    v_fma_f32 v112, v112, s90, v105
    v_fma_f32 v117, v117, s90, v105
    v_mul_f32 v111, v111, v108
    v_mul_f32 v116, v116, v113
    v_mul_f32 v112, v112, v109
    v_mul_f32 v117, v117, v114
    v_exp_f32 v111, v111
    v_exp_f32 v116, v116
    v_exp_f32 v112, v112
    v_exp_f32 v117, v117
    v_add_f32 v111, 1.0, v111
    v_add_f32 v116, 1.0, v116
    v_add_f32 v112, 1.0, v112
    v_add_f32 v117, 1.0, v117
    v_rcp_f32 v111, v111
    v_rcp_f32 v116, v116
    v_rcp_f32 v112, v112
    v_rcp_f32 v117, v117
    v_mul_f32 v108, v108, v111
    v_mul_f32 v113, v113, v116
    v_mul_f32 v109, v109, v112
    v_mul_f32 v114, v114, v117
    v_cvt_pk_bf16_f32 v110, v108, v109
    v_cvt_pk_bf16_f32 v115, v113, v114
    v_dot2_f32_bf16 v134, v110, v104, v134
    v_dot2_f32_bf16 v135, v115, v104, v135
    v_mul_f32 v108, s80, v100
    v_mul_f32 v113, s81, v100
    v_mul_f32 v109, s80, v101
    v_mul_f32 v114, s81, v101
    v_cvt_pk_bf16_f32 v110, v108, v109
    v_cvt_pk_bf16_f32 v115, v113, v114
    v_lshlrev_b32 v108, 16, v110
    v_lshlrev_b32 v113, 16, v115
    v_and_b32 v109, 0xffff0000, v110
    v_and_b32 v114, 0xffff0000, v115
    v_add_f32 v108, v108, v102
    v_add_f32 v113, v113, v102
    v_add_f32 v109, v109, v103
    v_add_f32 v114, v114, v103
    v_cvt_pk_bf16_f32 v110, v108, v109
    v_cvt_pk_bf16_f32 v115, v113, v114
    v_lshlrev_b32 v108, 16, v110
    v_lshlrev_b32 v113, 16, v115
    v_and_b32 v109, 0xffff0000, v110
    v_and_b32 v114, 0xffff0000, v115
    v_mul_f32 v111, v108, v108
    v_mul_f32 v116, v113, v113
    v_mul_f32 v112, v109, v109
    v_mul_f32 v117, v114, v114
    v_fma_f32 v111, v111, s90, v105
    v_fma_f32 v116, v116, s90, v105
    v_fma_f32 v112, v112, s90, v105
    v_fma_f32 v117, v117, s90, v105
    v_mul_f32 v111, v111, v108
    v_mul_f32 v116, v116, v113
    v_mul_f32 v112, v112, v109
    v_mul_f32 v117, v117, v114
    v_exp_f32 v111, v111
    v_exp_f32 v116, v116
    v_exp_f32 v112, v112
    v_exp_f32 v117, v117
    v_add_f32 v111, 1.0, v111
    v_add_f32 v116, 1.0, v116
    v_add_f32 v112, 1.0, v112
    v_add_f32 v117, 1.0, v117
    v_rcp_f32 v111, v111
    v_rcp_f32 v116, v116
    v_rcp_f32 v112, v112
    v_rcp_f32 v117, v117
    v_mul_f32 v108, v108, v111
    v_mul_f32 v113, v113, v116
    v_mul_f32 v109, v109, v112
    v_mul_f32 v114, v114, v117
    v_cvt_pk_bf16_f32 v110, v108, v109
    v_cvt_pk_bf16_f32 v115, v113, v114
    v_dot2_f32_bf16 v136, v110, v104, v136
    v_dot2_f32_bf16 v137, v115, v104, v137
    v_mul_f32 v108, s82, v100
    v_mul_f32 v113, s83, v100
    v_mul_f32 v109, s82, v101
    v_mul_f32 v114, s83, v101
    v_cvt_pk_bf16_f32 v110, v108, v109
    v_cvt_pk_bf16_f32 v115, v113, v114
    v_lshlrev_b32 v108, 16, v110
    v_lshlrev_b32 v113, 16, v115
    v_and_b32 v109, 0xffff0000, v110
    v_and_b32 v114, 0xffff0000, v115
    v_add_f32 v108, v108, v102
    v_add_f32 v113, v113, v102
    v_add_f32 v109, v109, v103
    v_add_f32 v114, v114, v103
    v_cvt_pk_bf16_f32 v110, v108, v109
    v_cvt_pk_bf16_f32 v115, v113, v114
    v_lshlrev_b32 v108, 16, v110
    v_lshlrev_b32 v113, 16, v115
    v_and_b32 v109, 0xffff0000, v110
    v_and_b32 v114, 0xffff0000, v115
    v_mul_f32 v111, v108, v108
    v_mul_f32 v116, v113, v113
    v_mul_f32 v112, v109, v109
    v_mul_f32 v117, v114, v114
    v_fma_f32 v111, v111, s90, v105
    v_fma_f32 v116, v116, s90, v105
    v_fma_f32 v112, v112, s90, v105
    v_fma_f32 v117, v117, s90, v105
    v_mul_f32 v111, v111, v108
    v_mul_f32 v116, v116, v113
    v_mul_f32 v112, v112, v109
    v_mul_f32 v117, v117, v114
    v_exp_f32 v111, v111
    v_exp_f32 v116, v116
    v_exp_f32 v112, v112
    v_exp_f32 v117, v117
    v_add_f32 v111, 1.0, v111
    v_add_f32 v116, 1.0, v116
    v_add_f32 v112, 1.0, v112
    v_add_f32 v117, 1.0, v117
    v_rcp_f32 v111, v111
    v_rcp_f32 v116, v116
    v_rcp_f32 v112, v112
    v_rcp_f32 v117, v117
    v_mul_f32 v108, v108, v111
    v_mul_f32 v113, v113, v116
    v_mul_f32 v109, v109, v112
    v_mul_f32 v114, v114, v117
    v_cvt_pk_bf16_f32 v110, v108, v109
    v_cvt_pk_bf16_f32 v115, v113, v114
    v_dot2_f32_bf16 v138, v110, v104, v138
    v_dot2_f32_bf16 v139, v115, v104, v139
    s_add_u32 s96, s96, 1
    s_cmp_lt_u32 s96, 4
    s_nop 0
    s_cbranch_scc1 L_gate
    v_add_f32_dpp v108, v120, v120 row_mirror row_mask:0xf bank_mask:0x3
    v_add_f32_dpp v108, v121, v121 row_mirror row_mask:0xf bank_mask:0xc
    v_add_f32_dpp v109, v122, v122 row_mirror row_mask:0xf bank_mask:0x3
    v_add_f32_dpp v109, v123, v123 row_mirror row_mask:0xf bank_mask:0xc
    v_add_f32_dpp v110, v124, v124 row_mirror row_mask:0xf bank_mask:0x3
    v_add_f32_dpp v110, v125, v125 row_mirror row_mask:0xf bank_mask:0xc
    v_add_f32_dpp v111, v126, v126 row_mirror row_mask:0xf bank_mask:0x3
    v_add_f32_dpp v111, v127, v127 row_mirror row_mask:0xf bank_mask:0xc
    v_add_f32_dpp v112, v128, v128 row_mirror row_mask:0xf bank_mask:0x3
    v_add_f32_dpp v112, v129, v129 row_mirror row_mask:0xf bank_mask:0xc
    v_add_f32_dpp v113, v130, v130 row_mirror row_mask:0xf bank_mask:0x3
    v_add_f32_dpp v113, v131, v131 row_mirror row_mask:0xf bank_mask:0xc
    v_add_f32_dpp v114, v132, v132 row_mirror row_mask:0xf bank_mask:0x3
    v_add_f32_dpp v114, v133, v133 row_mirror row_mask:0xf bank_mask:0xc
    v_add_f32_dpp v115, v134, v134 row_mirror row_mask:0xf bank_mask:0x3
    v_add_f32_dpp v115, v135, v135 row_mirror row_mask:0xf bank_mask:0xc
    v_add_f32_dpp v116, v136, v136 row_mirror row_mask:0xf bank_mask:0x3
    v_add_f32_dpp v116, v137, v137 row_mirror row_mask:0xf bank_mask:0xc
    v_add_f32_dpp v117, v138, v138 row_mirror row_mask:0xf bank_mask:0x3
    v_add_f32_dpp v117, v139, v139 row_mirror row_mask:0xf bank_mask:0xc
    v_add_f32_dpp v120, v108, v108 row_half_mirror row_mask:0xf bank_mask:0x5
    v_add_f32_dpp v120, v109, v109 row_half_mirror row_mask:0xf bank_mask:0xa
    v_add_f32_dpp v121, v110, v110 row_half_mirror row_mask:0xf bank_mask:0x5
    v_add_f32_dpp v121, v111, v111 row_half_mirror row_mask:0xf bank_mask:0xa
    v_add_f32_dpp v122, v112, v112 row_half_mirror row_mask:0xf bank_mask:0x5
    v_add_f32_dpp v122, v113, v113 row_half_mirror row_mask:0xf bank_mask:0xa
    v_add_f32_dpp v123, v114, v114 row_half_mirror row_mask:0xf bank_mask:0x5
    v_add_f32_dpp v123, v115, v115 row_half_mirror row_mask:0xf bank_mask:0xa
    v_add_f32_dpp v124, v116, v116 row_half_mirror row_mask:0xf bank_mask:0x5
    v_add_f32_dpp v124, v117, v117 row_half_mirror row_mask:0xf bank_mask:0xa
    v_cndmask_b32 v50, v120, v121, s[56:57]
    v_cndmask_b32 v51, v121, v120, s[56:57]
    s_nop 1
    v_add_f32_dpp v108, v51, v50 quad_perm:[2,3,0,1] row_mask:0xf bank_mask:0xf
    v_cndmask_b32 v50, v122, v123, s[56:57]
    v_cndmask_b32 v51, v123, v122, s[56:57]
    s_nop 1
    v_add_f32_dpp v109, v51, v50 quad_perm:[2,3,0,1] row_mask:0xf bank_mask:0xf
    v_add_f32_dpp v124, v124, v124 quad_perm:[2,3,0,1] row_mask:0xf bank_mask:0xf
    v_cndmask_b32 v50, v108, v109, s[58:59]
    v_cndmask_b32 v51, v109, v108, s[58:59]
    s_nop 1
    v_add_f32_dpp v120, v51, v50 quad_perm:[1,0,3,2] row_mask:0xf bank_mask:0xf
    v_add_f32_dpp v124, v124, v124 quad_perm:[1,0,3,2] row_mask:0xf bank_mask:0xf
    v_bfrev_b32 v39, v1
    v_lshrrev_b32 v39, 28, v39
    v_and_b32 v40, 3, v39
    v_mul_u32_u24 v41, 80, v53
    s_mul_i32 s54, s97, 320
    v_add_u32 v41, s54, v41
    v_lshl_add_u32 v39, v39, 2, v41
    v_lshl_add_u32 v40, v40, 2, v41
    ds_write_b32 v39, v120 offset:2240
    ds_write_b32 v40, v124 offset:2304
    s_waitcnt vmcnt(0)
    v_mul_u32_u24 v3, 1280, v53
    v_lshl_add_u32 v3, v54, 4, v3
    s_mul_i32 s61, s97, 40960
    s_add_u32 s60, s61, 40960
    s_and_b32 s92, s52, 3
    s_lshl_b32 s92, s92, 1
    s_mul_i32 s63, s92, 5120
    s_add_u32 s63, s63, s61
    buffer_load_dwordx4 v[96:99], v3, s[20:23], s63 offen offset:0
    buffer_load_dwordx4 v[104:107], v3, s[20:23], s63 offen offset:256
    buffer_load_dwordx4 v[112:115], v3, s[20:23], s63 offen offset:512
    s_waitcnt vmcnt(2)
    buffer_load_dwordx4 v[120:123], v3, s[20:23], s63 offen offset:768
    s_waitcnt vmcnt(2)
    buffer_load_dwordx4 v[128:131], v3, s[20:23], s63 offen offset:1024
    s_waitcnt vmcnt(2)
    s_add_u32 s63, s63, 5120
    s_cmp_ge_u32 s63, s60
    s_cselect_b32 s63, s61, s63
    buffer_load_dwordx4 v[100:103], v3, s[20:23], s63 offen offset:0
    s_waitcnt vmcnt(2)
    buffer_load_dwordx4 v[108:111], v3, s[20:23], s63 offen offset:256
    s_waitcnt vmcnt(2)
    buffer_load_dwordx4 v[116:119], v3, s[20:23], s63 offen offset:512
    s_waitcnt vmcnt(2)
    buffer_load_dwordx4 v[124:127], v3, s[20:23], s63 offen offset:768
    s_waitcnt vmcnt(2)
    buffer_load_dwordx4 v[132:135], v3, s[20:23], s63 offen offset:1024
    s_waitcnt vmcnt(2)
    s_add_u32 s63, s63, 5120
    s_cmp_ge_u32 s63, s60
    s_cselect_b32 s63, s61, s63
    buffer_load_dwordx4 v[136:139], v3, s[20:23], s63 offen offset:0
    s_waitcnt vmcnt(2)
    buffer_load_dwordx4 v[144:147], v3, s[20:23], s63 offen offset:256
    s_waitcnt vmcnt(2)
    buffer_load_dwordx4 v[152:155], v3, s[20:23], s63 offen offset:512
    s_waitcnt vmcnt(2)
    buffer_load_dwordx4 v[160:163], v3, s[20:23], s63 offen offset:768
    s_waitcnt vmcnt(2)
    buffer_load_dwordx4 v[168:171], v3, s[20:23], s63 offen offset:1024
    s_waitcnt vmcnt(2)
    s_add_u32 s63, s63, 5120
    s_cmp_ge_u32 s63, s60
    s_cselect_b32 s63, s61, s63
    buffer_load_dwordx4 v[140:143], v3, s[20:23], s63 offen offset:0
    s_waitcnt vmcnt(2)
    buffer_load_dwordx4 v[148:151], v3, s[20:23], s63 offen offset:256
    s_waitcnt vmcnt(2)
    buffer_load_dwordx4 v[156:159], v3, s[20:23], s63 offen offset:512
    s_waitcnt vmcnt(2)
    buffer_load_dwordx4 v[164:167], v3, s[20:23], s63 offen offset:768
    s_waitcnt vmcnt(2)
    buffer_load_dwordx4 v[172:175], v3, s[20:23], s63 offen offset:1024
    v_and_b32 v39, 3, v54
    v_mul_u32_u24 v66, 528, v39
    v_lshl_add_u32 v66, v53, 2, v66
    s_lshl_b32 s54, s97, 7
    v_add_u32 v66, s54, v66
    v_lshrrev_b32 v39, 2, v54
    v_lshlrev_b32 v39, 1, v39
    v_add_u32 v39, s92, v39
    v_add_u32 v40, 1, v39
    v_and_b32 v39, 7, v39
    v_and_b32 v40, 7, v40
    v_lshl_add_u32 v55, v40, 4, v66
    v_lshl_add_u32 v66, v39, 4, v66
    v_lshl_add_u32 v66, v53, 2, v66
    s_mul_i32 s54, s97, 2560
    v_add_u32 v67, s54, v52
    v_and_b32 v68, 7, v1
    v_lshrrev_b32 v40, 3, v1
    v_mul_u32_u24 v65, 10240, v68
    v_lshl_add_u32 v65, v40, 4, v65
    v_lshlrev_b32 v64, 3, v40
    v_mul_u32_u24 v41, 160, v68
    v_lshl_add_u32 v41, v40, 4, v41
    s_mul_i32 s62, s53, 40
    v_mov_b32 v51, 0
    buffer_load_dwordx2 v[70:71], v64, s[4:7], s62 offen
    buffer_load_ushort v69, v51, s[36:39], 0 offen
    s_waitcnt lgkmcnt(0)
    s_barrier
    ds_read_b128 v[72:75], v41 offset:2240
    ds_read_b128 v[76:79], v41 offset:2320
    s_waitcnt lgkmcnt(0)
    v_add_f32 v72, v72, v76
    v_add_f32 v73, v73, v77
    v_add_f32 v74, v74, v78
    v_add_f32 v75, v75, v79
    v_add_f32_dpp v72, v72, v72 quad_perm:[1,0,3,2] row_mask:0xf bank_mask:0xf
    v_add_f32_dpp v73, v73, v73 quad_perm:[1,0,3,2] row_mask:0xf bank_mask:0xf
    v_add_f32_dpp v74, v74, v74 quad_perm:[1,0,3,2] row_mask:0xf bank_mask:0xf
    v_add_f32_dpp v75, v75, v75 quad_perm:[1,0,3,2] row_mask:0xf bank_mask:0xf
    v_add_f32_dpp v72, v72, v72 quad_perm:[2,3,0,1] row_mask:0xf bank_mask:0xf
    v_add_f32_dpp v73, v73, v73 quad_perm:[2,3,0,1] row_mask:0xf bank_mask:0xf
    v_add_f32_dpp v74, v74, v74 quad_perm:[2,3,0,1] row_mask:0xf bank_mask:0xf
    v_add_f32_dpp v75, v75, v75 quad_perm:[2,3,0,1] row_mask:0xf bank_mask:0xf
    v_add_f32_dpp v72, v72, v72 row_half_mirror row_mask:0xf bank_mask:0xf
    v_add_f32_dpp v73, v73, v73 row_half_mirror row_mask:0xf bank_mask:0xf
    v_add_f32_dpp v74, v74, v74 row_half_mirror row_mask:0xf bank_mask:0xf
    v_add_f32_dpp v75, v75, v75 row_half_mirror row_mask:0xf bank_mask:0xf
    v_cvt_pk_bf16_f32 v50, v72, v73
    v_lshlrev_b32 v72, 16, v50
    v_and_b32 v73, 0xffff0000, v50
    v_cvt_pk_bf16_f32 v51, v74, v75
    v_lshlrev_b32 v74, 16, v51
    v_and_b32 v75, 0xffff0000, v51
    s_waitcnt vmcnt(0)
    v_lshlrev_b32 v69, 16, v69
    v_add_f32 v72, v72, v69
    v_add_f32 v73, v73, v69
    v_add_f32 v74, v74, v69
    v_add_f32 v75, v75, v69
    v_cvt_pk_bf16_f32 v50, v72, v73
    v_lshlrev_b32 v72, 16, v50
    v_and_b32 v73, 0xffff0000, v50
    v_cvt_pk_bf16_f32 v51, v74, v75
    v_lshlrev_b32 v74, 16, v51
    v_and_b32 v75, 0xffff0000, v51
    v_mul_f32 v76, s91, v72
    v_mul_f32 v77, s91, v73
    v_mul_f32 v78, s91, v74
    v_mul_f32 v79, s91, v75
    v_exp_f32 v76, -v76
    v_exp_f32 v77, -v77
    v_exp_f32 v78, -v78
    v_exp_f32 v79, -v79
    v_add_f32 v76, 1.0, v76
    v_add_f32 v77, 1.0, v77
    v_add_f32 v78, 1.0, v78
    v_add_f32 v79, 1.0, v79
    v_rcp_f32 v76, v76
    v_rcp_f32 v77, v77
    v_rcp_f32 v78, v78
    v_rcp_f32 v79, v79
    v_mul_f32 v72, v72, v76
    v_mul_f32 v73, v73, v77
    v_mul_f32 v74, v74, v78
    v_mul_f32 v75, v75, v79
    v_cvt_pk_bf16_f32 v50, v72, v73
    v_lshlrev_b32 v56, 16, v50
    v_and_b32 v57, 0xffff0000, v50
    v_cvt_pk_bf16_f32 v51, v74, v75
    v_lshlrev_b32 v58, 16, v51
    v_and_b32 v59, 0xffff0000, v51
    v_lshlrev_b32 v60, 16, v70
    v_and_b32 v61, 0xffff0000, v70
    v_lshlrev_b32 v62, 16, v71
    v_and_b32 v63, 0xffff0000, v71
    s_add_u32 s63, s63, 5120
    s_cmp_ge_u32 s63, s60
    s_cselect_b32 s63, s61, s63
    buffer_load_dwordx4 v[176:179], v3, s[20:23], s63 offen offset:0
    buffer_load_dwordx4 v[184:187], v3, s[20:23], s63 offen offset:256
    buffer_load_dwordx4 v[192:195], v3, s[20:23], s63 offen offset:512
    s_waitcnt vmcnt(2)
    buffer_load_dwordx4 v[200:203], v3, s[20:23], s63 offen offset:768
    s_waitcnt vmcnt(2)
    buffer_load_dwordx4 v[208:211], v3, s[20:23], s63 offen offset:1024
    s_waitcnt vmcnt(2)
    s_add_u32 s63, s63, 5120
    s_cmp_ge_u32 s63, s60
    s_cselect_b32 s63, s61, s63
    buffer_load_dwordx4 v[180:183], v3, s[20:23], s63 offen offset:0
    s_waitcnt vmcnt(2)
    buffer_load_dwordx4 v[188:191], v3, s[20:23], s63 offen offset:256
    s_waitcnt vmcnt(2)
    buffer_load_dwordx4 v[196:199], v3, s[20:23], s63 offen offset:512
    s_waitcnt vmcnt(2)
    buffer_load_dwordx4 v[204:207], v3, s[20:23], s63 offen offset:768
    s_waitcnt vmcnt(2)
    buffer_load_dwordx4 v[212:215], v3, s[20:23], s63 offen offset:1024
    s_waitcnt vmcnt(2)
    s_add_u32 s63, s63, 5120
    s_cmp_ge_u32 s63, s60
    s_cselect_b32 s63, s61, s63
    buffer_load_dwordx4 v[216:219], v3, s[20:23], s63 offen offset:0
    s_waitcnt vmcnt(2)
    buffer_load_dwordx4 v[224:227], v3, s[20:23], s63 offen offset:256
    s_waitcnt vmcnt(2)
    buffer_load_dwordx4 v[232:235], v3, s[20:23], s63 offen offset:512
    s_waitcnt vmcnt(2)
    buffer_load_dwordx4 v[240:243], v3, s[20:23], s63 offen offset:768
    s_waitcnt vmcnt(2)
    buffer_load_dwordx4 v[248:251], v3, s[20:23], s63 offen offset:1024
    s_waitcnt vmcnt(2)
    s_add_u32 s63, s63, 5120
    s_cmp_ge_u32 s63, s60
    s_cselect_b32 s63, s61, s63
    buffer_load_dwordx4 v[220:223], v3, s[20:23], s63 offen offset:0
    s_waitcnt vmcnt(2)
    buffer_load_dwordx4 v[228:231], v3, s[20:23], s63 offen offset:256
    s_waitcnt vmcnt(2)
    buffer_load_dwordx4 v[236:239], v3, s[20:23], s63 offen offset:512
    s_waitcnt vmcnt(2)
    buffer_load_dwordx4 v[244:247], v3, s[20:23], s63 offen offset:768
    s_waitcnt vmcnt(2)
    buffer_load_dwordx4 v[252:255], v3, s[20:23], s63 offen offset:1024
    s_waitcnt vmcnt(0)
    s_cmp_lg_u32 s3, 7
    s_cbranch_scc1 L_rdy_ok
    s_mov_b32 s96, 0
    s_lshl_b32 s55, s52, 5
    v_mov_b32 v51, 0
    s_nop 1
L_rdy:
    buffer_load_dword v50, v51, s[44:47], s55 offen sc1
    s_waitcnt vmcnt(0)
    v_readfirstlane_b32 s54, v50
    s_nop 0
    s_cmp_ge_u32 s54, 4
    s_cbranch_scc1 L_rdy_ok
    s_add_u32 s96, s96, 1
    s_cmp_ge_u32 s96, 0x100000
    s_cbranch_scc1 L_rdy_ok
    s_sleep 32
    s_branch L_rdy
L_rdy_ok:
    v_mov_b32 v24, -1
    v_mov_b32 v25, -1
    v_mov_b32 v26, -1
    v_mov_b32 v27, -1
    v_mov_b32 v28, -1
    v_mov_b32 v29, -1
    v_mov_b32 v30, -1
    v_mov_b32 v31, -1
    v_mov_b32 v32, -1
    v_mov_b32 v33, -1
    v_mov_b32 v34, -1
    v_mov_b32 v35, -1
    v_mov_b32 v36, -1
    v_mov_b32 v37, -1
    v_mov_b32 v38, -1
    v_mov_b32 v39, -1
    v_mov_b32 v72, 0
    v_mov_b32 v73, 0
    v_mov_b32 v74, 0
    v_mov_b32 v75, 0
    v_mov_b32 v76, 0
    v_mov_b32 v77, 0
    v_mov_b32 v78, 0
    v_mov_b32 v79, 0
    v_mov_b32 v80, 0
    v_mov_b32 v81, 0
    v_mov_b32 v82, 0
    v_mov_b32 v83, 0
    v_mov_b32 v84, 0
    v_mov_b32 v85, 0
    v_mov_b32 v86, 0
    v_mov_b32 v87, 0
    v_mov_b32 v88, 0
    v_mov_b32 v89, 0
    v_mov_b32 v90, 0
    v_mov_b32 v91, 0
    v_and_b32 v39, 3, v1
    v_mov_b32 v40, 0xffff
    v_mov_b32 v41, 0xffff0000
    v_cmp_eq_u32 vcc, 3, v39
    s_nop 1
    v_cndmask_b32 v40, v40, v41, vcc
    v_cndmask_b32 v39, v39, 0, vcc
    v_or_b32 v39, 12, v39
    v_mul_u32_u24 v94, 0x1111, v39
    v_lshl_or_b32 v94, v94, 16, v94
    v_lshrrev_b32 v41, 2, v54
    v_cmp_eq_u32 vcc, 0, v41
    s_nop 1
    v_cndmask_b32 v92, 0, v40, vcc
    v_cmp_eq_u32 vcc, 1, v41
    s_nop 1
    v_cndmask_b32 v93, 0, v40, vcc
    s_mul_i32 s80, s53, 80
    s_add_u32 s81, s80, 5120
    s_setprio 2
    s_barrier
    ds_read_b64 v[46:47], v66 offset:0
    s_waitcnt lgkmcnt(0)
    v_add_f32_dpp v46, v46, v46 quad_perm:[1,0,3,2] row_mask:0xf bank_mask:0xf
    v_add_f32_dpp v47, v47, v47 quad_perm:[1,0,3,2] row_mask:0xf bank_mask:0xf
    s_nop 0
    v_add_f32_dpp v46, v46, v46 quad_perm:[2,3,0,1] row_mask:0xf bank_mask:0xf
    v_add_f32_dpp v47, v47, v47 quad_perm:[2,3,0,1] row_mask:0xf bank_mask:0xf
    v_cvt_pk_bf16_f32 v46, v46, v46
    v_cvt_pk_bf16_f32 v47, v47, v47
    s_nop 0
    v_and_b32_dpp v16, v46, v92 row_newbcast:0 row_mask:0xf bank_mask:0xf
    v_and_b32_dpp v17, v46, v93 row_newbcast:0 row_mask:0xf bank_mask:0xf
    v_and_b32_dpp v18, v47, v92 row_newbcast:0 row_mask:0xf bank_mask:0xf
    v_and_b32_dpp v19, v47, v93 row_newbcast:0 row_mask:0xf bank_mask:0xf
    s_nop 1
    v_smfmac_f32_16x16x64_bf16 v[72:75], v[16:19], v[96:103], v94
    v_and_b32_dpp v20, v46, v92 row_newbcast:4 row_mask:0xf bank_mask:0xf
    v_and_b32_dpp v21, v46, v93 row_newbcast:4 row_mask:0xf bank_mask:0xf
    v_and_b32_dpp v22, v47, v92 row_newbcast:4 row_mask:0xf bank_mask:0xf
    v_and_b32_dpp v23, v47, v93 row_newbcast:4 row_mask:0xf bank_mask:0xf
    v_smfmac_f32_16x16x64_bf16 v[76:79], v[16:19], v[104:111], v94
    v_smfmac_f32_16x16x64_bf16 v[80:83], v[16:19], v[112:119], v94
    v_smfmac_f32_16x16x64_bf16 v[84:87], v[16:19], v[120:127], v94
    v_smfmac_f32_16x16x64_bf16 v[88:91], v[16:19], v[128:135], v94
    v_smfmac_f32_16x16x64_bf16 v[72:75], v[20:23], v[136:143], v94
    v_and_b32_dpp v16, v46, v92 row_newbcast:8 row_mask:0xf bank_mask:0xf
    v_and_b32_dpp v17, v46, v93 row_newbcast:8 row_mask:0xf bank_mask:0xf
    v_and_b32_dpp v18, v47, v92 row_newbcast:8 row_mask:0xf bank_mask:0xf
    v_and_b32_dpp v19, v47, v93 row_newbcast:8 row_mask:0xf bank_mask:0xf
    v_smfmac_f32_16x16x64_bf16 v[76:79], v[20:23], v[144:151], v94
    v_smfmac_f32_16x16x64_bf16 v[80:83], v[20:23], v[152:159], v94
    v_smfmac_f32_16x16x64_bf16 v[84:87], v[20:23], v[160:167], v94
    v_smfmac_f32_16x16x64_bf16 v[88:91], v[20:23], v[168:175], v94
    v_smfmac_f32_16x16x64_bf16 v[72:75], v[16:19], v[176:183], v94
    v_and_b32_dpp v20, v46, v92 row_newbcast:12 row_mask:0xf bank_mask:0xf
    v_and_b32_dpp v21, v46, v93 row_newbcast:12 row_mask:0xf bank_mask:0xf
    v_and_b32_dpp v22, v47, v92 row_newbcast:12 row_mask:0xf bank_mask:0xf
    v_and_b32_dpp v23, v47, v93 row_newbcast:12 row_mask:0xf bank_mask:0xf
    v_smfmac_f32_16x16x64_bf16 v[76:79], v[16:19], v[184:191], v94
    v_smfmac_f32_16x16x64_bf16 v[80:83], v[16:19], v[192:199], v94
    v_smfmac_f32_16x16x64_bf16 v[84:87], v[16:19], v[200:207], v94
    v_smfmac_f32_16x16x64_bf16 v[88:91], v[16:19], v[208:215], v94
    v_smfmac_f32_16x16x64_bf16 v[72:75], v[20:23], v[216:223], v94
    v_smfmac_f32_16x16x64_bf16 v[76:79], v[20:23], v[224:231], v94
    v_smfmac_f32_16x16x64_bf16 v[80:83], v[20:23], v[232:239], v94
    v_smfmac_f32_16x16x64_bf16 v[84:87], v[20:23], v[240:247], v94
    v_smfmac_f32_16x16x64_bf16 v[88:91], v[20:23], v[248:255], v94
    s_mov_b32 exec_hi, 0
    s_nop 6
    ds_write_b128 v67, v[72:75] offset:3584
    ds_write_b128 v67, v[76:79] offset:4096
    ds_write_b128 v67, v[80:83] offset:4608
    ds_write_b128 v67, v[84:87] offset:5120
    ds_write_b128 v67, v[88:91] offset:5632
    s_mov_b32 exec_hi, -1
    s_cmp_lg_u32 s3, 7
    s_waitcnt lgkmcnt(0)
    s_barrier
    s_cbranch_scc1 L_hend
    s_mov_b32 exec_hi, 0xff
    s_mov_b32 s96, 0
    s_mov_b64 s[64:65], exec
    s_mov_b64 s[66:67], exec
    s_mov_b64 s[68:69], exec
    s_mov_b64 s[70:71], exec
    s_mov_b64 s[72:73], exec
L_poll:
    s_or_b64 exec, s[64:65], 1
    buffer_load_dwordx4 v[24:27], v65, s[48:51], s80 offen offset:0 sc1
    s_or_b64 exec, s[66:67], 1
    buffer_load_dwordx4 v[28:31], v65, s[48:51], s80 offen offset:2560 sc1
    s_or_b64 exec, s[68:69], 1
    buffer_load_dwordx4 v[32:35], v65, s[48:51], s81 offen offset:0 sc1
    s_or_b64 exec, s[70:71], 1
    buffer_load_dwordx4 v[36:39], v65, s[48:51], s81 offen offset:2560 sc1
    s_mov_b64 exec, s[72:73]
    s_waitcnt vmcnt(4)
    v_max3_u32 v16, v24, v25, v26
    v_max3_u32 v17, v28, v29, v30
    v_max3_u32 v18, v32, v33, v34
    v_max3_u32 v19, v36, v37, v38
    v_max_u32 v16, v16, v27
    v_max_u32 v17, v17, v31
    v_max_u32 v18, v18, v35
    v_max_u32 v19, v19, v39
    v_cmp_eq_u32 s[64:65], -1, v16
    v_cmp_eq_u32 s[66:67], -1, v17
    v_cmp_eq_u32 s[68:69], -1, v18
    v_cmp_eq_u32 s[70:71], -1, v19
    s_or_b64 s[74:75], s[64:65], s[66:67]
    s_or_b64 s[76:77], s[68:69], s[70:71]
    s_or_b64 s[74:75], s[74:75], s[76:77]
    s_cbranch_scc0 L_got
    s_add_u32 s96, s96, 1
    s_cmp_ge_u32 s96, 0x800000
    s_cbranch_scc1 L_got
    s_branch L_poll
L_got:
    v_add_f32 v96, v24, v28
    v_add_f32 v97, v25, v29
    v_add_f32 v98, v26, v30
    v_add_f32 v99, v27, v31
    v_add_f32 v104, v32, v36
    v_add_f32 v105, v33, v37
    v_add_f32 v106, v34, v38
    v_add_f32 v107, v35, v39
    v_add_f32 v96, v96, v104
    v_add_f32 v97, v97, v105
    v_add_f32 v98, v98, v106
    v_add_f32 v99, v99, v107
    v_add_f32_dpp v96, v96, v96 quad_perm:[1,0,3,2] row_mask:0xf bank_mask:0xf
    v_add_f32_dpp v97, v97, v97 quad_perm:[1,0,3,2] row_mask:0xf bank_mask:0xf
    v_add_f32_dpp v98, v98, v98 quad_perm:[1,0,3,2] row_mask:0xf bank_mask:0xf
    v_add_f32_dpp v99, v99, v99 quad_perm:[1,0,3,2] row_mask:0xf bank_mask:0xf
    v_add_f32_dpp v96, v96, v96 quad_perm:[2,3,0,1] row_mask:0xf bank_mask:0xf
    v_add_f32_dpp v97, v97, v97 quad_perm:[2,3,0,1] row_mask:0xf bank_mask:0xf
    v_add_f32_dpp v98, v98, v98 quad_perm:[2,3,0,1] row_mask:0xf bank_mask:0xf
    v_add_f32_dpp v99, v99, v99 quad_perm:[2,3,0,1] row_mask:0xf bank_mask:0xf
    v_add_f32_dpp v96, v96, v96 row_half_mirror row_mask:0xf bank_mask:0xf
    v_add_f32_dpp v97, v97, v97 row_half_mirror row_mask:0xf bank_mask:0xf
    v_add_f32_dpp v98, v98, v98 row_half_mirror row_mask:0xf bank_mask:0xf
    v_add_f32_dpp v99, v99, v99 row_half_mirror row_mask:0xf bank_mask:0xf
    v_cvt_pk_bf16_f32 v50, v96, v97
    v_lshlrev_b32 v96, 16, v50
    v_and_b32 v97, 0xffff0000, v50
    v_cvt_pk_bf16_f32 v51, v98, v99
    v_lshlrev_b32 v98, 16, v51
    v_and_b32 v99, 0xffff0000, v51
    v_mul_f32 v96, v96, v56
    v_mul_f32 v97, v97, v57
    v_mul_f32 v98, v98, v58
    v_mul_f32 v99, v99, v59
    v_cvt_pk_bf16_f32 v50, v96, v97
    v_lshlrev_b32 v96, 16, v50
    v_and_b32 v97, 0xffff0000, v50
    v_cvt_pk_bf16_f32 v51, v98, v99
    v_lshlrev_b32 v98, 16, v51
    v_and_b32 v99, 0xffff0000, v51
    v_add_f32 v96, v96, v60
    v_add_f32 v97, v97, v61
    v_add_f32 v98, v98, v62
    v_add_f32 v99, v99, v63
    v_cvt_pk_bf16_f32 v96, v96, v97
    v_cvt_pk_bf16_f32 v97, v98, v99
    v_cmp_eq_u32 vcc, 0, v68
    s_nop 0
    s_and_b64 exec, exec, vcc
    buffer_store_dwordx2 v[96:97], v64, s[40:43], s62 offen
    s_nop 1
L_hend:
L_end:
    s_endpgm
L_smain:
    s_add_u32 s12, s68, s61
    s_addc_u32 s13, s69, 0
    s_add_u32 s48, s88, s94
    s_addc_u32 s49, s89, 0
    s_mov_b32 s91, 0x3fb8aa3b
    s_mov_b32 s92, 0x3db504f3
    v_lshrrev_b32 v56, 4, v1
    v_and_b32 v57, 15, v1
    s_mov_b32 s56, 0xcccccccc
    s_mov_b32 s57, 0xcccccccc
    s_mov_b32 s58, 0xaaaaaaaa
    s_mov_b32 s59, 0xaaaaaaaa
    v_mov_b32 v50, 0xffff
    v_mov_b32 v51, 0xffff0000
    v_cndmask_b32 v50, v50, v51, s[58:59]
    v_lshrrev_b32 v51, 1, v57
    v_cmp_eq_u32 vcc, 0, v51
    s_nop 1
    v_cndmask_b32 v4, 0, v50, vcc
    v_cmp_eq_u32 vcc, 1, v51
    s_nop 1
    v_cndmask_b32 v5, 0, v50, vcc
    v_cmp_eq_u32 vcc, 2, v51
    s_nop 1
    v_cndmask_b32 v6, 0, v50, vcc
    v_cmp_eq_u32 vcc, 3, v51
    s_nop 1
    v_cndmask_b32 v7, 0, v50, vcc
    v_lshlrev_b32 v52, 5, v57
    v_lshl_add_u32 v52, v56, 4, v52
    s_mul_i32 s54, s3, 528
    v_add_u32 v52, s54, v52
    s_lshl_b32 s54, s3, 6
    v_add_u32 v50, s54, v1
    v_lshlrev_b32 v54, 4, v50
    v_mov_b32 v55, v54
    s_mul_i32 s94, s53, 2560
    v_lshlrev_b32 v3, 5, v57
    s_mul_i32 s62, s3, 36864
    s_add_u32 s62, s62, 13824
    v_lshlrev_b32 v60, 4, v1
    v_add_u32 v60, s62, v60
    s_waitcnt vmcnt(5)
    buffer_load_dwordx4 v[88:91], v2, s[8:11], s60 offen offset:2048 nt
    s_waitcnt vmcnt(5)
    buffer_load_dwordx4 v[92:95], v2, s[8:11], s60 offen offset:3072 nt
    s_waitcnt vmcnt(5)
    s_xor_b32 s60, s63, 32768
    buffer_load_dwordx4 v[96:99], v2, s[8:11], s60 offen offset:0 nt
    s_waitcnt vmcnt(5)
    buffer_load_dwordx4 v[100:103], v2, s[8:11], s60 offen offset:1024 nt
    s_waitcnt vmcnt(5)
    buffer_load_dwordx4 v[104:107], v2, s[8:11], s60 offen offset:2048 nt
    s_waitcnt vmcnt(5)
    buffer_load_dwordx4 v[108:111], v2, s[8:11], s60 offen offset:3072 nt
    s_waitcnt vmcnt(5)
    s_xor_b32 s60, s63, 49152
    buffer_load_dwordx4 v[112:115], v2, s[8:11], s60 offen offset:0 nt
    s_waitcnt vmcnt(5)
    buffer_load_dwordx4 v[116:119], v2, s[8:11], s60 offen offset:1024 nt
    s_waitcnt vmcnt(5)
    buffer_load_dwordx4 v[120:123], v2, s[8:11], s60 offen offset:2048 nt
    s_waitcnt vmcnt(5)
    buffer_load_dwordx4 v[124:127], v2, s[8:11], s60 offen offset:3072 nt
    s_waitcnt vmcnt(5)
    s_xor_b32 s60, s63, 65536
    buffer_load_dwordx4 v[128:131], v2, s[8:11], s60 offen offset:0 nt
    s_waitcnt vmcnt(5)
    buffer_load_dwordx4 v[132:135], v2, s[8:11], s60 offen offset:1024 nt
    s_waitcnt vmcnt(5)
    buffer_load_dwordx4 v[136:139], v2, s[8:11], s60 offen offset:2048 nt
    s_waitcnt vmcnt(5)
    buffer_load_dwordx4 v[140:143], v2, s[8:11], s60 offen offset:3072 nt
    s_waitcnt vmcnt(5)
    s_xor_b32 s60, s63, 81920
    buffer_load_dwordx4 v[144:147], v2, s[8:11], s60 offen offset:0 nt
    s_waitcnt vmcnt(5)
    buffer_load_dwordx4 v[148:151], v2, s[8:11], s60 offen offset:1024 nt
    s_waitcnt vmcnt(5)
    buffer_load_dwordx4 v[152:155], v2, s[8:11], s60 offen offset:2048 nt
    s_waitcnt vmcnt(5)
    buffer_load_dwordx4 v[156:159], v2, s[8:11], s60 offen offset:3072 nt
    s_waitcnt vmcnt(5)
    s_xor_b32 s60, s63, 98304
    buffer_load_dwordx4 v[160:163], v2, s[8:11], s60 offen offset:0 nt
    s_waitcnt vmcnt(5)
    buffer_load_dwordx4 v[164:167], v2, s[8:11], s60 offen offset:1024 nt
    s_waitcnt vmcnt(5)
    buffer_load_dwordx4 v[168:171], v2, s[8:11], s60 offen offset:2048 nt
    s_waitcnt vmcnt(5)
    buffer_load_dwordx4 v[172:175], v2, s[8:11], s60 offen offset:3072 nt
    s_waitcnt vmcnt(5)
    s_xor_b32 s60, s63, 114688
    buffer_load_dwordx4 v[176:179], v2, s[8:11], s60 offen offset:0 nt
    s_waitcnt vmcnt(5)
    buffer_load_dwordx4 v[180:183], v2, s[8:11], s60 offen offset:1024 nt
    s_waitcnt vmcnt(5)
    buffer_load_dwordx4 v[184:187], v2, s[8:11], s60 offen offset:2048 nt
    s_waitcnt vmcnt(5)
    buffer_load_dwordx4 v[188:191], v2, s[8:11], s60 offen offset:3072 nt
    s_waitcnt vmcnt(5)
    s_xor_b32 s60, s63, 131072
    buffer_load_dwordx4 v[192:195], v2, s[8:11], s60 offen offset:0 nt
    s_waitcnt vmcnt(5)
    buffer_load_dwordx4 v[196:199], v2, s[8:11], s60 offen offset:1024 nt
    s_waitcnt vmcnt(5)
    buffer_load_dwordx4 v[200:203], v2, s[8:11], s60 offen offset:2048 nt
    s_waitcnt vmcnt(5)
    buffer_load_dwordx4 v[204:207], v2, s[8:11], s60 offen offset:3072 nt
    s_waitcnt vmcnt(5)
    s_xor_b32 s60, s63, 147456
    buffer_load_dwordx4 v[208:211], v2, s[8:11], s60 offen offset:0 nt
    s_waitcnt vmcnt(5)
    buffer_load_dwordx4 v[212:215], v2, s[8:11], s60 offen offset:1024 nt
    s_waitcnt vmcnt(5)
    buffer_load_dwordx4 v[216:219], v2, s[8:11], s60 offen offset:2048 nt
    s_waitcnt vmcnt(5)
    buffer_load_dwordx4 v[220:223], v2, s[8:11], s60 offen offset:3072 nt
    s_waitcnt vmcnt(5)
    s_xor_b32 s60, s63, 163840
    buffer_load_dwordx4 v[224:227], v2, s[8:11], s60 offen offset:0 nt
    s_waitcnt vmcnt(5)
    buffer_load_dwordx4 v[228:231], v2, s[8:11], s60 offen offset:1024 nt
    s_waitcnt vmcnt(5)
    buffer_load_dwordx4 v[232:235], v2, s[8:11], s60 offen offset:2048 nt
    s_waitcnt vmcnt(5)
    buffer_load_dwordx4 v[236:239], v2, s[8:11], s60 offen offset:3072 nt
    s_waitcnt vmcnt(5)
    s_xor_b32 s60, s63, 180224
    buffer_load_dwordx4 v[240:243], v2, s[8:11], s60 offen offset:0 nt
    s_waitcnt vmcnt(5)
    buffer_load_dwordx4 v[244:247], v2, s[8:11], s60 offen offset:1024 nt
    s_waitcnt vmcnt(5)
    buffer_load_dwordx4 v[248:251], v2, s[8:11], s60 offen offset:2048 nt
    s_waitcnt vmcnt(5)
    buffer_load_dwordx4 v[252:255], v2, s[8:11], s60 offen offset:3072 nt
    s_waitcnt vmcnt(5)
    s_add_u32 m0, s62, 0
    s_xor_b32 s60, s63, 196608
    buffer_load_dwordx4 v2, s[8:11], s60 offen offset:0 nt lds
    s_waitcnt vmcnt(5)
    buffer_load_dwordx4 v2, s[8:11], s60 offen offset:1024 nt lds
    s_waitcnt vmcnt(5)
    buffer_load_dwordx4 v2, s[8:11], s60 offen offset:2048 nt lds
    s_waitcnt vmcnt(5)
    buffer_load_dwordx4 v2, s[8:11], s60 offen offset:3072 nt lds
    s_waitcnt vmcnt(5)
    s_add_u32 m0, s62, 4096
    s_xor_b32 s60, s63, 212992
    buffer_load_dwordx4 v2, s[8:11], s60 offen offset:0 nt lds
    s_waitcnt vmcnt(5)
    buffer_load_dwordx4 v2, s[8:11], s60 offen offset:1024 nt lds
    s_waitcnt vmcnt(5)
    buffer_load_dwordx4 v2, s[8:11], s60 offen offset:2048 nt lds
    s_waitcnt vmcnt(5)
    buffer_load_dwordx4 v2, s[8:11], s60 offen offset:3072 nt lds
    s_waitcnt vmcnt(5)
    s_add_u32 m0, s62, 8192
    s_xor_b32 s60, s63, 229376
    buffer_load_dwordx4 v2, s[8:11], s60 offen offset:0 nt lds
    s_waitcnt vmcnt(5)
    buffer_load_dwordx4 v2, s[8:11], s60 offen offset:1024 nt lds
    s_waitcnt vmcnt(5)
    buffer_load_dwordx4 v2, s[8:11], s60 offen offset:2048 nt lds
    s_waitcnt vmcnt(5)
    buffer_load_dwordx4 v2, s[8:11], s60 offen offset:3072 nt lds
    s_waitcnt vmcnt(5)
    s_add_u32 m0, s62, 12288
    s_xor_b32 s60, s63, 245760
    buffer_load_dwordx4 v2, s[8:11], s60 offen offset:0 nt lds
    s_waitcnt vmcnt(5)
    buffer_load_dwordx4 v2, s[8:11], s60 offen offset:1024 nt lds
    s_waitcnt vmcnt(5)
    buffer_load_dwordx4 v2, s[8:11], s60 offen offset:2048 nt lds
    s_waitcnt vmcnt(5)
    buffer_load_dwordx4 v2, s[8:11], s60 offen offset:3072 nt lds
    s_waitcnt vmcnt(5)
    s_add_u32 m0, s62, 16384
    s_xor_b32 s60, s63, 262144
    buffer_load_dwordx4 v2, s[8:11], s60 offen offset:0 nt lds
    s_waitcnt vmcnt(5)
    buffer_load_dwordx4 v2, s[8:11], s60 offen offset:1024 nt lds
    s_waitcnt vmcnt(5)
    buffer_load_dwordx4 v2, s[8:11], s60 offen offset:2048 nt lds
    s_waitcnt vmcnt(5)
    buffer_load_dwordx4 v2, s[8:11], s60 offen offset:3072 nt lds
    s_waitcnt vmcnt(5)
    s_add_u32 m0, s62, 20480
    s_xor_b32 s60, s63, 278528
    buffer_load_dwordx4 v2, s[8:11], s60 offen offset:0 nt lds
    s_waitcnt vmcnt(5)
    buffer_load_dwordx4 v2, s[8:11], s60 offen offset:1024 nt lds
    s_waitcnt vmcnt(5)
    buffer_load_dwordx4 v2, s[8:11], s60 offen offset:2048 nt lds
    s_waitcnt vmcnt(5)
    buffer_load_dwordx4 v2, s[8:11], s60 offen offset:3072 nt lds
    s_waitcnt vmcnt(5)
    s_add_u32 m0, s62, 24576
    s_xor_b32 s60, s63, 294912
    buffer_load_dwordx4 v2, s[8:11], s60 offen offset:0 nt lds
    s_waitcnt vmcnt(5)
    buffer_load_dwordx4 v2, s[8:11], s60 offen offset:1024 nt lds
    s_waitcnt vmcnt(5)
    buffer_load_dwordx4 v2, s[8:11], s60 offen offset:2048 nt lds
    s_waitcnt vmcnt(5)
    buffer_load_dwordx4 v2, s[8:11], s60 offen offset:3072 nt lds
    s_waitcnt vmcnt(5)
    s_add_u32 m0, s62, 28672
    s_xor_b32 s60, s63, 311296
    buffer_load_dwordx4 v2, s[8:11], s60 offen offset:0 nt lds
    s_waitcnt vmcnt(5)
    buffer_load_dwordx4 v2, s[8:11], s60 offen offset:1024 nt lds
    s_waitcnt vmcnt(5)
    buffer_load_dwordx4 v2, s[8:11], s60 offen offset:2048 nt lds
    s_waitcnt vmcnt(5)
    buffer_load_dwordx4 v2, s[8:11], s60 offen offset:3072 nt lds
    s_waitcnt vmcnt(5)
    s_add_u32 m0, s62, 32768
    s_xor_b32 s60, s63, 327680
    buffer_load_dwordx4 v2, s[8:11], s60 offen offset:0 nt lds
    s_waitcnt vmcnt(5)
    buffer_load_dwordx4 v2, s[8:11], s60 offen offset:1024 nt lds
    s_waitcnt vmcnt(5)
    buffer_load_dwordx4 v2, s[8:11], s60 offen offset:2048 nt lds
    s_waitcnt vmcnt(5)
    buffer_load_dwordx4 v2, s[8:11], s60 offen offset:3072 nt lds
    s_barrier
    ds_read_b128 v[24:27], v3 offset:0
    ds_read_b128 v[28:31], v3 offset:16
    ds_read_b128 v[32:35], v3 offset:528
    ds_read_b128 v[36:39], v3 offset:544
    ds_read_b128 v[12:15], v3 offset:1056
    ds_read_b128 v[16:19], v3 offset:1072
    ds_read_b128 v[20:23], v3 offset:1584
    ds_read_b128 v[40:43], v3 offset:1600
    s_waitcnt lgkmcnt(4)
    v_add_f32 v24, v24, v32
    v_add_f32 v28, v28, v36
    v_add_f32 v25, v25, v33
    v_add_f32 v29, v29, v37
    v_add_f32 v26, v26, v34
    v_add_f32 v30, v30, v38
    v_add_f32 v27, v27, v35
    v_add_f32 v31, v31, v39
    s_waitcnt lgkmcnt(0)
    v_add_f32 v12, v12, v20
    v_add_f32 v16, v16, v40
    v_add_f32 v13, v13, v21
    v_add_f32 v17, v17, v41
    v_add_f32 v14, v14, v22
    v_add_f32 v18, v18, v42
    v_add_f32 v15, v15, v23
    v_add_f32 v19, v19, v43
    v_add_f32 v24, v24, v12
    v_add_f32 v28, v28, v16
    v_add_f32 v25, v25, v13
    v_add_f32 v29, v29, v17
    v_add_f32 v26, v26, v14
    v_add_f32 v30, v30, v18
    v_add_f32 v27, v27, v15
    v_add_f32 v31, v31, v19
    v_cvt_pk_bf16_f32 v8, v24, v25
    v_cvt_pk_bf16_f32 v9, v26, v27
    v_cvt_pk_bf16_f32 v10, v28, v29
    v_cvt_pk_bf16_f32 v11, v30, v31
    v_dot2_f32_bf16 v40, v64, v8, 0
    v_dot2_f32_bf16 v40, v65, v9, v40
    v_dot2_f32_bf16 v40, v66, v10, v40
    v_dot2_f32_bf16 v40, v67, v11, v40
    s_waitcnt vmcnt(5)
    s_xor_b32 s60, s63, 344064
    buffer_load_dwordx4 v[64:67], v2, s[8:11], s60 offen offset:0 nt
    v_dot2_f32_bf16 v41, v68, v8, 0
    v_dot2_f32_bf16 v41, v69, v9, v41
    v_dot2_f32_bf16 v41, v70, v10, v41
    v_dot2_f32_bf16 v41, v71, v11, v41
    s_waitcnt vmcnt(5)
    buffer_load_dwordx4 v[68:71], v2, s[8:11], s60 offen offset:1024 nt
    v_dot2_f32_bf16 v42, v72, v8, 0
    v_dot2_f32_bf16 v42, v73, v9, v42
    v_dot2_f32_bf16 v42, v74, v10, v42
    v_dot2_f32_bf16 v42, v75, v11, v42
    s_waitcnt vmcnt(5)
    buffer_load_dwordx4 v[72:75], v2, s[8:11], s60 offen offset:2048 nt
    v_add_f32_dpp v44, v40, v40 row_mirror row_mask:0xf bank_mask:0x3
    v_add_f32_dpp v44, v41, v41 row_mirror row_mask:0xf bank_mask:0xc
    v_dot2_f32_bf16 v43, v76, v8, 0
    v_dot2_f32_bf16 v43, v77, v9, v43
    v_dot2_f32_bf16 v43, v78, v10, v43
    v_dot2_f32_bf16 v43, v79, v11, v43
    s_waitcnt vmcnt(5)
    buffer_load_dwordx4 v[76:79], v2, s[8:11], s60 offen offset:3072 nt
    v_dot2_f32_bf16 v40, v80, v8, 0
    v_dot2_f32_bf16 v40, v81, v9, v40
    v_dot2_f32_bf16 v40, v82, v10, v40
    v_dot2_f32_bf16 v40, v83, v11, v40
    s_waitcnt vmcnt(5)
    s_xor_b32 s60, s63, 360448
    buffer_load_dwordx4 v[80:83], v2, s[8:11], s60 offen offset:0 nt
    v_add_f32_dpp v45, v42, v42 row_mirror row_mask:0xf bank_mask:0x3
    v_add_f32_dpp v45, v43, v43 row_mirror row_mask:0xf bank_mask:0xc
    v_add_f32_dpp v46, v44, v44 row_half_mirror row_mask:0xf bank_mask:0x5
    s_nop 0
    v_add_f32_dpp v46, v45, v45 row_half_mirror row_mask:0xf bank_mask:0xa
    v_dot2_f32_bf16 v41, v84, v8, 0
    v_dot2_f32_bf16 v41, v85, v9, v41
    v_dot2_f32_bf16 v41, v86, v10, v41
    v_dot2_f32_bf16 v41, v87, v11, v41
    s_waitcnt vmcnt(5)
    buffer_load_dwordx4 v[84:87], v2, s[8:11], s60 offen offset:1024 nt
    v_dot2_f32_bf16 v42, v88, v8, 0
    v_dot2_f32_bf16 v42, v89, v9, v42
    v_dot2_f32_bf16 v42, v90, v10, v42
    v_dot2_f32_bf16 v42, v91, v11, v42
    v_add_f32_dpp v44, v40, v40 row_mirror row_mask:0xf bank_mask:0x3
    v_add_f32_dpp v44, v41, v41 row_mirror row_mask:0xf bank_mask:0xc
    v_dot2_f32_bf16 v43, v92, v8, 0
    v_dot2_f32_bf16 v43, v93, v9, v43
    v_dot2_f32_bf16 v43, v94, v10, v43
    v_dot2_f32_bf16 v43, v95, v11, v43
    v_dot2_f32_bf16 v40, v96, v8, 0
    v_dot2_f32_bf16 v40, v97, v9, v40
    v_dot2_f32_bf16 v40, v98, v10, v40
    v_dot2_f32_bf16 v40, v99, v11, v40
    s_waitcnt vmcnt(5)
    buffer_load_dwordx4 v[88:91], v2, s[8:11], s60 offen offset:2048 nt
    v_add_f32_dpp v45, v42, v42 row_mirror row_mask:0xf bank_mask:0x3
    v_add_f32_dpp v45, v43, v43 row_mirror row_mask:0xf bank_mask:0xc
    v_add_f32_dpp v47, v44, v44 row_half_mirror row_mask:0xf bank_mask:0x5
    s_nop 0
    v_add_f32_dpp v47, v45, v45 row_half_mirror row_mask:0xf bank_mask:0xa
    v_cndmask_b32 v50, v46, v47, s[56:57]
    v_cndmask_b32 v51, v47, v46, s[56:57]
    s_nop 1
    v_add_f32_dpp v48, v51, v50 quad_perm:[2,3,0,1] row_mask:0xf bank_mask:0xf
    v_dot2_f32_bf16 v41, v100, v8, 0
    v_dot2_f32_bf16 v41, v101, v9, v41
    v_dot2_f32_bf16 v41, v102, v10, v41
    v_dot2_f32_bf16 v41, v103, v11, v41
    v_dot2_f32_bf16 v42, v104, v8, 0
    v_dot2_f32_bf16 v42, v105, v9, v42
    v_dot2_f32_bf16 v42, v106, v10, v42
    v_dot2_f32_bf16 v42, v107, v11, v42
    v_add_f32_dpp v44, v40, v40 row_mirror row_mask:0xf bank_mask:0x3
    v_add_f32_dpp v44, v41, v41 row_mirror row_mask:0xf bank_mask:0xc
    v_dot2_f32_bf16 v43, v108, v8, 0
    v_dot2_f32_bf16 v43, v109, v9, v43
    v_dot2_f32_bf16 v43, v110, v10, v43
    v_dot2_f32_bf16 v43, v111, v11, v43
    v_dot2_f32_bf16 v40, v112, v8, 0
    v_dot2_f32_bf16 v40, v113, v9, v40
    v_dot2_f32_bf16 v40, v114, v10, v40
    v_dot2_f32_bf16 v40, v115, v11, v40
    s_waitcnt vmcnt(5)
    buffer_load_dwordx4 v[92:95], v2, s[8:11], s60 offen offset:3072 nt
    v_add_f32_dpp v45, v42, v42 row_mirror row_mask:0xf bank_mask:0x3
    v_add_f32_dpp v45, v43, v43 row_mirror row_mask:0xf bank_mask:0xc
    v_add_f32_dpp v46, v44, v44 row_half_mirror row_mask:0xf bank_mask:0x5
    s_nop 0
    v_add_f32_dpp v46, v45, v45 row_half_mirror row_mask:0xf bank_mask:0xa
    v_dot2_f32_bf16 v41, v116, v8, 0
    v_dot2_f32_bf16 v41, v117, v9, v41
    v_dot2_f32_bf16 v41, v118, v10, v41
    v_dot2_f32_bf16 v41, v119, v11, v41
    v_dot2_f32_bf16 v42, v120, v8, 0
    v_dot2_f32_bf16 v42, v121, v9, v42
    v_dot2_f32_bf16 v42, v122, v10, v42
    v_dot2_f32_bf16 v42, v123, v11, v42
    v_add_f32_dpp v44, v40, v40 row_mirror row_mask:0xf bank_mask:0x3
    v_add_f32_dpp v44, v41, v41 row_mirror row_mask:0xf bank_mask:0xc
    v_dot2_f32_bf16 v43, v124, v8, 0
    v_dot2_f32_bf16 v43, v125, v9, v43
    v_dot2_f32_bf16 v43, v126, v10, v43
    v_dot2_f32_bf16 v43, v127, v11, v43
    v_dot2_f32_bf16 v40, v128, v8, 0
    v_dot2_f32_bf16 v40, v129, v9, v40
    v_dot2_f32_bf16 v40, v130, v10, v40
    v_dot2_f32_bf16 v40, v131, v11, v40
    s_waitcnt vmcnt(5)
    s_xor_b32 s60, s63, 376832
    buffer_load_dwordx4 v[96:99], v2, s[8:11], s60 offen offset:0 nt
    v_add_f32_dpp v45, v42, v42 row_mirror row_mask:0xf bank_mask:0x3
    v_add_f32_dpp v45, v43, v43 row_mirror row_mask:0xf bank_mask:0xc
    v_add_f32_dpp v47, v44, v44 row_half_mirror row_mask:0xf bank_mask:0x5
    s_nop 0
    v_add_f32_dpp v47, v45, v45 row_half_mirror row_mask:0xf bank_mask:0xa
    v_cndmask_b32 v50, v46, v47, s[56:57]
    v_cndmask_b32 v51, v47, v46, s[56:57]
    s_nop 1
    v_add_f32_dpp v49, v51, v50 quad_perm:[2,3,0,1] row_mask:0xf bank_mask:0xf
    v_cndmask_b32 v50, v48, v49, s[58:59]
    v_cndmask_b32 v51, v49, v48, s[58:59]
    s_nop 1
    v_add_f32_dpp v24, v51, v50 quad_perm:[1,0,3,2] row_mask:0xf bank_mask:0xf
    v_cvt_pk_bf16_f32 v24, v24, v24
    v_and_b32 v24, 0xffff0000, v24
    v_mul_f32 v24, s92, v24
    v_cvt_pk_bf16_f32 v24, v24, v24
    v_and_b32 v24, 0xffff0000, v24
    v_mov_b32 v58, v24
    v_dot2_f32_bf16 v41, v132, v8, 0
    v_dot2_f32_bf16 v41, v133, v9, v41
    v_dot2_f32_bf16 v41, v134, v10, v41
    v_dot2_f32_bf16 v41, v135, v11, v41
    v_dot2_f32_bf16 v42, v136, v8, 0
    v_dot2_f32_bf16 v42, v137, v9, v42
    v_dot2_f32_bf16 v42, v138, v10, v42
    v_dot2_f32_bf16 v42, v139, v11, v42
    v_add_f32_dpp v44, v40, v40 row_mirror row_mask:0xf bank_mask:0x3
    v_add_f32_dpp v44, v41, v41 row_mirror row_mask:0xf bank_mask:0xc
    v_dot2_f32_bf16 v43, v140, v8, 0
    v_dot2_f32_bf16 v43, v141, v9, v43
    v_dot2_f32_bf16 v43, v142, v10, v43
    v_dot2_f32_bf16 v43, v143, v11, v43
    v_dot2_f32_bf16 v40, v144, v8, 0
    v_dot2_f32_bf16 v40, v145, v9, v40
    v_dot2_f32_bf16 v40, v146, v10, v40
    v_dot2_f32_bf16 v40, v147, v11, v40
    s_waitcnt vmcnt(5)
    buffer_load_dwordx4 v[100:103], v2, s[8:11], s60 offen offset:1024 nt
    v_add_f32_dpp v45, v42, v42 row_mirror row_mask:0xf bank_mask:0x3
    v_add_f32_dpp v45, v43, v43 row_mirror row_mask:0xf bank_mask:0xc
    v_add_f32_dpp v46, v44, v44 row_half_mirror row_mask:0xf bank_mask:0x5
    s_nop 0
    v_add_f32_dpp v46, v45, v45 row_half_mirror row_mask:0xf bank_mask:0xa
    v_dot2_f32_bf16 v41, v148, v8, 0
    v_dot2_f32_bf16 v41, v149, v9, v41
    v_dot2_f32_bf16 v41, v150, v10, v41
    v_dot2_f32_bf16 v41, v151, v11, v41
    v_dot2_f32_bf16 v42, v152, v8, 0
    v_dot2_f32_bf16 v42, v153, v9, v42
    v_dot2_f32_bf16 v42, v154, v10, v42
    v_dot2_f32_bf16 v42, v155, v11, v42
    v_add_f32_dpp v44, v40, v40 row_mirror row_mask:0xf bank_mask:0x3
    v_add_f32_dpp v44, v41, v41 row_mirror row_mask:0xf bank_mask:0xc
    v_dot2_f32_bf16 v43, v156, v8, 0
    v_dot2_f32_bf16 v43, v157, v9, v43
    v_dot2_f32_bf16 v43, v158, v10, v43
    v_dot2_f32_bf16 v43, v159, v11, v43
    v_dot2_f32_bf16 v40, v160, v8, 0
    v_dot2_f32_bf16 v40, v161, v9, v40
    v_dot2_f32_bf16 v40, v162, v10, v40
    v_dot2_f32_bf16 v40, v163, v11, v40
    s_waitcnt vmcnt(5)
    buffer_load_dwordx4 v[104:107], v2, s[8:11], s60 offen offset:2048 nt
    v_add_f32_dpp v45, v42, v42 row_mirror row_mask:0xf bank_mask:0x3
    v_add_f32_dpp v45, v43, v43 row_mirror row_mask:0xf bank_mask:0xc
    v_add_f32_dpp v47, v44, v44 row_half_mirror row_mask:0xf bank_mask:0x5
    s_nop 0
    v_add_f32_dpp v47, v45, v45 row_half_mirror row_mask:0xf bank_mask:0xa
    v_cndmask_b32 v50, v46, v47, s[56:57]
    v_cndmask_b32 v51, v47, v46, s[56:57]
    s_nop 1
    v_add_f32_dpp v48, v51, v50 quad_perm:[2,3,0,1] row_mask:0xf bank_mask:0xf
    v_dot2_f32_bf16 v41, v164, v8, 0
    v_dot2_f32_bf16 v41, v165, v9, v41
    v_dot2_f32_bf16 v41, v166, v10, v41
    v_dot2_f32_bf16 v41, v167, v11, v41
    v_dot2_f32_bf16 v42, v168, v8, 0
    v_dot2_f32_bf16 v42, v169, v9, v42
    v_dot2_f32_bf16 v42, v170, v10, v42
    v_dot2_f32_bf16 v42, v171, v11, v42
    v_add_f32_dpp v44, v40, v40 row_mirror row_mask:0xf bank_mask:0x3
    v_add_f32_dpp v44, v41, v41 row_mirror row_mask:0xf bank_mask:0xc
    v_dot2_f32_bf16 v43, v172, v8, 0
    v_dot2_f32_bf16 v43, v173, v9, v43
    v_dot2_f32_bf16 v43, v174, v10, v43
    v_dot2_f32_bf16 v43, v175, v11, v43
    v_dot2_f32_bf16 v40, v176, v8, 0
    v_dot2_f32_bf16 v40, v177, v9, v40
    v_dot2_f32_bf16 v40, v178, v10, v40
    v_dot2_f32_bf16 v40, v179, v11, v40
    s_waitcnt vmcnt(5)
    buffer_load_dwordx4 v[108:111], v2, s[8:11], s60 offen offset:3072 nt
    v_add_f32_dpp v45, v42, v42 row_mirror row_mask:0xf bank_mask:0x3
    v_add_f32_dpp v45, v43, v43 row_mirror row_mask:0xf bank_mask:0xc
    v_add_f32_dpp v46, v44, v44 row_half_mirror row_mask:0xf bank_mask:0x5
    s_nop 0
    v_add_f32_dpp v46, v45, v45 row_half_mirror row_mask:0xf bank_mask:0xa
    v_dot2_f32_bf16 v41, v180, v8, 0
    v_dot2_f32_bf16 v41, v181, v9, v41
    v_dot2_f32_bf16 v41, v182, v10, v41
    v_dot2_f32_bf16 v41, v183, v11, v41
    v_dot2_f32_bf16 v42, v184, v8, 0
    v_dot2_f32_bf16 v42, v185, v9, v42
    v_dot2_f32_bf16 v42, v186, v10, v42
    v_dot2_f32_bf16 v42, v187, v11, v42
    v_add_f32_dpp v44, v40, v40 row_mirror row_mask:0xf bank_mask:0x3
    v_add_f32_dpp v44, v41, v41 row_mirror row_mask:0xf bank_mask:0xc
    v_dot2_f32_bf16 v43, v188, v8, 0
    v_dot2_f32_bf16 v43, v189, v9, v43
    v_dot2_f32_bf16 v43, v190, v10, v43
    v_dot2_f32_bf16 v43, v191, v11, v43
    v_dot2_f32_bf16 v40, v192, v8, 0
    v_dot2_f32_bf16 v40, v193, v9, v40
    v_dot2_f32_bf16 v40, v194, v10, v40
    v_dot2_f32_bf16 v40, v195, v11, v40
    s_waitcnt vmcnt(5)
    s_xor_b32 s60, s63, 393216
    buffer_load_dwordx4 v[112:115], v2, s[8:11], s60 offen offset:0 nt
    v_add_f32_dpp v45, v42, v42 row_mirror row_mask:0xf bank_mask:0x3
    v_add_f32_dpp v45, v43, v43 row_mirror row_mask:0xf bank_mask:0xc
    v_add_f32_dpp v47, v44, v44 row_half_mirror row_mask:0xf bank_mask:0x5
    s_nop 0
    v_add_f32_dpp v47, v45, v45 row_half_mirror row_mask:0xf bank_mask:0xa
    v_cndmask_b32 v50, v46, v47, s[56:57]
    v_cndmask_b32 v51, v47, v46, s[56:57]
    s_nop 1
    v_add_f32_dpp v49, v51, v50 quad_perm:[2,3,0,1] row_mask:0xf bank_mask:0xf
    v_cndmask_b32 v50, v48, v49, s[58:59]
    v_cndmask_b32 v51, v49, v48, s[58:59]
    s_nop 1
    v_add_f32_dpp v25, v51, v50 quad_perm:[1,0,3,2] row_mask:0xf bank_mask:0xf
    v_cvt_pk_bf16_f32 v25, v25, v25
    v_and_b32 v25, 0xffff0000, v25
    v_mul_f32 v25, s92, v25
    v_cvt_pk_bf16_f32 v25, v25, v25
    v_and_b32 v25, 0xffff0000, v25
    v_max_f32 v58, v58, v25
    v_dot2_f32_bf16 v41, v196, v8, 0
    v_dot2_f32_bf16 v41, v197, v9, v41
    v_dot2_f32_bf16 v41, v198, v10, v41
    v_dot2_f32_bf16 v41, v199, v11, v41
    v_dot2_f32_bf16 v42, v200, v8, 0
    v_dot2_f32_bf16 v42, v201, v9, v42
    v_dot2_f32_bf16 v42, v202, v10, v42
    v_dot2_f32_bf16 v42, v203, v11, v42
    v_add_f32_dpp v44, v40, v40 row_mirror row_mask:0xf bank_mask:0x3
    v_add_f32_dpp v44, v41, v41 row_mirror row_mask:0xf bank_mask:0xc
    v_dot2_f32_bf16 v43, v204, v8, 0
    v_dot2_f32_bf16 v43, v205, v9, v43
    v_dot2_f32_bf16 v43, v206, v10, v43
    v_dot2_f32_bf16 v43, v207, v11, v43
    v_dot2_f32_bf16 v40, v208, v8, 0
    v_dot2_f32_bf16 v40, v209, v9, v40
    v_dot2_f32_bf16 v40, v210, v10, v40
    v_dot2_f32_bf16 v40, v211, v11, v40
    s_waitcnt vmcnt(5)
    buffer_load_dwordx4 v[116:119], v2, s[8:11], s60 offen offset:1024 nt
    v_add_f32_dpp v45, v42, v42 row_mirror row_mask:0xf bank_mask:0x3
    v_add_f32_dpp v45, v43, v43 row_mirror row_mask:0xf bank_mask:0xc
    v_add_f32_dpp v46, v44, v44 row_half_mirror row_mask:0xf bank_mask:0x5
    s_nop 0
    v_add_f32_dpp v46, v45, v45 row_half_mirror row_mask:0xf bank_mask:0xa
    v_dot2_f32_bf16 v41, v212, v8, 0
    v_dot2_f32_bf16 v41, v213, v9, v41
    v_dot2_f32_bf16 v41, v214, v10, v41
    v_dot2_f32_bf16 v41, v215, v11, v41
    v_dot2_f32_bf16 v42, v216, v8, 0
    v_dot2_f32_bf16 v42, v217, v9, v42
    v_dot2_f32_bf16 v42, v218, v10, v42
    v_dot2_f32_bf16 v42, v219, v11, v42
    v_add_f32_dpp v44, v40, v40 row_mirror row_mask:0xf bank_mask:0x3
    v_add_f32_dpp v44, v41, v41 row_mirror row_mask:0xf bank_mask:0xc
    v_dot2_f32_bf16 v43, v220, v8, 0
    v_dot2_f32_bf16 v43, v221, v9, v43
    v_dot2_f32_bf16 v43, v222, v10, v43
    v_dot2_f32_bf16 v43, v223, v11, v43
    v_dot2_f32_bf16 v40, v224, v8, 0
    v_dot2_f32_bf16 v40, v225, v9, v40
    v_dot2_f32_bf16 v40, v226, v10, v40
    v_dot2_f32_bf16 v40, v227, v11, v40
    s_waitcnt vmcnt(5)
    buffer_load_dwordx4 v[120:123], v2, s[8:11], s60 offen offset:2048 nt
    v_add_f32_dpp v45, v42, v42 row_mirror row_mask:0xf bank_mask:0x3
    v_add_f32_dpp v45, v43, v43 row_mirror row_mask:0xf bank_mask:0xc
    v_add_f32_dpp v47, v44, v44 row_half_mirror row_mask:0xf bank_mask:0x5
    s_nop 0
    v_add_f32_dpp v47, v45, v45 row_half_mirror row_mask:0xf bank_mask:0xa
    v_cndmask_b32 v50, v46, v47, s[56:57]
    v_cndmask_b32 v51, v47, v46, s[56:57]
    s_nop 1
    v_add_f32_dpp v48, v51, v50 quad_perm:[2,3,0,1] row_mask:0xf bank_mask:0xf
    v_dot2_f32_bf16 v41, v228, v8, 0
    v_dot2_f32_bf16 v41, v229, v9, v41
    v_dot2_f32_bf16 v41, v230, v10, v41
    v_dot2_f32_bf16 v41, v231, v11, v41
    v_dot2_f32_bf16 v42, v232, v8, 0
    v_dot2_f32_bf16 v42, v233, v9, v42
    v_dot2_f32_bf16 v42, v234, v10, v42
    v_dot2_f32_bf16 v42, v235, v11, v42
    v_add_f32_dpp v44, v40, v40 row_mirror row_mask:0xf bank_mask:0x3
    v_add_f32_dpp v44, v41, v41 row_mirror row_mask:0xf bank_mask:0xc
    v_dot2_f32_bf16 v43, v236, v8, 0
    v_dot2_f32_bf16 v43, v237, v9, v43
    v_dot2_f32_bf16 v43, v238, v10, v43
    v_dot2_f32_bf16 v43, v239, v11, v43
    v_dot2_f32_bf16 v40, v240, v8, 0
    v_dot2_f32_bf16 v40, v241, v9, v40
    v_dot2_f32_bf16 v40, v242, v10, v40
    v_dot2_f32_bf16 v40, v243, v11, v40
    s_waitcnt vmcnt(5)
    buffer_load_dwordx4 v[124:127], v2, s[8:11], s60 offen offset:3072 nt
    v_add_f32_dpp v45, v42, v42 row_mirror row_mask:0xf bank_mask:0x3
    v_add_f32_dpp v45, v43, v43 row_mirror row_mask:0xf bank_mask:0xc
    v_add_f32_dpp v46, v44, v44 row_half_mirror row_mask:0xf bank_mask:0x5
    s_nop 0
    v_add_f32_dpp v46, v45, v45 row_half_mirror row_mask:0xf bank_mask:0xa
    v_dot2_f32_bf16 v41, v244, v8, 0
    v_dot2_f32_bf16 v41, v245, v9, v41
    v_dot2_f32_bf16 v41, v246, v10, v41
    v_dot2_f32_bf16 v41, v247, v11, v41
    ds_read_b128 v[128:131], v60 offset:0
    v_dot2_f32_bf16 v42, v248, v8, 0
    v_dot2_f32_bf16 v42, v249, v9, v42
    v_dot2_f32_bf16 v42, v250, v10, v42
    v_dot2_f32_bf16 v42, v251, v11, v42
    ds_read_b128 v[132:135], v60 offset:1024
    v_add_f32_dpp v44, v40, v40 row_mirror row_mask:0xf bank_mask:0x3
    v_add_f32_dpp v44, v41, v41 row_mirror row_mask:0xf bank_mask:0xc
    v_dot2_f32_bf16 v43, v252, v8, 0
    v_dot2_f32_bf16 v43, v253, v9, v43
    v_dot2_f32_bf16 v43, v254, v10, v43
    v_dot2_f32_bf16 v43, v255, v11, v43
    ds_read_b128 v[136:139], v60 offset:2048
    s_waitcnt lgkmcnt(2)
    v_dot2_f32_bf16 v40, v128, v8, 0
    v_dot2_f32_bf16 v40, v129, v9, v40
    v_dot2_f32_bf16 v40, v130, v10, v40
    v_dot2_f32_bf16 v40, v131, v11, v40
    ds_read_b128 v[140:143], v60 offset:3072
    s_waitcnt vmcnt(5)
    s_xor_b32 s60, s63, 409600
    buffer_load_dwordx4 v[144:147], v2, s[8:11], s60 offen offset:0 nt
    v_add_f32_dpp v45, v42, v42 row_mirror row_mask:0xf bank_mask:0x3
    v_add_f32_dpp v45, v43, v43 row_mirror row_mask:0xf bank_mask:0xc
    v_add_f32_dpp v47, v44, v44 row_half_mirror row_mask:0xf bank_mask:0x5
    s_nop 0
    v_add_f32_dpp v47, v45, v45 row_half_mirror row_mask:0xf bank_mask:0xa
    v_cndmask_b32 v50, v46, v47, s[56:57]
    v_cndmask_b32 v51, v47, v46, s[56:57]
    s_nop 1
    v_add_f32_dpp v49, v51, v50 quad_perm:[2,3,0,1] row_mask:0xf bank_mask:0xf
    v_cndmask_b32 v50, v48, v49, s[58:59]
    v_cndmask_b32 v51, v49, v48, s[58:59]
    s_nop 1
    v_add_f32_dpp v26, v51, v50 quad_perm:[1,0,3,2] row_mask:0xf bank_mask:0xf
    v_cvt_pk_bf16_f32 v26, v26, v26
    v_and_b32 v26, 0xffff0000, v26
    v_mul_f32 v26, s92, v26
    v_cvt_pk_bf16_f32 v26, v26, v26
    v_and_b32 v26, 0xffff0000, v26
    v_max_f32 v58, v58, v26
    s_waitcnt lgkmcnt(2)
    v_dot2_f32_bf16 v41, v132, v8, 0
    v_dot2_f32_bf16 v41, v133, v9, v41
    v_dot2_f32_bf16 v41, v134, v10, v41
    v_dot2_f32_bf16 v41, v135, v11, v41
    ds_read_b128 v[148:151], v60 offset:4096
    s_waitcnt lgkmcnt(2)
    v_dot2_f32_bf16 v42, v136, v8, 0
    v_dot2_f32_bf16 v42, v137, v9, v42
    v_dot2_f32_bf16 v42, v138, v10, v42
    v_dot2_f32_bf16 v42, v139, v11, v42
    ds_read_b128 v[152:155], v60 offset:5120
    v_add_f32_dpp v44, v40, v40 row_mirror row_mask:0xf bank_mask:0x3
    v_add_f32_dpp v44, v41, v41 row_mirror row_mask:0xf bank_mask:0xc
    s_waitcnt lgkmcnt(2)
    v_dot2_f32_bf16 v43, v140, v8, 0
    v_dot2_f32_bf16 v43, v141, v9, v43
    v_dot2_f32_bf16 v43, v142, v10, v43
    v_dot2_f32_bf16 v43, v143, v11, v43
    ds_read_b128 v[156:159], v60 offset:6144
    s_waitcnt lgkmcnt(2)
    v_dot2_f32_bf16 v40, v148, v8, 0
    v_dot2_f32_bf16 v40, v149, v9, v40
    v_dot2_f32_bf16 v40, v150, v10, v40
    v_dot2_f32_bf16 v40, v151, v11, v40
    ds_read_b128 v[160:163], v60 offset:7168
    s_waitcnt vmcnt(5)
    buffer_load_dwordx4 v[164:167], v2, s[8:11], s60 offen offset:1024 nt
    v_add_f32_dpp v45, v42, v42 row_mirror row_mask:0xf bank_mask:0x3
    v_add_f32_dpp v45, v43, v43 row_mirror row_mask:0xf bank_mask:0xc
    v_add_f32_dpp v46, v44, v44 row_half_mirror row_mask:0xf bank_mask:0x5
    s_nop 0
    v_add_f32_dpp v46, v45, v45 row_half_mirror row_mask:0xf bank_mask:0xa
    s_waitcnt lgkmcnt(2)
    v_dot2_f32_bf16 v41, v152, v8, 0
    v_dot2_f32_bf16 v41, v153, v9, v41
    v_dot2_f32_bf16 v41, v154, v10, v41
    v_dot2_f32_bf16 v41, v155, v11, v41
    ds_read_b128 v[168:171], v60 offset:8192
    s_waitcnt lgkmcnt(2)
    v_dot2_f32_bf16 v42, v156, v8, 0
    v_dot2_f32_bf16 v42, v157, v9, v42
    v_dot2_f32_bf16 v42, v158, v10, v42
    v_dot2_f32_bf16 v42, v159, v11, v42
    ds_read_b128 v[172:175], v60 offset:9216
    v_add_f32_dpp v44, v40, v40 row_mirror row_mask:0xf bank_mask:0x3
    v_add_f32_dpp v44, v41, v41 row_mirror row_mask:0xf bank_mask:0xc
    s_waitcnt lgkmcnt(2)
    v_dot2_f32_bf16 v43, v160, v8, 0
    v_dot2_f32_bf16 v43, v161, v9, v43
    v_dot2_f32_bf16 v43, v162, v10, v43
    v_dot2_f32_bf16 v43, v163, v11, v43
    ds_read_b128 v[176:179], v60 offset:10240
    s_waitcnt lgkmcnt(2)
    v_dot2_f32_bf16 v40, v168, v8, 0
    v_dot2_f32_bf16 v40, v169, v9, v40
    v_dot2_f32_bf16 v40, v170, v10, v40
    v_dot2_f32_bf16 v40, v171, v11, v40
    ds_read_b128 v[180:183], v60 offset:11264
    s_waitcnt vmcnt(5)
    buffer_load_dwordx4 v[184:187], v2, s[8:11], s60 offen offset:2048 nt
    v_add_f32_dpp v45, v42, v42 row_mirror row_mask:0xf bank_mask:0x3
    v_add_f32_dpp v45, v43, v43 row_mirror row_mask:0xf bank_mask:0xc
    v_add_f32_dpp v47, v44, v44 row_half_mirror row_mask:0xf bank_mask:0x5
    s_nop 0
    v_add_f32_dpp v47, v45, v45 row_half_mirror row_mask:0xf bank_mask:0xa
    v_cndmask_b32 v50, v46, v47, s[56:57]
    v_cndmask_b32 v51, v47, v46, s[56:57]
    s_nop 1
    v_add_f32_dpp v48, v51, v50 quad_perm:[2,3,0,1] row_mask:0xf bank_mask:0xf
    s_waitcnt lgkmcnt(2)
    v_dot2_f32_bf16 v41, v172, v8, 0
    v_dot2_f32_bf16 v41, v173, v9, v41
    v_dot2_f32_bf16 v41, v174, v10, v41
    v_dot2_f32_bf16 v41, v175, v11, v41
    ds_read_b128 v[188:191], v60 offset:12288
    s_waitcnt lgkmcnt(2)
    v_dot2_f32_bf16 v42, v176, v8, 0
    v_dot2_f32_bf16 v42, v177, v9, v42
    v_dot2_f32_bf16 v42, v178, v10, v42
    v_dot2_f32_bf16 v42, v179, v11, v42
    ds_read_b128 v[192:195], v60 offset:13312
    v_add_f32_dpp v44, v40, v40 row_mirror row_mask:0xf bank_mask:0x3
    v_add_f32_dpp v44, v41, v41 row_mirror row_mask:0xf bank_mask:0xc
    s_waitcnt lgkmcnt(2)
    v_dot2_f32_bf16 v43, v180, v8, 0
    v_dot2_f32_bf16 v43, v181, v9, v43
    v_dot2_f32_bf16 v43, v182, v10, v43
    v_dot2_f32_bf16 v43, v183, v11, v43
    ds_read_b128 v[196:199], v60 offset:14336
    s_waitcnt lgkmcnt(2)
    v_dot2_f32_bf16 v40, v188, v8, 0
    v_dot2_f32_bf16 v40, v189, v9, v40
    v_dot2_f32_bf16 v40, v190, v10, v40
    v_dot2_f32_bf16 v40, v191, v11, v40
    ds_read_b128 v[200:203], v60 offset:15360
    s_waitcnt vmcnt(5)
    buffer_load_dwordx4 v[204:207], v2, s[8:11], s60 offen offset:3072 nt
    v_add_f32_dpp v45, v42, v42 row_mirror row_mask:0xf bank_mask:0x3
    v_add_f32_dpp v45, v43, v43 row_mirror row_mask:0xf bank_mask:0xc
    v_add_f32_dpp v46, v44, v44 row_half_mirror row_mask:0xf bank_mask:0x5
    s_nop 0
    v_add_f32_dpp v46, v45, v45 row_half_mirror row_mask:0xf bank_mask:0xa
    s_waitcnt lgkmcnt(2)
    v_dot2_f32_bf16 v41, v192, v8, 0
    v_dot2_f32_bf16 v41, v193, v9, v41
    v_dot2_f32_bf16 v41, v194, v10, v41
    v_dot2_f32_bf16 v41, v195, v11, v41
    ds_read_b128 v[208:211], v60 offset:16384
    s_waitcnt lgkmcnt(2)
    v_dot2_f32_bf16 v42, v196, v8, 0
    v_dot2_f32_bf16 v42, v197, v9, v42
    v_dot2_f32_bf16 v42, v198, v10, v42
    v_dot2_f32_bf16 v42, v199, v11, v42
    ds_read_b128 v[212:215], v60 offset:17408
    v_add_f32_dpp v44, v40, v40 row_mirror row_mask:0xf bank_mask:0x3
    v_add_f32_dpp v44, v41, v41 row_mirror row_mask:0xf bank_mask:0xc
    s_waitcnt lgkmcnt(2)
    v_dot2_f32_bf16 v43, v200, v8, 0
    v_dot2_f32_bf16 v43, v201, v9, v43
    v_dot2_f32_bf16 v43, v202, v10, v43
    v_dot2_f32_bf16 v43, v203, v11, v43
    ds_read_b128 v[216:219], v60 offset:18432
    s_waitcnt lgkmcnt(2)
    v_dot2_f32_bf16 v40, v208, v8, 0
    v_dot2_f32_bf16 v40, v209, v9, v40
    v_dot2_f32_bf16 v40, v210, v10, v40
    v_dot2_f32_bf16 v40, v211, v11, v40
    ds_read_b128 v[220:223], v60 offset:19456
    s_waitcnt vmcnt(5)
    s_xor_b32 s60, s63, 425984
    buffer_load_dwordx4 v[224:227], v2, s[8:11], s60 offen offset:0 nt
    v_add_f32_dpp v45, v42, v42 row_mirror row_mask:0xf bank_mask:0x3
    v_add_f32_dpp v45, v43, v43 row_mirror row_mask:0xf bank_mask:0xc
    v_add_f32_dpp v47, v44, v44 row_half_mirror row_mask:0xf bank_mask:0x5
    s_nop 0
    v_add_f32_dpp v47, v45, v45 row_half_mirror row_mask:0xf bank_mask:0xa
    v_cndmask_b32 v50, v46, v47, s[56:57]
    v_cndmask_b32 v51, v47, v46, s[56:57]
    s_nop 1
    v_add_f32_dpp v49, v51, v50 quad_perm:[2,3,0,1] row_mask:0xf bank_mask:0xf
    v_cndmask_b32 v50, v48, v49, s[58:59]
    v_cndmask_b32 v51, v49, v48, s[58:59]
    s_nop 1
    v_add_f32_dpp v27, v51, v50 quad_perm:[1,0,3,2] row_mask:0xf bank_mask:0xf
    v_cvt_pk_bf16_f32 v27, v27, v27
    v_and_b32 v27, 0xffff0000, v27
    v_mul_f32 v27, s92, v27
    v_cvt_pk_bf16_f32 v27, v27, v27
    v_and_b32 v27, 0xffff0000, v27
    v_max_f32 v58, v58, v27
    s_waitcnt lgkmcnt(2)
    v_dot2_f32_bf16 v41, v212, v8, 0
    v_dot2_f32_bf16 v41, v213, v9, v41
    v_dot2_f32_bf16 v41, v214, v10, v41
    v_dot2_f32_bf16 v41, v215, v11, v41
    ds_read_b128 v[228:231], v60 offset:20480
    s_waitcnt lgkmcnt(2)
    v_dot2_f32_bf16 v42, v216, v8, 0
    v_dot2_f32_bf16 v42, v217, v9, v42
    v_dot2_f32_bf16 v42, v218, v10, v42
    v_dot2_f32_bf16 v42, v219, v11, v42
    ds_read_b128 v[232:235], v60 offset:21504
    v_add_f32_dpp v44, v40, v40 row_mirror row_mask:0xf bank_mask:0x3
    v_add_f32_dpp v44, v41, v41 row_mirror row_mask:0xf bank_mask:0xc
    s_waitcnt lgkmcnt(2)
    v_dot2_f32_bf16 v43, v220, v8, 0
    v_dot2_f32_bf16 v43, v221, v9, v43
    v_dot2_f32_bf16 v43, v222, v10, v43
    v_dot2_f32_bf16 v43, v223, v11, v43
    ds_read_b128 v[236:239], v60 offset:22528
    s_waitcnt lgkmcnt(2)
    v_dot2_f32_bf16 v40, v228, v8, 0
    v_dot2_f32_bf16 v40, v229, v9, v40
    v_dot2_f32_bf16 v40, v230, v10, v40
    v_dot2_f32_bf16 v40, v231, v11, v40
    ds_read_b128 v[240:243], v60 offset:23552
    s_waitcnt vmcnt(5)
    buffer_load_dwordx4 v[244:247], v2, s[8:11], s60 offen offset:1024 nt
    v_add_f32_dpp v45, v42, v42 row_mirror row_mask:0xf bank_mask:0x3
    v_add_f32_dpp v45, v43, v43 row_mirror row_mask:0xf bank_mask:0xc
    v_add_f32_dpp v46, v44, v44 row_half_mirror row_mask:0xf bank_mask:0x5
    s_nop 0
    v_add_f32_dpp v46, v45, v45 row_half_mirror row_mask:0xf bank_mask:0xa
    s_waitcnt lgkmcnt(2)
    v_dot2_f32_bf16 v41, v232, v8, 0
    v_dot2_f32_bf16 v41, v233, v9, v41
    v_dot2_f32_bf16 v41, v234, v10, v41
    v_dot2_f32_bf16 v41, v235, v11, v41
    ds_read_b128 v[248:251], v60 offset:24576
    s_waitcnt lgkmcnt(2)
    v_dot2_f32_bf16 v42, v236, v8, 0
    v_dot2_f32_bf16 v42, v237, v9, v42
    v_dot2_f32_bf16 v42, v238, v10, v42
    v_dot2_f32_bf16 v42, v239, v11, v42
    ds_read_b128 v[252:255], v60 offset:25600
    v_add_f32_dpp v44, v40, v40 row_mirror row_mask:0xf bank_mask:0x3
    v_add_f32_dpp v44, v41, v41 row_mirror row_mask:0xf bank_mask:0xc
    s_waitcnt lgkmcnt(2)
    v_dot2_f32_bf16 v43, v240, v8, 0
    v_dot2_f32_bf16 v43, v241, v9, v43
    v_dot2_f32_bf16 v43, v242, v10, v43
    v_dot2_f32_bf16 v43, v243, v11, v43
    ds_read_b128 v[128:131], v60 offset:26624
    s_waitcnt lgkmcnt(2)
    v_dot2_f32_bf16 v40, v248, v8, 0
    v_dot2_f32_bf16 v40, v249, v9, v40
    v_dot2_f32_bf16 v40, v250, v10, v40
    v_dot2_f32_bf16 v40, v251, v11, v40
    ds_read_b128 v[132:135], v60 offset:27648
    s_waitcnt vmcnt(5)
    buffer_load_dwordx4 v[136:139], v2, s[8:11], s60 offen offset:2048 nt
    v_add_f32_dpp v45, v42, v42 row_mirror row_mask:0xf bank_mask:0x3
    v_add_f32_dpp v45, v43, v43 row_mirror row_mask:0xf bank_mask:0xc
    v_add_f32_dpp v47, v44, v44 row_half_mirror row_mask:0xf bank_mask:0x5
    s_nop 0
    v_add_f32_dpp v47, v45, v45 row_half_mirror row_mask:0xf bank_mask:0xa
    v_cndmask_b32 v50, v46, v47, s[56:57]
    v_cndmask_b32 v51, v47, v46, s[56:57]
    s_nop 1
    v_add_f32_dpp v48, v51, v50 quad_perm:[2,3,0,1] row_mask:0xf bank_mask:0xf
    s_waitcnt lgkmcnt(2)
    v_dot2_f32_bf16 v41, v252, v8, 0
    v_dot2_f32_bf16 v41, v253, v9, v41
    v_dot2_f32_bf16 v41, v254, v10, v41
    v_dot2_f32_bf16 v41, v255, v11, v41
    ds_read_b128 v[140:143], v60 offset:28672
    s_waitcnt lgkmcnt(2)
    v_dot2_f32_bf16 v42, v128, v8, 0
    v_dot2_f32_bf16 v42, v129, v9, v42
    v_dot2_f32_bf16 v42, v130, v10, v42
    v_dot2_f32_bf16 v42, v131, v11, v42
    ds_read_b128 v[148:151], v60 offset:29696
    v_add_f32_dpp v44, v40, v40 row_mirror row_mask:0xf bank_mask:0x3
    v_add_f32_dpp v44, v41, v41 row_mirror row_mask:0xf bank_mask:0xc
    s_waitcnt lgkmcnt(2)
    v_dot2_f32_bf16 v43, v132, v8, 0
    v_dot2_f32_bf16 v43, v133, v9, v43
    v_dot2_f32_bf16 v43, v134, v10, v43
    v_dot2_f32_bf16 v43, v135, v11, v43
    ds_read_b128 v[152:155], v60 offset:30720
    s_waitcnt lgkmcnt(2)
    v_dot2_f32_bf16 v40, v140, v8, 0
    v_dot2_f32_bf16 v40, v141, v9, v40
    v_dot2_f32_bf16 v40, v142, v10, v40
    v_dot2_f32_bf16 v40, v143, v11, v40
    ds_read_b128 v[156:159], v60 offset:31744
    s_waitcnt vmcnt(5)
    buffer_load_dwordx4 v[160:163], v2, s[8:11], s60 offen offset:3072 nt
    v_add_f32_dpp v45, v42, v42 row_mirror row_mask:0xf bank_mask:0x3
    v_add_f32_dpp v45, v43, v43 row_mirror row_mask:0xf bank_mask:0xc
    v_add_f32_dpp v46, v44, v44 row_half_mirror row_mask:0xf bank_mask:0x5
    s_nop 0
    v_add_f32_dpp v46, v45, v45 row_half_mirror row_mask:0xf bank_mask:0xa
    s_waitcnt lgkmcnt(2)
    v_dot2_f32_bf16 v41, v148, v8, 0
    v_dot2_f32_bf16 v41, v149, v9, v41
    v_dot2_f32_bf16 v41, v150, v10, v41
    v_dot2_f32_bf16 v41, v151, v11, v41
    ds_read_b128 v[168:171], v60 offset:32768
    s_waitcnt lgkmcnt(2)
    v_dot2_f32_bf16 v42, v152, v8, 0
    v_dot2_f32_bf16 v42, v153, v9, v42
    v_dot2_f32_bf16 v42, v154, v10, v42
    v_dot2_f32_bf16 v42, v155, v11, v42
    ds_read_b128 v[172:175], v60 offset:33792
    v_add_f32_dpp v44, v40, v40 row_mirror row_mask:0xf bank_mask:0x3
    v_add_f32_dpp v44, v41, v41 row_mirror row_mask:0xf bank_mask:0xc
    s_waitcnt lgkmcnt(2)
    v_dot2_f32_bf16 v43, v156, v8, 0
    v_dot2_f32_bf16 v43, v157, v9, v43
    v_dot2_f32_bf16 v43, v158, v10, v43
    v_dot2_f32_bf16 v43, v159, v11, v43
    ds_read_b128 v[176:179], v60 offset:34816
    s_waitcnt lgkmcnt(2)
    v_dot2_f32_bf16 v40, v168, v8, 0
    v_dot2_f32_bf16 v40, v169, v9, v40
    v_dot2_f32_bf16 v40, v170, v10, v40
    v_dot2_f32_bf16 v40, v171, v11, v40
    ds_read_b128 v[180:183], v60 offset:35840
    s_waitcnt vmcnt(5)
    s_xor_b32 s60, s63, 442368
    buffer_load_dwordx4 v[188:191], v2, s[8:11], s60 offen offset:0 nt
    v_add_f32_dpp v45, v42, v42 row_mirror row_mask:0xf bank_mask:0x3
    v_add_f32_dpp v45, v43, v43 row_mirror row_mask:0xf bank_mask:0xc
    v_add_f32_dpp v47, v44, v44 row_half_mirror row_mask:0xf bank_mask:0x5
    s_nop 0
    v_add_f32_dpp v47, v45, v45 row_half_mirror row_mask:0xf bank_mask:0xa
    v_cndmask_b32 v50, v46, v47, s[56:57]
    v_cndmask_b32 v51, v47, v46, s[56:57]
    s_nop 1
    v_add_f32_dpp v49, v51, v50 quad_perm:[2,3,0,1] row_mask:0xf bank_mask:0xf
    v_cndmask_b32 v50, v48, v49, s[58:59]
    v_cndmask_b32 v51, v49, v48, s[58:59]
    s_nop 1
    v_add_f32_dpp v28, v51, v50 quad_perm:[1,0,3,2] row_mask:0xf bank_mask:0xf
    v_cvt_pk_bf16_f32 v28, v28, v28
    v_and_b32 v28, 0xffff0000, v28
    v_mul_f32 v28, s92, v28
    v_cvt_pk_bf16_f32 v28, v28, v28
    v_and_b32 v28, 0xffff0000, v28
    v_max_f32 v58, v58, v28
    s_waitcnt lgkmcnt(2)
    v_dot2_f32_bf16 v41, v172, v8, 0
    v_dot2_f32_bf16 v41, v173, v9, v41
    v_dot2_f32_bf16 v41, v174, v10, v41
    v_dot2_f32_bf16 v41, v175, v11, v41
    s_waitcnt lgkmcnt(1)
    v_dot2_f32_bf16 v42, v176, v8, 0
    v_dot2_f32_bf16 v42, v177, v9, v42
    v_dot2_f32_bf16 v42, v178, v10, v42
    v_dot2_f32_bf16 v42, v179, v11, v42
    v_add_f32_dpp v44, v40, v40 row_mirror row_mask:0xf bank_mask:0x3
    v_add_f32_dpp v44, v41, v41 row_mirror row_mask:0xf bank_mask:0xc
    s_waitcnt lgkmcnt(0)
    v_dot2_f32_bf16 v43, v180, v8, 0
    v_dot2_f32_bf16 v43, v181, v9, v43
    v_dot2_f32_bf16 v43, v182, v10, v43
    v_dot2_f32_bf16 v43, v183, v11, v43
    v_dot2_f32_bf16 v40, v64, v8, 0
    v_dot2_f32_bf16 v40, v65, v9, v40
    v_dot2_f32_bf16 v40, v66, v10, v40
    v_dot2_f32_bf16 v40, v67, v11, v40
    s_waitcnt vmcnt(5)
    buffer_load_dwordx4 v[192:195], v2, s[8:11], s60 offen offset:1024 nt
    v_add_f32_dpp v45, v42, v42 row_mirror row_mask:0xf bank_mask:0x3
    v_add_f32_dpp v45, v43, v43 row_mirror row_mask:0xf bank_mask:0xc
    v_add_f32_dpp v46, v44, v44 row_half_mirror row_mask:0xf bank_mask:0x5
    s_nop 0
    v_add_f32_dpp v46, v45, v45 row_half_mirror row_mask:0xf bank_mask:0xa
    v_dot2_f32_bf16 v41, v68, v8, 0
    v_dot2_f32_bf16 v41, v69, v9, v41
    v_dot2_f32_bf16 v41, v70, v10, v41
    v_dot2_f32_bf16 v41, v71, v11, v41
    v_dot2_f32_bf16 v42, v72, v8, 0
    v_dot2_f32_bf16 v42, v73, v9, v42
    v_dot2_f32_bf16 v42, v74, v10, v42
    v_dot2_f32_bf16 v42, v75, v11, v42
    v_add_f32_dpp v44, v40, v40 row_mirror row_mask:0xf bank_mask:0x3
    v_add_f32_dpp v44, v41, v41 row_mirror row_mask:0xf bank_mask:0xc
    v_dot2_f32_bf16 v43, v76, v8, 0
    v_dot2_f32_bf16 v43, v77, v9, v43
    v_dot2_f32_bf16 v43, v78, v10, v43
    v_dot2_f32_bf16 v43, v79, v11, v43
    v_dot2_f32_bf16 v40, v80, v8, 0
    v_dot2_f32_bf16 v40, v81, v9, v40
    v_dot2_f32_bf16 v40, v82, v10, v40
    v_dot2_f32_bf16 v40, v83, v11, v40
    s_waitcnt vmcnt(5)
    buffer_load_dwordx4 v[196:199], v2, s[8:11], s60 offen offset:2048 nt
    v_add_f32_dpp v45, v42, v42 row_mirror row_mask:0xf bank_mask:0x3
    v_add_f32_dpp v45, v43, v43 row_mirror row_mask:0xf bank_mask:0xc
    v_add_f32_dpp v47, v44, v44 row_half_mirror row_mask:0xf bank_mask:0x5
    s_nop 0
    v_add_f32_dpp v47, v45, v45 row_half_mirror row_mask:0xf bank_mask:0xa
    v_cndmask_b32 v50, v46, v47, s[56:57]
    v_cndmask_b32 v51, v47, v46, s[56:57]
    s_nop 1
    v_add_f32_dpp v48, v51, v50 quad_perm:[2,3,0,1] row_mask:0xf bank_mask:0xf
    v_dot2_f32_bf16 v41, v84, v8, 0
    v_dot2_f32_bf16 v41, v85, v9, v41
    v_dot2_f32_bf16 v41, v86, v10, v41
    v_dot2_f32_bf16 v41, v87, v11, v41
    v_dot2_f32_bf16 v42, v88, v8, 0
    v_dot2_f32_bf16 v42, v89, v9, v42
    v_dot2_f32_bf16 v42, v90, v10, v42
    v_dot2_f32_bf16 v42, v91, v11, v42
    v_add_f32_dpp v44, v40, v40 row_mirror row_mask:0xf bank_mask:0x3
    v_add_f32_dpp v44, v41, v41 row_mirror row_mask:0xf bank_mask:0xc
    v_dot2_f32_bf16 v43, v92, v8, 0
    v_dot2_f32_bf16 v43, v93, v9, v43
    v_dot2_f32_bf16 v43, v94, v10, v43
    v_dot2_f32_bf16 v43, v95, v11, v43
    v_dot2_f32_bf16 v40, v96, v8, 0
    v_dot2_f32_bf16 v40, v97, v9, v40
    v_dot2_f32_bf16 v40, v98, v10, v40
    v_dot2_f32_bf16 v40, v99, v11, v40
    s_waitcnt vmcnt(5)
    buffer_load_dwordx4 v[200:203], v2, s[8:11], s60 offen offset:3072 nt
    v_add_f32_dpp v45, v42, v42 row_mirror row_mask:0xf bank_mask:0x3
    v_add_f32_dpp v45, v43, v43 row_mirror row_mask:0xf bank_mask:0xc
    v_add_f32_dpp v46, v44, v44 row_half_mirror row_mask:0xf bank_mask:0x5
    s_nop 0
    v_add_f32_dpp v46, v45, v45 row_half_mirror row_mask:0xf bank_mask:0xa
    v_dot2_f32_bf16 v41, v100, v8, 0
    v_dot2_f32_bf16 v41, v101, v9, v41
    v_dot2_f32_bf16 v41, v102, v10, v41
    v_dot2_f32_bf16 v41, v103, v11, v41
    v_dot2_f32_bf16 v42, v104, v8, 0
    v_dot2_f32_bf16 v42, v105, v9, v42
    v_dot2_f32_bf16 v42, v106, v10, v42
    v_dot2_f32_bf16 v42, v107, v11, v42
    v_add_f32_dpp v44, v40, v40 row_mirror row_mask:0xf bank_mask:0x3
    v_add_f32_dpp v44, v41, v41 row_mirror row_mask:0xf bank_mask:0xc
    v_dot2_f32_bf16 v43, v108, v8, 0
    v_dot2_f32_bf16 v43, v109, v9, v43
    v_dot2_f32_bf16 v43, v110, v10, v43
    v_dot2_f32_bf16 v43, v111, v11, v43
    v_dot2_f32_bf16 v40, v112, v8, 0
    v_dot2_f32_bf16 v40, v113, v9, v40
    v_dot2_f32_bf16 v40, v114, v10, v40
    v_dot2_f32_bf16 v40, v115, v11, v40
    s_waitcnt vmcnt(5)
    s_xor_b32 s60, s63, 458752
    buffer_load_dwordx4 v[208:211], v2, s[8:11], s60 offen offset:0 nt
    v_add_f32_dpp v45, v42, v42 row_mirror row_mask:0xf bank_mask:0x3
    v_add_f32_dpp v45, v43, v43 row_mirror row_mask:0xf bank_mask:0xc
    v_add_f32_dpp v47, v44, v44 row_half_mirror row_mask:0xf bank_mask:0x5
    s_nop 0
    v_add_f32_dpp v47, v45, v45 row_half_mirror row_mask:0xf bank_mask:0xa
    v_cndmask_b32 v50, v46, v47, s[56:57]
    v_cndmask_b32 v51, v47, v46, s[56:57]
    s_nop 1
    v_add_f32_dpp v49, v51, v50 quad_perm:[2,3,0,1] row_mask:0xf bank_mask:0xf
    v_cndmask_b32 v50, v48, v49, s[58:59]
    v_cndmask_b32 v51, v49, v48, s[58:59]
    s_nop 1
    v_add_f32_dpp v29, v51, v50 quad_perm:[1,0,3,2] row_mask:0xf bank_mask:0xf
    v_cvt_pk_bf16_f32 v29, v29, v29
    v_and_b32 v29, 0xffff0000, v29
    v_mul_f32 v29, s92, v29
    v_cvt_pk_bf16_f32 v29, v29, v29
    v_and_b32 v29, 0xffff0000, v29
    v_max_f32 v58, v58, v29
    v_dot2_f32_bf16 v41, v116, v8, 0
    v_dot2_f32_bf16 v41, v117, v9, v41
    v_dot2_f32_bf16 v41, v118, v10, v41
    v_dot2_f32_bf16 v41, v119, v11, v41
    v_dot2_f32_bf16 v42, v120, v8, 0
    v_dot2_f32_bf16 v42, v121, v9, v42
    v_dot2_f32_bf16 v42, v122, v10, v42
    v_dot2_f32_bf16 v42, v123, v11, v42
    v_add_f32_dpp v44, v40, v40 row_mirror row_mask:0xf bank_mask:0x3
    v_add_f32_dpp v44, v41, v41 row_mirror row_mask:0xf bank_mask:0xc
    v_dot2_f32_bf16 v43, v124, v8, 0
    v_dot2_f32_bf16 v43, v125, v9, v43
    v_dot2_f32_bf16 v43, v126, v10, v43
    v_dot2_f32_bf16 v43, v127, v11, v43
    v_dot2_f32_bf16 v40, v144, v8, 0
    v_dot2_f32_bf16 v40, v145, v9, v40
    v_dot2_f32_bf16 v40, v146, v10, v40
    v_dot2_f32_bf16 v40, v147, v11, v40
    s_waitcnt vmcnt(5)
    buffer_load_dwordx4 v[212:215], v2, s[8:11], s60 offen offset:1024 nt
    v_add_f32_dpp v45, v42, v42 row_mirror row_mask:0xf bank_mask:0x3
    v_add_f32_dpp v45, v43, v43 row_mirror row_mask:0xf bank_mask:0xc
    v_add_f32_dpp v46, v44, v44 row_half_mirror row_mask:0xf bank_mask:0x5
    s_nop 0
    v_add_f32_dpp v46, v45, v45 row_half_mirror row_mask:0xf bank_mask:0xa
    v_dot2_f32_bf16 v41, v164, v8, 0
    v_dot2_f32_bf16 v41, v165, v9, v41
    v_dot2_f32_bf16 v41, v166, v10, v41
    v_dot2_f32_bf16 v41, v167, v11, v41
    v_dot2_f32_bf16 v42, v184, v8, 0
    v_dot2_f32_bf16 v42, v185, v9, v42
    v_dot2_f32_bf16 v42, v186, v10, v42
    v_dot2_f32_bf16 v42, v187, v11, v42
    v_add_f32_dpp v44, v40, v40 row_mirror row_mask:0xf bank_mask:0x3
    v_add_f32_dpp v44, v41, v41 row_mirror row_mask:0xf bank_mask:0xc
    v_dot2_f32_bf16 v43, v204, v8, 0
    v_dot2_f32_bf16 v43, v205, v9, v43
    v_dot2_f32_bf16 v43, v206, v10, v43
    v_dot2_f32_bf16 v43, v207, v11, v43
    v_dot2_f32_bf16 v40, v224, v8, 0
    v_dot2_f32_bf16 v40, v225, v9, v40
    v_dot2_f32_bf16 v40, v226, v10, v40
    v_dot2_f32_bf16 v40, v227, v11, v40
    s_waitcnt vmcnt(5)
    buffer_load_dwordx4 v[216:219], v2, s[8:11], s60 offen offset:2048 nt
    v_add_f32_dpp v45, v42, v42 row_mirror row_mask:0xf bank_mask:0x3
    v_add_f32_dpp v45, v43, v43 row_mirror row_mask:0xf bank_mask:0xc
    v_add_f32_dpp v47, v44, v44 row_half_mirror row_mask:0xf bank_mask:0x5
    s_nop 0
    v_add_f32_dpp v47, v45, v45 row_half_mirror row_mask:0xf bank_mask:0xa
    v_cndmask_b32 v50, v46, v47, s[56:57]
    v_cndmask_b32 v51, v47, v46, s[56:57]
    s_nop 1
    v_add_f32_dpp v48, v51, v50 quad_perm:[2,3,0,1] row_mask:0xf bank_mask:0xf
    v_dot2_f32_bf16 v41, v244, v8, 0
    v_dot2_f32_bf16 v41, v245, v9, v41
    v_dot2_f32_bf16 v41, v246, v10, v41
    v_dot2_f32_bf16 v41, v247, v11, v41
    v_dot2_f32_bf16 v42, v136, v8, 0
    v_dot2_f32_bf16 v42, v137, v9, v42
    v_dot2_f32_bf16 v42, v138, v10, v42
    v_dot2_f32_bf16 v42, v139, v11, v42
    v_add_f32_dpp v44, v40, v40 row_mirror row_mask:0xf bank_mask:0x3
    v_add_f32_dpp v44, v41, v41 row_mirror row_mask:0xf bank_mask:0xc
    v_dot2_f32_bf16 v43, v160, v8, 0
    v_dot2_f32_bf16 v43, v161, v9, v43
    v_dot2_f32_bf16 v43, v162, v10, v43
    v_dot2_f32_bf16 v43, v163, v11, v43
    v_dot2_f32_bf16 v40, v188, v8, 0
    v_dot2_f32_bf16 v40, v189, v9, v40
    v_dot2_f32_bf16 v40, v190, v10, v40
    v_dot2_f32_bf16 v40, v191, v11, v40
    s_waitcnt vmcnt(5)
    buffer_load_dwordx4 v[220:223], v2, s[8:11], s60 offen offset:3072 nt
    v_add_f32_dpp v45, v42, v42 row_mirror row_mask:0xf bank_mask:0x3
    v_add_f32_dpp v45, v43, v43 row_mirror row_mask:0xf bank_mask:0xc
    v_add_f32_dpp v46, v44, v44 row_half_mirror row_mask:0xf bank_mask:0x5
    s_nop 0
    v_add_f32_dpp v46, v45, v45 row_half_mirror row_mask:0xf bank_mask:0xa
    v_dot2_f32_bf16 v41, v192, v8, 0
    v_dot2_f32_bf16 v41, v193, v9, v41
    v_dot2_f32_bf16 v41, v194, v10, v41
    v_dot2_f32_bf16 v41, v195, v11, v41
    s_waitcnt vmcnt(5)
    v_dot2_f32_bf16 v42, v196, v8, 0
    v_dot2_f32_bf16 v42, v197, v9, v42
    v_dot2_f32_bf16 v42, v198, v10, v42
    v_dot2_f32_bf16 v42, v199, v11, v42
    s_xor_b32 s60, s63, 475136
    buffer_load_dwordx4 v[228:231], v2, s[8:11], s60 offen offset:0 nt
    v_add_f32_dpp v44, v40, v40 row_mirror row_mask:0xf bank_mask:0x3
    v_add_f32_dpp v44, v41, v41 row_mirror row_mask:0xf bank_mask:0xc
    s_waitcnt vmcnt(5)
    v_dot2_f32_bf16 v43, v200, v8, 0
    v_dot2_f32_bf16 v43, v201, v9, v43
    v_dot2_f32_bf16 v43, v202, v10, v43
    v_dot2_f32_bf16 v43, v203, v11, v43
    buffer_load_dwordx4 v[232:235], v2, s[8:11], s60 offen offset:1024 nt
    s_waitcnt vmcnt(5)
    v_dot2_f32_bf16 v40, v208, v8, 0
    v_dot2_f32_bf16 v40, v209, v9, v40
    v_dot2_f32_bf16 v40, v210, v10, v40
    v_dot2_f32_bf16 v40, v211, v11, v40
    buffer_load_dwordx4 v[236:239], v2, s[8:11], s60 offen offset:2048 nt
    v_add_f32_dpp v45, v42, v42 row_mirror row_mask:0xf bank_mask:0x3
    v_add_f32_dpp v45, v43, v43 row_mirror row_mask:0xf bank_mask:0xc
    v_add_f32_dpp v47, v44, v44 row_half_mirror row_mask:0xf bank_mask:0x5
    s_nop 0
    v_add_f32_dpp v47, v45, v45 row_half_mirror row_mask:0xf bank_mask:0xa
    v_cndmask_b32 v50, v46, v47, s[56:57]
    v_cndmask_b32 v51, v47, v46, s[56:57]
    s_nop 1
    v_add_f32_dpp v49, v51, v50 quad_perm:[2,3,0,1] row_mask:0xf bank_mask:0xf
    v_cndmask_b32 v50, v48, v49, s[58:59]
    v_cndmask_b32 v51, v49, v48, s[58:59]
    s_nop 1
    v_add_f32_dpp v30, v51, v50 quad_perm:[1,0,3,2] row_mask:0xf bank_mask:0xf
    v_cvt_pk_bf16_f32 v30, v30, v30
    v_and_b32 v30, 0xffff0000, v30
    v_mul_f32 v30, s92, v30
    v_cvt_pk_bf16_f32 v30, v30, v30
    v_and_b32 v30, 0xffff0000, v30
    v_max_f32 v58, v58, v30
    s_waitcnt vmcnt(5)
    v_dot2_f32_bf16 v41, v212, v8, 0
    v_dot2_f32_bf16 v41, v213, v9, v41
    v_dot2_f32_bf16 v41, v214, v10, v41
    v_dot2_f32_bf16 v41, v215, v11, v41
    buffer_load_dwordx4 v[240:243], v2, s[8:11], s60 offen offset:3072 nt
    s_waitcnt vmcnt(5)
    v_dot2_f32_bf16 v42, v216, v8, 0
    v_dot2_f32_bf16 v42, v217, v9, v42
    v_dot2_f32_bf16 v42, v218, v10, v42
    v_dot2_f32_bf16 v42, v219, v11, v42
    s_xor_b32 s60, s63, 491520
    buffer_load_dwordx4 v[248:251], v2, s[8:11], s60 offen offset:0 nt
    v_add_f32_dpp v44, v40, v40 row_mirror row_mask:0xf bank_mask:0x3
    v_add_f32_dpp v44, v41, v41 row_mirror row_mask:0xf bank_mask:0xc
    s_waitcnt vmcnt(5)
    v_dot2_f32_bf16 v43, v220, v8, 0
    v_dot2_f32_bf16 v43, v221, v9, v43
    v_dot2_f32_bf16 v43, v222, v10, v43
    v_dot2_f32_bf16 v43, v223, v11, v43
    buffer_load_dwordx4 v[252:255], v2, s[8:11], s60 offen offset:1024 nt
    s_waitcnt vmcnt(5)
    v_dot2_f32_bf16 v40, v228, v8, 0
    v_dot2_f32_bf16 v40, v229, v9, v40
    v_dot2_f32_bf16 v40, v230, v10, v40
    v_dot2_f32_bf16 v40, v231, v11, v40
    buffer_load_dwordx4 v[128:131], v2, s[8:11], s60 offen offset:2048 nt
    v_add_f32_dpp v45, v42, v42 row_mirror row_mask:0xf bank_mask:0x3
    v_add_f32_dpp v45, v43, v43 row_mirror row_mask:0xf bank_mask:0xc
    v_add_f32_dpp v46, v44, v44 row_half_mirror row_mask:0xf bank_mask:0x5
    s_nop 0
    v_add_f32_dpp v46, v45, v45 row_half_mirror row_mask:0xf bank_mask:0xa
    s_waitcnt vmcnt(5)
    v_dot2_f32_bf16 v41, v232, v8, 0
    v_dot2_f32_bf16 v41, v233, v9, v41
    v_dot2_f32_bf16 v41, v234, v10, v41
    v_dot2_f32_bf16 v41, v235, v11, v41
    buffer_load_dwordx4 v[132:135], v2, s[8:11], s60 offen offset:3072 nt
    s_waitcnt vmcnt(5)
    v_dot2_f32_bf16 v42, v236, v8, 0
    v_dot2_f32_bf16 v42, v237, v9, v42
    v_dot2_f32_bf16 v42, v238, v10, v42
    v_dot2_f32_bf16 v42, v239, v11, v42
    s_xor_b32 s60, s63, 507904
    buffer_load_dwordx4 v[140:143], v2, s[8:11], s60 offen offset:0 nt
    v_add_f32_dpp v44, v40, v40 row_mirror row_mask:0xf bank_mask:0x3
    v_add_f32_dpp v44, v41, v41 row_mirror row_mask:0xf bank_mask:0xc
    s_waitcnt vmcnt(5)
    v_dot2_f32_bf16 v43, v240, v8, 0
    v_dot2_f32_bf16 v43, v241, v9, v43
    v_dot2_f32_bf16 v43, v242, v10, v43
    v_dot2_f32_bf16 v43, v243, v11, v43
    buffer_load_dwordx4 v[148:151], v2, s[8:11], s60 offen offset:1024 nt
    s_waitcnt vmcnt(5)
    v_dot2_f32_bf16 v40, v248, v8, 0
    v_dot2_f32_bf16 v40, v249, v9, v40
    v_dot2_f32_bf16 v40, v250, v10, v40
    v_dot2_f32_bf16 v40, v251, v11, v40
    buffer_load_dwordx4 v[152:155], v2, s[8:11], s60 offen offset:2048 nt
    v_add_f32_dpp v45, v42, v42 row_mirror row_mask:0xf bank_mask:0x3
    v_add_f32_dpp v45, v43, v43 row_mirror row_mask:0xf bank_mask:0xc
    v_add_f32_dpp v47, v44, v44 row_half_mirror row_mask:0xf bank_mask:0x5
    s_nop 0
    v_add_f32_dpp v47, v45, v45 row_half_mirror row_mask:0xf bank_mask:0xa
    v_cndmask_b32 v50, v46, v47, s[56:57]
    v_cndmask_b32 v51, v47, v46, s[56:57]
    s_nop 1
    v_add_f32_dpp v48, v51, v50 quad_perm:[2,3,0,1] row_mask:0xf bank_mask:0xf
    s_waitcnt vmcnt(5)
    v_dot2_f32_bf16 v41, v252, v8, 0
    v_dot2_f32_bf16 v41, v253, v9, v41
    v_dot2_f32_bf16 v41, v254, v10, v41
    v_dot2_f32_bf16 v41, v255, v11, v41
    buffer_load_dwordx4 v[156:159], v2, s[8:11], s60 offen offset:3072 nt
    s_waitcnt vmcnt(5)
    v_dot2_f32_bf16 v42, v128, v8, 0
    v_dot2_f32_bf16 v42, v129, v9, v42
    v_dot2_f32_bf16 v42, v130, v10, v42
    v_dot2_f32_bf16 v42, v131, v11, v42
    s_xor_b32 s60, s63, 524288
    buffer_load_dwordx4 v[168:171], v2, s[8:11], s60 offen offset:0 nt
    v_add_f32_dpp v44, v40, v40 row_mirror row_mask:0xf bank_mask:0x3
    v_add_f32_dpp v44, v41, v41 row_mirror row_mask:0xf bank_mask:0xc
    s_waitcnt vmcnt(5)
    v_dot2_f32_bf16 v43, v132, v8, 0
    v_dot2_f32_bf16 v43, v133, v9, v43
    v_dot2_f32_bf16 v43, v134, v10, v43
    v_dot2_f32_bf16 v43, v135, v11, v43
    buffer_load_dwordx4 v[172:175], v2, s[8:11], s60 offen offset:1024 nt
    s_waitcnt vmcnt(5)
    v_dot2_f32_bf16 v40, v140, v8, 0
    v_dot2_f32_bf16 v40, v141, v9, v40
    v_dot2_f32_bf16 v40, v142, v10, v40
    v_dot2_f32_bf16 v40, v143, v11, v40
    buffer_load_dwordx4 v[176:179], v2, s[8:11], s60 offen offset:2048 nt
    v_add_f32_dpp v45, v42, v42 row_mirror row_mask:0xf bank_mask:0x3
    v_add_f32_dpp v45, v43, v43 row_mirror row_mask:0xf bank_mask:0xc
    v_add_f32_dpp v46, v44, v44 row_half_mirror row_mask:0xf bank_mask:0x5
    s_nop 0
    v_add_f32_dpp v46, v45, v45 row_half_mirror row_mask:0xf bank_mask:0xa
    s_waitcnt vmcnt(5)
    v_dot2_f32_bf16 v41, v148, v8, 0
    v_dot2_f32_bf16 v41, v149, v9, v41
    v_dot2_f32_bf16 v41, v150, v10, v41
    v_dot2_f32_bf16 v41, v151, v11, v41
    buffer_load_dwordx4 v[180:183], v2, s[8:11], s60 offen offset:3072 nt
    s_waitcnt vmcnt(5)
    v_dot2_f32_bf16 v42, v152, v8, 0
    v_dot2_f32_bf16 v42, v153, v9, v42
    v_dot2_f32_bf16 v42, v154, v10, v42
    v_dot2_f32_bf16 v42, v155, v11, v42
    s_xor_b32 s60, s63, 540672
    buffer_load_dwordx4 v[64:67], v2, s[8:11], s60 offen offset:0 nt
    v_add_f32_dpp v44, v40, v40 row_mirror row_mask:0xf bank_mask:0x3
    v_add_f32_dpp v44, v41, v41 row_mirror row_mask:0xf bank_mask:0xc
    s_waitcnt vmcnt(5)
    v_dot2_f32_bf16 v43, v156, v8, 0
    v_dot2_f32_bf16 v43, v157, v9, v43
    v_dot2_f32_bf16 v43, v158, v10, v43
    v_dot2_f32_bf16 v43, v159, v11, v43
    buffer_load_dwordx4 v[68:71], v2, s[8:11], s60 offen offset:1024 nt
    s_waitcnt vmcnt(5)
    v_dot2_f32_bf16 v40, v168, v8, 0
    v_dot2_f32_bf16 v40, v169, v9, v40
    v_dot2_f32_bf16 v40, v170, v10, v40
    v_dot2_f32_bf16 v40, v171, v11, v40
    buffer_load_dwordx4 v[72:75], v2, s[8:11], s60 offen offset:2048 nt
    v_add_f32_dpp v45, v42, v42 row_mirror row_mask:0xf bank_mask:0x3
    v_add_f32_dpp v45, v43, v43 row_mirror row_mask:0xf bank_mask:0xc
    v_add_f32_dpp v47, v44, v44 row_half_mirror row_mask:0xf bank_mask:0x5
    s_nop 0
    v_add_f32_dpp v47, v45, v45 row_half_mirror row_mask:0xf bank_mask:0xa
    v_cndmask_b32 v50, v46, v47, s[56:57]
    v_cndmask_b32 v51, v47, v46, s[56:57]
    s_nop 1
    v_add_f32_dpp v49, v51, v50 quad_perm:[2,3,0,1] row_mask:0xf bank_mask:0xf
    v_cndmask_b32 v50, v48, v49, s[58:59]
    v_cndmask_b32 v51, v49, v48, s[58:59]
    s_nop 1
    v_add_f32_dpp v31, v51, v50 quad_perm:[1,0,3,2] row_mask:0xf bank_mask:0xf
    v_cvt_pk_bf16_f32 v31, v31, v31
    v_and_b32 v31, 0xffff0000, v31
    v_mul_f32 v31, s92, v31
    v_cvt_pk_bf16_f32 v31, v31, v31
    v_and_b32 v31, 0xffff0000, v31
    v_max_f32 v58, v58, v31
    s_waitcnt vmcnt(5)
    v_dot2_f32_bf16 v41, v172, v8, 0
    v_dot2_f32_bf16 v41, v173, v9, v41
    v_dot2_f32_bf16 v41, v174, v10, v41
    v_dot2_f32_bf16 v41, v175, v11, v41
    buffer_load_dwordx4 v[76:79], v2, s[8:11], s60 offen offset:3072 nt
    s_waitcnt vmcnt(5)
    v_dot2_f32_bf16 v42, v176, v8, 0
    v_dot2_f32_bf16 v42, v177, v9, v42
    v_dot2_f32_bf16 v42, v178, v10, v42
    v_dot2_f32_bf16 v42, v179, v11, v42
    s_xor_b32 s60, s63, 557056
    buffer_load_dwordx4 v[80:83], v2, s[8:11], s60 offen offset:0 nt
    v_add_f32_dpp v44, v40, v40 row_mirror row_mask:0xf bank_mask:0x3
    v_add_f32_dpp v44, v41, v41 row_mirror row_mask:0xf bank_mask:0xc
    s_waitcnt vmcnt(5)
    v_dot2_f32_bf16 v43, v180, v8, 0
    v_dot2_f32_bf16 v43, v181, v9, v43
    v_dot2_f32_bf16 v43, v182, v10, v43
    v_dot2_f32_bf16 v43, v183, v11, v43
    buffer_load_dwordx4 v[84:87], v2, s[8:11], s60 offen offset:1024 nt
    s_waitcnt vmcnt(5)
    v_dot2_f32_bf16 v40, v64, v8, 0
    v_dot2_f32_bf16 v40, v65, v9, v40
    v_dot2_f32_bf16 v40, v66, v10, v40
    v_dot2_f32_bf16 v40, v67, v11, v40
    buffer_load_dwordx4 v[88:91], v2, s[8:11], s60 offen offset:2048 nt
    v_add_f32_dpp v45, v42, v42 row_mirror row_mask:0xf bank_mask:0x3
    v_add_f32_dpp v45, v43, v43 row_mirror row_mask:0xf bank_mask:0xc
    v_add_f32_dpp v46, v44, v44 row_half_mirror row_mask:0xf bank_mask:0x5
    s_nop 0
    v_add_f32_dpp v46, v45, v45 row_half_mirror row_mask:0xf bank_mask:0xa
    s_waitcnt vmcnt(5)
    v_dot2_f32_bf16 v41, v68, v8, 0
    v_dot2_f32_bf16 v41, v69, v9, v41
    v_dot2_f32_bf16 v41, v70, v10, v41
    v_dot2_f32_bf16 v41, v71, v11, v41
    buffer_load_dwordx4 v[92:95], v2, s[8:11], s60 offen offset:3072 nt
    s_waitcnt vmcnt(5)
    v_dot2_f32_bf16 v42, v72, v8, 0
    v_dot2_f32_bf16 v42, v73, v9, v42
    v_dot2_f32_bf16 v42, v74, v10, v42
    v_dot2_f32_bf16 v42, v75, v11, v42
    s_xor_b32 s60, s63, 573440
    buffer_load_dwordx4 v[96:99], v2, s[8:11], s60 offen offset:0 nt
    v_add_f32_dpp v44, v40, v40 row_mirror row_mask:0xf bank_mask:0x3
    v_add_f32_dpp v44, v41, v41 row_mirror row_mask:0xf bank_mask:0xc
    s_waitcnt vmcnt(5)
    v_dot2_f32_bf16 v43, v76, v8, 0
    v_dot2_f32_bf16 v43, v77, v9, v43
    v_dot2_f32_bf16 v43, v78, v10, v43
    v_dot2_f32_bf16 v43, v79, v11, v43
    buffer_load_dwordx4 v[100:103], v2, s[8:11], s60 offen offset:1024 nt
    s_waitcnt vmcnt(5)
    v_dot2_f32_bf16 v40, v80, v8, 0
    v_dot2_f32_bf16 v40, v81, v9, v40
    v_dot2_f32_bf16 v40, v82, v10, v40
    v_dot2_f32_bf16 v40, v83, v11, v40
    buffer_load_dwordx4 v[104:107], v2, s[8:11], s60 offen offset:2048 nt
    v_add_f32_dpp v45, v42, v42 row_mirror row_mask:0xf bank_mask:0x3
    v_add_f32_dpp v45, v43, v43 row_mirror row_mask:0xf bank_mask:0xc
    v_add_f32_dpp v47, v44, v44 row_half_mirror row_mask:0xf bank_mask:0x5
    s_nop 0
    v_add_f32_dpp v47, v45, v45 row_half_mirror row_mask:0xf bank_mask:0xa
    v_cndmask_b32 v50, v46, v47, s[56:57]
    v_cndmask_b32 v51, v47, v46, s[56:57]
    s_nop 1
    v_add_f32_dpp v48, v51, v50 quad_perm:[2,3,0,1] row_mask:0xf bank_mask:0xf
    s_waitcnt vmcnt(5)
    v_dot2_f32_bf16 v41, v84, v8, 0
    v_dot2_f32_bf16 v41, v85, v9, v41
    v_dot2_f32_bf16 v41, v86, v10, v41
    v_dot2_f32_bf16 v41, v87, v11, v41
    buffer_load_dwordx4 v[108:111], v2, s[8:11], s60 offen offset:3072 nt
    s_waitcnt vmcnt(5)
    v_dot2_f32_bf16 v42, v88, v8, 0
    v_dot2_f32_bf16 v42, v89, v9, v42
    v_dot2_f32_bf16 v42, v90, v10, v42
    v_dot2_f32_bf16 v42, v91, v11, v42
    s_xor_b32 s60, s63, 589824
    buffer_load_dwordx4 v[112:115], v2, s[8:11], s60 offen offset:0 nt
    v_add_f32_dpp v44, v40, v40 row_mirror row_mask:0xf bank_mask:0x3
    v_add_f32_dpp v44, v41, v41 row_mirror row_mask:0xf bank_mask:0xc
    s_waitcnt vmcnt(5)
    v_dot2_f32_bf16 v43, v92, v8, 0
    v_dot2_f32_bf16 v43, v93, v9, v43
    v_dot2_f32_bf16 v43, v94, v10, v43
    v_dot2_f32_bf16 v43, v95, v11, v43
    buffer_load_dwordx4 v[116:119], v2, s[8:11], s60 offen offset:1024 nt
    s_waitcnt vmcnt(5)
    v_dot2_f32_bf16 v40, v96, v8, 0
    v_dot2_f32_bf16 v40, v97, v9, v40
    v_dot2_f32_bf16 v40, v98, v10, v40
    v_dot2_f32_bf16 v40, v99, v11, v40
    buffer_load_dwordx4 v[120:123], v2, s[8:11], s60 offen offset:2048 nt
    v_add_f32_dpp v45, v42, v42 row_mirror row_mask:0xf bank_mask:0x3
    v_add_f32_dpp v45, v43, v43 row_mirror row_mask:0xf bank_mask:0xc
    v_add_f32_dpp v46, v44, v44 row_half_mirror row_mask:0xf bank_mask:0x5
    s_nop 0
    v_add_f32_dpp v46, v45, v45 row_half_mirror row_mask:0xf bank_mask:0xa
    s_waitcnt vmcnt(5)
    v_dot2_f32_bf16 v41, v100, v8, 0
    v_dot2_f32_bf16 v41, v101, v9, v41
    v_dot2_f32_bf16 v41, v102, v10, v41
    v_dot2_f32_bf16 v41, v103, v11, v41
    buffer_load_dwordx4 v[124:127], v2, s[8:11], s60 offen offset:3072 nt
    s_waitcnt vmcnt(5)
    v_dot2_f32_bf16 v42, v104, v8, 0
    v_dot2_f32_bf16 v42, v105, v9, v42
    v_dot2_f32_bf16 v42, v106, v10, v42
    v_dot2_f32_bf16 v42, v107, v11, v42
    s_xor_b32 s60, s63, 606208
    buffer_load_dwordx4 v[144:147], v2, s[8:11], s60 offen offset:0 nt
    v_add_f32_dpp v44, v40, v40 row_mirror row_mask:0xf bank_mask:0x3
    v_add_f32_dpp v44, v41, v41 row_mirror row_mask:0xf bank_mask:0xc
    s_waitcnt vmcnt(5)
    v_dot2_f32_bf16 v43, v108, v8, 0
    v_dot2_f32_bf16 v43, v109, v9, v43
    v_dot2_f32_bf16 v43, v110, v10, v43
    v_dot2_f32_bf16 v43, v111, v11, v43
    buffer_load_dwordx4 v[164:167], v2, s[8:11], s60 offen offset:1024 nt
    s_waitcnt vmcnt(5)
    v_dot2_f32_bf16 v40, v112, v8, 0
    v_dot2_f32_bf16 v40, v113, v9, v40
    v_dot2_f32_bf16 v40, v114, v10, v40
    v_dot2_f32_bf16 v40, v115, v11, v40
    buffer_load_dwordx4 v[184:187], v2, s[8:11], s60 offen offset:2048 nt
    v_add_f32_dpp v45, v42, v42 row_mirror row_mask:0xf bank_mask:0x3
    v_add_f32_dpp v45, v43, v43 row_mirror row_mask:0xf bank_mask:0xc
    v_add_f32_dpp v47, v44, v44 row_half_mirror row_mask:0xf bank_mask:0x5
    s_nop 0
    v_add_f32_dpp v47, v45, v45 row_half_mirror row_mask:0xf bank_mask:0xa
    v_cndmask_b32 v50, v46, v47, s[56:57]
    v_cndmask_b32 v51, v47, v46, s[56:57]
    s_nop 1
    v_add_f32_dpp v49, v51, v50 quad_perm:[2,3,0,1] row_mask:0xf bank_mask:0xf
    v_cndmask_b32 v50, v48, v49, s[58:59]
    v_cndmask_b32 v51, v49, v48, s[58:59]
    s_nop 1
    v_add_f32_dpp v32, v51, v50 quad_perm:[1,0,3,2] row_mask:0xf bank_mask:0xf
    v_cvt_pk_bf16_f32 v32, v32, v32
    v_and_b32 v32, 0xffff0000, v32
    v_mul_f32 v32, s92, v32
    v_cvt_pk_bf16_f32 v32, v32, v32
    v_and_b32 v32, 0xffff0000, v32
    v_max_f32 v58, v58, v32
    s_waitcnt vmcnt(5)
    v_dot2_f32_bf16 v41, v116, v8, 0
    v_dot2_f32_bf16 v41, v117, v9, v41
    v_dot2_f32_bf16 v41, v118, v10, v41
    v_dot2_f32_bf16 v41, v119, v11, v41
    buffer_load_dwordx4 v[204:207], v2, s[8:11], s60 offen offset:3072 nt
    s_waitcnt vmcnt(5)
    v_dot2_f32_bf16 v42, v120, v8, 0
    v_dot2_f32_bf16 v42, v121, v9, v42
    v_dot2_f32_bf16 v42, v122, v10, v42
    v_dot2_f32_bf16 v42, v123, v11, v42
    s_xor_b32 s60, s63, 622592
    buffer_load_dwordx4 v[224:227], v2, s[8:11], s60 offen offset:0 nt
    v_add_f32_dpp v44, v40, v40 row_mirror row_mask:0xf bank_mask:0x3
    v_add_f32_dpp v44, v41, v41 row_mirror row_mask:0xf bank_mask:0xc
    s_waitcnt vmcnt(5)
    v_dot2_f32_bf16 v43, v124, v8, 0
    v_dot2_f32_bf16 v43, v125, v9, v43
    v_dot2_f32_bf16 v43, v126, v10, v43
    v_dot2_f32_bf16 v43, v127, v11, v43
    buffer_load_dwordx4 v[244:247], v2, s[8:11], s60 offen offset:1024 nt
    s_waitcnt vmcnt(5)
    v_dot2_f32_bf16 v40, v144, v8, 0
    v_dot2_f32_bf16 v40, v145, v9, v40
    v_dot2_f32_bf16 v40, v146, v10, v40
    v_dot2_f32_bf16 v40, v147, v11, v40
    buffer_load_dwordx4 v[136:139], v2, s[8:11], s60 offen offset:2048 nt
    v_add_f32_dpp v45, v42, v42 row_mirror row_mask:0xf bank_mask:0x3
    v_add_f32_dpp v45, v43, v43 row_mirror row_mask:0xf bank_mask:0xc
    v_add_f32_dpp v46, v44, v44 row_half_mirror row_mask:0xf bank_mask:0x5
    s_nop 0
    v_add_f32_dpp v46, v45, v45 row_half_mirror row_mask:0xf bank_mask:0xa
    s_waitcnt vmcnt(5)
    v_dot2_f32_bf16 v41, v164, v8, 0
    v_dot2_f32_bf16 v41, v165, v9, v41
    v_dot2_f32_bf16 v41, v166, v10, v41
    v_dot2_f32_bf16 v41, v167, v11, v41
    buffer_load_dwordx4 v[160:163], v2, s[8:11], s60 offen offset:3072 nt
    s_waitcnt vmcnt(5)
    v_dot2_f32_bf16 v42, v184, v8, 0
    v_dot2_f32_bf16 v42, v185, v9, v42
    v_dot2_f32_bf16 v42, v186, v10, v42
    v_dot2_f32_bf16 v42, v187, v11, v42
    s_xor_b32 s60, s63, 638976
    buffer_load_dwordx4 v[188:191], v2, s[8:11], s60 offen offset:0 nt
    v_add_f32_dpp v44, v40, v40 row_mirror row_mask:0xf bank_mask:0x3
    v_add_f32_dpp v44, v41, v41 row_mirror row_mask:0xf bank_mask:0xc
    s_waitcnt vmcnt(5)
    v_dot2_f32_bf16 v43, v204, v8, 0
    v_dot2_f32_bf16 v43, v205, v9, v43
    v_dot2_f32_bf16 v43, v206, v10, v43
    v_dot2_f32_bf16 v43, v207, v11, v43
    buffer_load_dwordx4 v[192:195], v2, s[8:11], s60 offen offset:1024 nt
    s_waitcnt vmcnt(5)
    v_dot2_f32_bf16 v40, v224, v8, 0
    v_dot2_f32_bf16 v40, v225, v9, v40
    v_dot2_f32_bf16 v40, v226, v10, v40
    v_dot2_f32_bf16 v40, v227, v11, v40
    buffer_load_dwordx4 v[196:199], v2, s[8:11], s60 offen offset:2048 nt
    v_add_f32_dpp v45, v42, v42 row_mirror row_mask:0xf bank_mask:0x3
    v_add_f32_dpp v45, v43, v43 row_mirror row_mask:0xf bank_mask:0xc
    v_add_f32_dpp v47, v44, v44 row_half_mirror row_mask:0xf bank_mask:0x5
    s_nop 0
    v_add_f32_dpp v47, v45, v45 row_half_mirror row_mask:0xf bank_mask:0xa
    v_cndmask_b32 v50, v46, v47, s[56:57]
    v_cndmask_b32 v51, v47, v46, s[56:57]
    s_nop 1
    v_add_f32_dpp v48, v51, v50 quad_perm:[2,3,0,1] row_mask:0xf bank_mask:0xf
    s_waitcnt vmcnt(5)
    v_dot2_f32_bf16 v41, v244, v8, 0
    v_dot2_f32_bf16 v41, v245, v9, v41
    v_dot2_f32_bf16 v41, v246, v10, v41
    v_dot2_f32_bf16 v41, v247, v11, v41
    buffer_load_dwordx4 v[200:203], v2, s[8:11], s60 offen offset:3072 nt
    s_waitcnt vmcnt(5)
    v_dot2_f32_bf16 v42, v136, v8, 0
    v_dot2_f32_bf16 v42, v137, v9, v42
    v_dot2_f32_bf16 v42, v138, v10, v42
    v_dot2_f32_bf16 v42, v139, v11, v42
    s_xor_b32 s60, s63, 655360
    buffer_load_dwordx4 v[208:211], v2, s[8:11], s60 offen offset:0 nt
    v_add_f32_dpp v44, v40, v40 row_mirror row_mask:0xf bank_mask:0x3
    v_add_f32_dpp v44, v41, v41 row_mirror row_mask:0xf bank_mask:0xc
    s_waitcnt vmcnt(5)
    v_dot2_f32_bf16 v43, v160, v8, 0
    v_dot2_f32_bf16 v43, v161, v9, v43
    v_dot2_f32_bf16 v43, v162, v10, v43
    v_dot2_f32_bf16 v43, v163, v11, v43
    buffer_load_dwordx4 v[212:215], v2, s[8:11], s60 offen offset:1024 nt
    s_waitcnt vmcnt(5)
    v_dot2_f32_bf16 v40, v188, v8, 0
    v_dot2_f32_bf16 v40, v189, v9, v40
    v_dot2_f32_bf16 v40, v190, v10, v40
    v_dot2_f32_bf16 v40, v191, v11, v40
    buffer_load_dwordx4 v[216:219], v2, s[8:11], s60 offen offset:2048 nt
    v_add_f32_dpp v45, v42, v42 row_mirror row_mask:0xf bank_mask:0x3
    v_add_f32_dpp v45, v43, v43 row_mirror row_mask:0xf bank_mask:0xc
    v_add_f32_dpp v46, v44, v44 row_half_mirror row_mask:0xf bank_mask:0x5
    s_nop 0
    v_add_f32_dpp v46, v45, v45 row_half_mirror row_mask:0xf bank_mask:0xa
    s_waitcnt vmcnt(5)
    v_dot2_f32_bf16 v41, v192, v8, 0
    v_dot2_f32_bf16 v41, v193, v9, v41
    v_dot2_f32_bf16 v41, v194, v10, v41
    v_dot2_f32_bf16 v41, v195, v11, v41
    buffer_load_dwordx4 v[220:223], v2, s[8:11], s60 offen offset:3072 nt
    s_waitcnt vmcnt(5)
    v_dot2_f32_bf16 v42, v196, v8, 0
    v_dot2_f32_bf16 v42, v197, v9, v42
    v_dot2_f32_bf16 v42, v198, v10, v42
    v_dot2_f32_bf16 v42, v199, v11, v42
    s_xor_b32 s60, s63, 671744
    buffer_load_dwordx4 v[228:231], v2, s[8:11], s60 offen offset:0 nt
    v_add_f32_dpp v44, v40, v40 row_mirror row_mask:0xf bank_mask:0x3
    v_add_f32_dpp v44, v41, v41 row_mirror row_mask:0xf bank_mask:0xc
    s_waitcnt vmcnt(5)
    v_dot2_f32_bf16 v43, v200, v8, 0
    v_dot2_f32_bf16 v43, v201, v9, v43
    v_dot2_f32_bf16 v43, v202, v10, v43
    v_dot2_f32_bf16 v43, v203, v11, v43
    buffer_load_dwordx4 v[232:235], v2, s[8:11], s60 offen offset:1024 nt
    s_waitcnt vmcnt(5)
    v_dot2_f32_bf16 v40, v208, v8, 0
    v_dot2_f32_bf16 v40, v209, v9, v40
    v_dot2_f32_bf16 v40, v210, v10, v40
    v_dot2_f32_bf16 v40, v211, v11, v40
    buffer_load_dwordx4 v[236:239], v2, s[8:11], s60 offen offset:2048 nt
    v_add_f32_dpp v45, v42, v42 row_mirror row_mask:0xf bank_mask:0x3
    v_add_f32_dpp v45, v43, v43 row_mirror row_mask:0xf bank_mask:0xc
    v_add_f32_dpp v47, v44, v44 row_half_mirror row_mask:0xf bank_mask:0x5
    s_nop 0
    v_add_f32_dpp v47, v45, v45 row_half_mirror row_mask:0xf bank_mask:0xa
    v_cndmask_b32 v50, v46, v47, s[56:57]
    v_cndmask_b32 v51, v47, v46, s[56:57]
    s_nop 1
    v_add_f32_dpp v49, v51, v50 quad_perm:[2,3,0,1] row_mask:0xf bank_mask:0xf
    v_cndmask_b32 v50, v48, v49, s[58:59]
    v_cndmask_b32 v51, v49, v48, s[58:59]
    s_nop 1
    v_add_f32_dpp v33, v51, v50 quad_perm:[1,0,3,2] row_mask:0xf bank_mask:0xf
    v_cvt_pk_bf16_f32 v33, v33, v33
    v_and_b32 v33, 0xffff0000, v33
    v_mul_f32 v33, s92, v33
    v_cvt_pk_bf16_f32 v33, v33, v33
    v_and_b32 v33, 0xffff0000, v33
    v_max_f32 v58, v58, v33
    s_waitcnt vmcnt(5)
    v_dot2_f32_bf16 v41, v212, v8, 0
    v_dot2_f32_bf16 v41, v213, v9, v41
    v_dot2_f32_bf16 v41, v214, v10, v41
    v_dot2_f32_bf16 v41, v215, v11, v41
    buffer_load_dwordx4 v[240:243], v2, s[8:11], s60 offen offset:3072 nt
    s_waitcnt vmcnt(5)
    v_dot2_f32_bf16 v42, v216, v8, 0
    v_dot2_f32_bf16 v42, v217, v9, v42
    v_dot2_f32_bf16 v42, v218, v10, v42
    v_dot2_f32_bf16 v42, v219, v11, v42
    s_xor_b32 s60, s63, 688128
    buffer_load_dwordx4 v[248:251], v2, s[8:11], s60 offen offset:0 nt
    v_add_f32_dpp v44, v40, v40 row_mirror row_mask:0xf bank_mask:0x3
    v_add_f32_dpp v44, v41, v41 row_mirror row_mask:0xf bank_mask:0xc
    s_waitcnt vmcnt(5)
    v_dot2_f32_bf16 v43, v220, v8, 0
    v_dot2_f32_bf16 v43, v221, v9, v43
    v_dot2_f32_bf16 v43, v222, v10, v43
    v_dot2_f32_bf16 v43, v223, v11, v43
    buffer_load_dwordx4 v[252:255], v2, s[8:11], s60 offen offset:1024 nt
    s_waitcnt vmcnt(5)
    v_dot2_f32_bf16 v40, v228, v8, 0
    v_dot2_f32_bf16 v40, v229, v9, v40
    v_dot2_f32_bf16 v40, v230, v10, v40
    v_dot2_f32_bf16 v40, v231, v11, v40
    buffer_load_dwordx4 v[128:131], v2, s[8:11], s60 offen offset:2048 nt
    v_add_f32_dpp v45, v42, v42 row_mirror row_mask:0xf bank_mask:0x3
    v_add_f32_dpp v45, v43, v43 row_mirror row_mask:0xf bank_mask:0xc
    v_add_f32_dpp v46, v44, v44 row_half_mirror row_mask:0xf bank_mask:0x5
    s_nop 0
    v_add_f32_dpp v46, v45, v45 row_half_mirror row_mask:0xf bank_mask:0xa
    s_waitcnt vmcnt(5)
    v_dot2_f32_bf16 v41, v232, v8, 0
    v_dot2_f32_bf16 v41, v233, v9, v41
    v_dot2_f32_bf16 v41, v234, v10, v41
    v_dot2_f32_bf16 v41, v235, v11, v41
    buffer_load_dwordx4 v[132:135], v2, s[8:11], s60 offen offset:3072 nt
    s_waitcnt vmcnt(5)
    v_dot2_f32_bf16 v42, v236, v8, 0
    v_dot2_f32_bf16 v42, v237, v9, v42
    v_dot2_f32_bf16 v42, v238, v10, v42
    v_dot2_f32_bf16 v42, v239, v11, v42
    s_xor_b32 s60, s63, 704512
    buffer_load_dwordx4 v[140:143], v2, s[8:11], s60 offen offset:0 nt
    v_add_f32_dpp v44, v40, v40 row_mirror row_mask:0xf bank_mask:0x3
    v_add_f32_dpp v44, v41, v41 row_mirror row_mask:0xf bank_mask:0xc
    s_waitcnt vmcnt(5)
    v_dot2_f32_bf16 v43, v240, v8, 0
    v_dot2_f32_bf16 v43, v241, v9, v43
    v_dot2_f32_bf16 v43, v242, v10, v43
    v_dot2_f32_bf16 v43, v243, v11, v43
    buffer_load_dwordx4 v[148:151], v2, s[8:11], s60 offen offset:1024 nt
    s_waitcnt vmcnt(5)
    v_dot2_f32_bf16 v40, v248, v8, 0
    v_dot2_f32_bf16 v40, v249, v9, v40
    v_dot2_f32_bf16 v40, v250, v10, v40
    v_dot2_f32_bf16 v40, v251, v11, v40
    buffer_load_dwordx4 v[152:155], v2, s[8:11], s60 offen offset:2048 nt
    v_add_f32_dpp v45, v42, v42 row_mirror row_mask:0xf bank_mask:0x3
    v_add_f32_dpp v45, v43, v43 row_mirror row_mask:0xf bank_mask:0xc
    v_add_f32_dpp v47, v44, v44 row_half_mirror row_mask:0xf bank_mask:0x5
    s_nop 0
    v_add_f32_dpp v47, v45, v45 row_half_mirror row_mask:0xf bank_mask:0xa
    v_cndmask_b32 v50, v46, v47, s[56:57]
    v_cndmask_b32 v51, v47, v46, s[56:57]
    s_nop 1
    v_add_f32_dpp v48, v51, v50 quad_perm:[2,3,0,1] row_mask:0xf bank_mask:0xf
    s_waitcnt vmcnt(5)
    v_dot2_f32_bf16 v41, v252, v8, 0
    v_dot2_f32_bf16 v41, v253, v9, v41
    v_dot2_f32_bf16 v41, v254, v10, v41
    v_dot2_f32_bf16 v41, v255, v11, v41
    buffer_load_dwordx4 v[156:159], v2, s[8:11], s60 offen offset:3072 nt
    s_waitcnt vmcnt(5)
    v_dot2_f32_bf16 v42, v128, v8, 0
    v_dot2_f32_bf16 v42, v129, v9, v42
    v_dot2_f32_bf16 v42, v130, v10, v42
    v_dot2_f32_bf16 v42, v131, v11, v42
    s_xor_b32 s60, s63, 720896
    buffer_load_dwordx4 v[168:171], v2, s[8:11], s60 offen offset:0 nt
    v_add_f32_dpp v44, v40, v40 row_mirror row_mask:0xf bank_mask:0x3
    v_add_f32_dpp v44, v41, v41 row_mirror row_mask:0xf bank_mask:0xc
    s_waitcnt vmcnt(5)
    v_dot2_f32_bf16 v43, v132, v8, 0
    v_dot2_f32_bf16 v43, v133, v9, v43
    v_dot2_f32_bf16 v43, v134, v10, v43
    v_dot2_f32_bf16 v43, v135, v11, v43
    buffer_load_dwordx4 v[172:175], v2, s[8:11], s60 offen offset:1024 nt
    s_waitcnt vmcnt(5)
    v_dot2_f32_bf16 v40, v140, v8, 0
    v_dot2_f32_bf16 v40, v141, v9, v40
    v_dot2_f32_bf16 v40, v142, v10, v40
    v_dot2_f32_bf16 v40, v143, v11, v40
    buffer_load_dwordx4 v[176:179], v2, s[8:11], s60 offen offset:2048 nt
    v_add_f32_dpp v45, v42, v42 row_mirror row_mask:0xf bank_mask:0x3
    v_add_f32_dpp v45, v43, v43 row_mirror row_mask:0xf bank_mask:0xc
    v_add_f32_dpp v46, v44, v44 row_half_mirror row_mask:0xf bank_mask:0x5
    s_nop 0
    v_add_f32_dpp v46, v45, v45 row_half_mirror row_mask:0xf bank_mask:0xa
    s_waitcnt vmcnt(5)
    v_dot2_f32_bf16 v41, v148, v8, 0
    v_dot2_f32_bf16 v41, v149, v9, v41
    v_dot2_f32_bf16 v41, v150, v10, v41
    v_dot2_f32_bf16 v41, v151, v11, v41
    buffer_load_dwordx4 v[180:183], v2, s[8:11], s60 offen offset:3072 nt
    s_waitcnt vmcnt(5)
    v_dot2_f32_bf16 v42, v152, v8, 0
    v_dot2_f32_bf16 v42, v153, v9, v42
    v_dot2_f32_bf16 v42, v154, v10, v42
    v_dot2_f32_bf16 v42, v155, v11, v42
    s_xor_b32 s60, s63, 737280
    buffer_load_dwordx4 v[64:67], v2, s[8:11], s60 offen offset:0 nt
    v_add_f32_dpp v44, v40, v40 row_mirror row_mask:0xf bank_mask:0x3
    v_add_f32_dpp v44, v41, v41 row_mirror row_mask:0xf bank_mask:0xc
    s_waitcnt vmcnt(5)
    v_dot2_f32_bf16 v43, v156, v8, 0
    v_dot2_f32_bf16 v43, v157, v9, v43
    v_dot2_f32_bf16 v43, v158, v10, v43
    v_dot2_f32_bf16 v43, v159, v11, v43
    buffer_load_dwordx4 v[68:71], v2, s[8:11], s60 offen offset:1024 nt
    s_waitcnt vmcnt(5)
    v_dot2_f32_bf16 v40, v168, v8, 0
    v_dot2_f32_bf16 v40, v169, v9, v40
    v_dot2_f32_bf16 v40, v170, v10, v40
    v_dot2_f32_bf16 v40, v171, v11, v40
    buffer_load_dwordx4 v[72:75], v2, s[8:11], s60 offen offset:2048 nt
    v_add_f32_dpp v45, v42, v42 row_mirror row_mask:0xf bank_mask:0x3
    v_add_f32_dpp v45, v43, v43 row_mirror row_mask:0xf bank_mask:0xc
    v_add_f32_dpp v47, v44, v44 row_half_mirror row_mask:0xf bank_mask:0x5
    s_nop 0
    v_add_f32_dpp v47, v45, v45 row_half_mirror row_mask:0xf bank_mask:0xa
    v_cndmask_b32 v50, v46, v47, s[56:57]
    v_cndmask_b32 v51, v47, v46, s[56:57]
    s_nop 1
    v_add_f32_dpp v49, v51, v50 quad_perm:[2,3,0,1] row_mask:0xf bank_mask:0xf
    v_cndmask_b32 v50, v48, v49, s[58:59]
    v_cndmask_b32 v51, v49, v48, s[58:59]
    s_nop 1
    v_add_f32_dpp v34, v51, v50 quad_perm:[1,0,3,2] row_mask:0xf bank_mask:0xf
    v_cvt_pk_bf16_f32 v34, v34, v34
    v_and_b32 v34, 0xffff0000, v34
    v_mul_f32 v34, s92, v34
    v_cvt_pk_bf16_f32 v34, v34, v34
    v_and_b32 v34, 0xffff0000, v34
    v_max_f32 v58, v58, v34
    s_waitcnt vmcnt(5)
    v_dot2_f32_bf16 v41, v172, v8, 0
    v_dot2_f32_bf16 v41, v173, v9, v41
    v_dot2_f32_bf16 v41, v174, v10, v41
    v_dot2_f32_bf16 v41, v175, v11, v41
    buffer_load_dwordx4 v[76:79], v2, s[8:11], s60 offen offset:3072 nt
    s_waitcnt vmcnt(5)
    v_dot2_f32_bf16 v42, v176, v8, 0
    v_dot2_f32_bf16 v42, v177, v9, v42
    v_dot2_f32_bf16 v42, v178, v10, v42
    v_dot2_f32_bf16 v42, v179, v11, v42
    s_xor_b32 s60, s63, 753664
    buffer_load_dwordx4 v[80:83], v2, s[8:11], s60 offen offset:0 nt
    v_add_f32_dpp v44, v40, v40 row_mirror row_mask:0xf bank_mask:0x3
    v_add_f32_dpp v44, v41, v41 row_mirror row_mask:0xf bank_mask:0xc
    s_waitcnt vmcnt(5)
    v_dot2_f32_bf16 v43, v180, v8, 0
    v_dot2_f32_bf16 v43, v181, v9, v43
    v_dot2_f32_bf16 v43, v182, v10, v43
    v_dot2_f32_bf16 v43, v183, v11, v43
    buffer_load_dwordx4 v[84:87], v2, s[8:11], s60 offen offset:1024 nt
    s_waitcnt vmcnt(5)
    v_dot2_f32_bf16 v40, v64, v8, 0
    v_dot2_f32_bf16 v40, v65, v9, v40
    v_dot2_f32_bf16 v40, v66, v10, v40
    v_dot2_f32_bf16 v40, v67, v11, v40
    buffer_load_dwordx4 v[88:91], v2, s[8:11], s60 offen offset:2048 nt
    v_add_f32_dpp v45, v42, v42 row_mirror row_mask:0xf bank_mask:0x3
    v_add_f32_dpp v45, v43, v43 row_mirror row_mask:0xf bank_mask:0xc
    v_add_f32_dpp v46, v44, v44 row_half_mirror row_mask:0xf bank_mask:0x5
    s_nop 0
    v_add_f32_dpp v46, v45, v45 row_half_mirror row_mask:0xf bank_mask:0xa
    s_waitcnt vmcnt(5)
    v_dot2_f32_bf16 v41, v68, v8, 0
    v_dot2_f32_bf16 v41, v69, v9, v41
    v_dot2_f32_bf16 v41, v70, v10, v41
    v_dot2_f32_bf16 v41, v71, v11, v41
    buffer_load_dwordx4 v[92:95], v2, s[8:11], s60 offen offset:3072 nt
    s_waitcnt vmcnt(5)
    v_dot2_f32_bf16 v42, v72, v8, 0
    v_dot2_f32_bf16 v42, v73, v9, v42
    v_dot2_f32_bf16 v42, v74, v10, v42
    v_dot2_f32_bf16 v42, v75, v11, v42
    s_xor_b32 s60, s63, 770048
    buffer_load_dwordx4 v[96:99], v2, s[8:11], s60 offen offset:0 nt
    v_add_f32_dpp v44, v40, v40 row_mirror row_mask:0xf bank_mask:0x3
    v_add_f32_dpp v44, v41, v41 row_mirror row_mask:0xf bank_mask:0xc
    s_waitcnt vmcnt(5)
    v_dot2_f32_bf16 v43, v76, v8, 0
    v_dot2_f32_bf16 v43, v77, v9, v43
    v_dot2_f32_bf16 v43, v78, v10, v43
    v_dot2_f32_bf16 v43, v79, v11, v43
    buffer_load_dwordx4 v[100:103], v2, s[8:11], s60 offen offset:1024 nt
    s_waitcnt vmcnt(5)
    v_dot2_f32_bf16 v40, v80, v8, 0
    v_dot2_f32_bf16 v40, v81, v9, v40
    v_dot2_f32_bf16 v40, v82, v10, v40
    v_dot2_f32_bf16 v40, v83, v11, v40
    buffer_load_dwordx4 v[104:107], v2, s[8:11], s60 offen offset:2048 nt
    v_add_f32_dpp v45, v42, v42 row_mirror row_mask:0xf bank_mask:0x3
    v_add_f32_dpp v45, v43, v43 row_mirror row_mask:0xf bank_mask:0xc
    v_add_f32_dpp v47, v44, v44 row_half_mirror row_mask:0xf bank_mask:0x5
    s_nop 0
    v_add_f32_dpp v47, v45, v45 row_half_mirror row_mask:0xf bank_mask:0xa
    v_cndmask_b32 v50, v46, v47, s[56:57]
    v_cndmask_b32 v51, v47, v46, s[56:57]
    s_nop 1
    v_add_f32_dpp v48, v51, v50 quad_perm:[2,3,0,1] row_mask:0xf bank_mask:0xf
    s_waitcnt vmcnt(5)
    v_dot2_f32_bf16 v41, v84, v8, 0
    v_dot2_f32_bf16 v41, v85, v9, v41
    v_dot2_f32_bf16 v41, v86, v10, v41
    v_dot2_f32_bf16 v41, v87, v11, v41
    buffer_load_dwordx4 v[108:111], v2, s[8:11], s60 offen offset:3072 nt
    s_waitcnt vmcnt(5)
    v_dot2_f32_bf16 v42, v88, v8, 0
    v_dot2_f32_bf16 v42, v89, v9, v42
    v_dot2_f32_bf16 v42, v90, v10, v42
    v_dot2_f32_bf16 v42, v91, v11, v42
    s_xor_b32 s60, s63, 786432
    buffer_load_dwordx4 v[112:115], v2, s[8:11], s60 offen offset:0 nt
    v_add_f32_dpp v44, v40, v40 row_mirror row_mask:0xf bank_mask:0x3
    v_add_f32_dpp v44, v41, v41 row_mirror row_mask:0xf bank_mask:0xc
    s_waitcnt vmcnt(5)
    v_dot2_f32_bf16 v43, v92, v8, 0
    v_dot2_f32_bf16 v43, v93, v9, v43
    v_dot2_f32_bf16 v43, v94, v10, v43
    v_dot2_f32_bf16 v43, v95, v11, v43
    buffer_load_dwordx4 v[116:119], v2, s[8:11], s60 offen offset:1024 nt
    s_waitcnt vmcnt(5)
    v_dot2_f32_bf16 v40, v96, v8, 0
    v_dot2_f32_bf16 v40, v97, v9, v40
    v_dot2_f32_bf16 v40, v98, v10, v40
    v_dot2_f32_bf16 v40, v99, v11, v40
    buffer_load_dwordx4 v[120:123], v2, s[8:11], s60 offen offset:2048 nt
    v_add_f32_dpp v45, v42, v42 row_mirror row_mask:0xf bank_mask:0x3
    v_add_f32_dpp v45, v43, v43 row_mirror row_mask:0xf bank_mask:0xc
    v_add_f32_dpp v46, v44, v44 row_half_mirror row_mask:0xf bank_mask:0x5
    s_nop 0
    v_add_f32_dpp v46, v45, v45 row_half_mirror row_mask:0xf bank_mask:0xa
    s_waitcnt vmcnt(5)
    v_dot2_f32_bf16 v41, v100, v8, 0
    v_dot2_f32_bf16 v41, v101, v9, v41
    v_dot2_f32_bf16 v41, v102, v10, v41
    v_dot2_f32_bf16 v41, v103, v11, v41
    buffer_load_dwordx4 v[124:127], v2, s[8:11], s60 offen offset:3072 nt
    s_waitcnt vmcnt(5)
    v_dot2_f32_bf16 v42, v104, v8, 0
    v_dot2_f32_bf16 v42, v105, v9, v42
    v_dot2_f32_bf16 v42, v106, v10, v42
    v_dot2_f32_bf16 v42, v107, v11, v42
    s_xor_b32 s60, s63, 802816
    buffer_load_dwordx4 v[144:147], v2, s[8:11], s60 offen offset:0 nt
    v_add_f32_dpp v44, v40, v40 row_mirror row_mask:0xf bank_mask:0x3
    v_add_f32_dpp v44, v41, v41 row_mirror row_mask:0xf bank_mask:0xc
    s_waitcnt vmcnt(5)
    v_dot2_f32_bf16 v43, v108, v8, 0
    v_dot2_f32_bf16 v43, v109, v9, v43
    v_dot2_f32_bf16 v43, v110, v10, v43
    v_dot2_f32_bf16 v43, v111, v11, v43
    buffer_load_dwordx4 v[164:167], v2, s[8:11], s60 offen offset:1024 nt
    s_waitcnt vmcnt(5)
    v_dot2_f32_bf16 v40, v112, v8, 0
    v_dot2_f32_bf16 v40, v113, v9, v40
    v_dot2_f32_bf16 v40, v114, v10, v40
    v_dot2_f32_bf16 v40, v115, v11, v40
    buffer_load_dwordx4 v[184:187], v2, s[8:11], s60 offen offset:2048 nt
    v_add_f32_dpp v45, v42, v42 row_mirror row_mask:0xf bank_mask:0x3
    v_add_f32_dpp v45, v43, v43 row_mirror row_mask:0xf bank_mask:0xc
    v_add_f32_dpp v47, v44, v44 row_half_mirror row_mask:0xf bank_mask:0x5
    s_nop 0
    v_add_f32_dpp v47, v45, v45 row_half_mirror row_mask:0xf bank_mask:0xa
    v_cndmask_b32 v50, v46, v47, s[56:57]
    v_cndmask_b32 v51, v47, v46, s[56:57]
    s_nop 1
    v_add_f32_dpp v49, v51, v50 quad_perm:[2,3,0,1] row_mask:0xf bank_mask:0xf
    v_cndmask_b32 v50, v48, v49, s[58:59]
    v_cndmask_b32 v51, v49, v48, s[58:59]
    s_nop 1
    v_add_f32_dpp v35, v51, v50 quad_perm:[1,0,3,2] row_mask:0xf bank_mask:0xf
    v_cvt_pk_bf16_f32 v35, v35, v35
    v_and_b32 v35, 0xffff0000, v35
    v_mul_f32 v35, s92, v35
    v_cvt_pk_bf16_f32 v35, v35, v35
    v_and_b32 v35, 0xffff0000, v35
    v_max_f32 v58, v58, v35
    s_waitcnt vmcnt(5)
    v_dot2_f32_bf16 v41, v116, v8, 0
    v_dot2_f32_bf16 v41, v117, v9, v41
    v_dot2_f32_bf16 v41, v118, v10, v41
    v_dot2_f32_bf16 v41, v119, v11, v41
    buffer_load_dwordx4 v[204:207], v2, s[8:11], s60 offen offset:3072 nt
    s_waitcnt vmcnt(5)
    v_dot2_f32_bf16 v42, v120, v8, 0
    v_dot2_f32_bf16 v42, v121, v9, v42
    v_dot2_f32_bf16 v42, v122, v10, v42
    v_dot2_f32_bf16 v42, v123, v11, v42
    s_xor_b32 s60, s63, 819200
    buffer_load_dwordx4 v[224:227], v2, s[8:11], s60 offen offset:0 nt
    v_add_f32_dpp v44, v40, v40 row_mirror row_mask:0xf bank_mask:0x3
    v_add_f32_dpp v44, v41, v41 row_mirror row_mask:0xf bank_mask:0xc
    s_waitcnt vmcnt(5)
    v_dot2_f32_bf16 v43, v124, v8, 0
    v_dot2_f32_bf16 v43, v125, v9, v43
    v_dot2_f32_bf16 v43, v126, v10, v43
    v_dot2_f32_bf16 v43, v127, v11, v43
    buffer_load_dwordx4 v[244:247], v2, s[8:11], s60 offen offset:1024 nt
    s_waitcnt vmcnt(5)
    v_dot2_f32_bf16 v40, v144, v8, 0
    v_dot2_f32_bf16 v40, v145, v9, v40
    v_dot2_f32_bf16 v40, v146, v10, v40
    v_dot2_f32_bf16 v40, v147, v11, v40
    buffer_load_dwordx4 v[136:139], v2, s[8:11], s60 offen offset:2048 nt
    v_add_f32_dpp v45, v42, v42 row_mirror row_mask:0xf bank_mask:0x3
    v_add_f32_dpp v45, v43, v43 row_mirror row_mask:0xf bank_mask:0xc
    v_add_f32_dpp v46, v44, v44 row_half_mirror row_mask:0xf bank_mask:0x5
    s_nop 0
    v_add_f32_dpp v46, v45, v45 row_half_mirror row_mask:0xf bank_mask:0xa
    s_waitcnt vmcnt(5)
    v_dot2_f32_bf16 v41, v164, v8, 0
    v_dot2_f32_bf16 v41, v165, v9, v41
    v_dot2_f32_bf16 v41, v166, v10, v41
    v_dot2_f32_bf16 v41, v167, v11, v41
    buffer_load_dwordx4 v[160:163], v2, s[8:11], s60 offen offset:3072 nt
    s_waitcnt vmcnt(5)
    v_dot2_f32_bf16 v42, v184, v8, 0
    v_dot2_f32_bf16 v42, v185, v9, v42
    v_dot2_f32_bf16 v42, v186, v10, v42
    v_dot2_f32_bf16 v42, v187, v11, v42
    s_xor_b32 s60, s63, 835584
    buffer_load_dwordx4 v[188:191], v2, s[8:11], s60 offen offset:0 nt
    v_add_f32_dpp v44, v40, v40 row_mirror row_mask:0xf bank_mask:0x3
    v_add_f32_dpp v44, v41, v41 row_mirror row_mask:0xf bank_mask:0xc
    s_waitcnt vmcnt(5)
    v_dot2_f32_bf16 v43, v204, v8, 0
    v_dot2_f32_bf16 v43, v205, v9, v43
    v_dot2_f32_bf16 v43, v206, v10, v43
    v_dot2_f32_bf16 v43, v207, v11, v43
    buffer_load_dwordx4 v[192:195], v2, s[8:11], s60 offen offset:1024 nt
    s_waitcnt vmcnt(5)
    v_dot2_f32_bf16 v40, v224, v8, 0
    v_dot2_f32_bf16 v40, v225, v9, v40
    v_dot2_f32_bf16 v40, v226, v10, v40
    v_dot2_f32_bf16 v40, v227, v11, v40
    buffer_load_dwordx4 v[196:199], v2, s[8:11], s60 offen offset:2048 nt
    v_add_f32_dpp v45, v42, v42 row_mirror row_mask:0xf bank_mask:0x3
    v_add_f32_dpp v45, v43, v43 row_mirror row_mask:0xf bank_mask:0xc
    v_add_f32_dpp v47, v44, v44 row_half_mirror row_mask:0xf bank_mask:0x5
    s_nop 0
    v_add_f32_dpp v47, v45, v45 row_half_mirror row_mask:0xf bank_mask:0xa
    v_cndmask_b32 v50, v46, v47, s[56:57]
    v_cndmask_b32 v51, v47, v46, s[56:57]
    s_nop 1
    v_add_f32_dpp v48, v51, v50 quad_perm:[2,3,0,1] row_mask:0xf bank_mask:0xf
    s_waitcnt vmcnt(5)
    v_dot2_f32_bf16 v41, v244, v8, 0
    v_dot2_f32_bf16 v41, v245, v9, v41
    v_dot2_f32_bf16 v41, v246, v10, v41
    v_dot2_f32_bf16 v41, v247, v11, v41
    buffer_load_dwordx4 v[200:203], v2, s[8:11], s60 offen offset:3072 nt
    s_waitcnt vmcnt(5)
    v_dot2_f32_bf16 v42, v136, v8, 0
    v_dot2_f32_bf16 v42, v137, v9, v42
    v_dot2_f32_bf16 v42, v138, v10, v42
    v_dot2_f32_bf16 v42, v139, v11, v42
    s_xor_b32 s60, s63, 851968
    buffer_load_dwordx4 v[208:211], v2, s[8:11], s60 offen offset:0 nt
    v_add_f32_dpp v44, v40, v40 row_mirror row_mask:0xf bank_mask:0x3
    v_add_f32_dpp v44, v41, v41 row_mirror row_mask:0xf bank_mask:0xc
    s_waitcnt vmcnt(5)
    v_dot2_f32_bf16 v43, v160, v8, 0
    v_dot2_f32_bf16 v43, v161, v9, v43
    v_dot2_f32_bf16 v43, v162, v10, v43
    v_dot2_f32_bf16 v43, v163, v11, v43
    buffer_load_dwordx4 v[212:215], v2, s[8:11], s60 offen offset:1024 nt
    s_waitcnt vmcnt(5)
    v_dot2_f32_bf16 v40, v188, v8, 0
    v_dot2_f32_bf16 v40, v189, v9, v40
    v_dot2_f32_bf16 v40, v190, v10, v40
    v_dot2_f32_bf16 v40, v191, v11, v40
    buffer_load_dwordx4 v[216:219], v2, s[8:11], s60 offen offset:2048 nt
    v_add_f32_dpp v45, v42, v42 row_mirror row_mask:0xf bank_mask:0x3
    v_add_f32_dpp v45, v43, v43 row_mirror row_mask:0xf bank_mask:0xc
    v_add_f32_dpp v46, v44, v44 row_half_mirror row_mask:0xf bank_mask:0x5
    s_nop 0
    v_add_f32_dpp v46, v45, v45 row_half_mirror row_mask:0xf bank_mask:0xa
    s_waitcnt vmcnt(5)
    v_dot2_f32_bf16 v41, v192, v8, 0
    v_dot2_f32_bf16 v41, v193, v9, v41
    v_dot2_f32_bf16 v41, v194, v10, v41
    v_dot2_f32_bf16 v41, v195, v11, v41
    buffer_load_dwordx4 v[220:223], v2, s[8:11], s60 offen offset:3072 nt
    s_waitcnt vmcnt(5)
    v_dot2_f32_bf16 v42, v196, v8, 0
    v_dot2_f32_bf16 v42, v197, v9, v42
    v_dot2_f32_bf16 v42, v198, v10, v42
    v_dot2_f32_bf16 v42, v199, v11, v42
    s_xor_b32 s60, s63, 868352
    buffer_load_dwordx4 v[228:231], v2, s[8:11], s60 offen offset:0 nt
    v_add_f32_dpp v44, v40, v40 row_mirror row_mask:0xf bank_mask:0x3
    v_add_f32_dpp v44, v41, v41 row_mirror row_mask:0xf bank_mask:0xc
    s_waitcnt vmcnt(5)
    v_dot2_f32_bf16 v43, v200, v8, 0
    v_dot2_f32_bf16 v43, v201, v9, v43
    v_dot2_f32_bf16 v43, v202, v10, v43
    v_dot2_f32_bf16 v43, v203, v11, v43
    buffer_load_dwordx4 v[232:235], v2, s[8:11], s60 offen offset:1024 nt
    s_waitcnt vmcnt(5)
    v_dot2_f32_bf16 v40, v208, v8, 0
    v_dot2_f32_bf16 v40, v209, v9, v40
    v_dot2_f32_bf16 v40, v210, v10, v40
    v_dot2_f32_bf16 v40, v211, v11, v40
    buffer_load_dwordx4 v[236:239], v2, s[8:11], s60 offen offset:2048 nt
    v_add_f32_dpp v45, v42, v42 row_mirror row_mask:0xf bank_mask:0x3
    v_add_f32_dpp v45, v43, v43 row_mirror row_mask:0xf bank_mask:0xc
    v_add_f32_dpp v47, v44, v44 row_half_mirror row_mask:0xf bank_mask:0x5
    s_nop 0
    v_add_f32_dpp v47, v45, v45 row_half_mirror row_mask:0xf bank_mask:0xa
    v_cndmask_b32 v50, v46, v47, s[56:57]
    v_cndmask_b32 v51, v47, v46, s[56:57]
    s_nop 1
    v_add_f32_dpp v49, v51, v50 quad_perm:[2,3,0,1] row_mask:0xf bank_mask:0xf
    v_cndmask_b32 v50, v48, v49, s[58:59]
    v_cndmask_b32 v51, v49, v48, s[58:59]
    s_nop 1
    v_add_f32_dpp v36, v51, v50 quad_perm:[1,0,3,2] row_mask:0xf bank_mask:0xf
    v_cvt_pk_bf16_f32 v36, v36, v36
    v_and_b32 v36, 0xffff0000, v36
    v_mul_f32 v36, s92, v36
    v_cvt_pk_bf16_f32 v36, v36, v36
    v_and_b32 v36, 0xffff0000, v36
    v_max_f32 v58, v58, v36
    s_waitcnt vmcnt(5)
    v_dot2_f32_bf16 v41, v212, v8, 0
    v_dot2_f32_bf16 v41, v213, v9, v41
    v_dot2_f32_bf16 v41, v214, v10, v41
    v_dot2_f32_bf16 v41, v215, v11, v41
    buffer_load_dwordx4 v[240:243], v2, s[8:11], s60 offen offset:3072 nt
    s_waitcnt vmcnt(5)
    v_dot2_f32_bf16 v42, v216, v8, 0
    v_dot2_f32_bf16 v42, v217, v9, v42
    v_dot2_f32_bf16 v42, v218, v10, v42
    v_dot2_f32_bf16 v42, v219, v11, v42
    s_xor_b32 s60, s63, 884736
    buffer_load_dwordx4 v[248:251], v2, s[8:11], s60 offen offset:0 nt
    v_add_f32_dpp v44, v40, v40 row_mirror row_mask:0xf bank_mask:0x3
    v_add_f32_dpp v44, v41, v41 row_mirror row_mask:0xf bank_mask:0xc
    s_waitcnt vmcnt(5)
    v_dot2_f32_bf16 v43, v220, v8, 0
    v_dot2_f32_bf16 v43, v221, v9, v43
    v_dot2_f32_bf16 v43, v222, v10, v43
    v_dot2_f32_bf16 v43, v223, v11, v43
    buffer_load_dwordx4 v[252:255], v2, s[8:11], s60 offen offset:1024 nt
    s_waitcnt vmcnt(5)
    v_dot2_f32_bf16 v40, v228, v8, 0
    v_dot2_f32_bf16 v40, v229, v9, v40
    v_dot2_f32_bf16 v40, v230, v10, v40
    v_dot2_f32_bf16 v40, v231, v11, v40
    buffer_load_dwordx4 v[128:131], v2, s[8:11], s60 offen offset:2048 nt
    v_add_f32_dpp v45, v42, v42 row_mirror row_mask:0xf bank_mask:0x3
    v_add_f32_dpp v45, v43, v43 row_mirror row_mask:0xf bank_mask:0xc
    v_add_f32_dpp v46, v44, v44 row_half_mirror row_mask:0xf bank_mask:0x5
    s_nop 0
    v_add_f32_dpp v46, v45, v45 row_half_mirror row_mask:0xf bank_mask:0xa
    s_waitcnt vmcnt(5)
    v_dot2_f32_bf16 v41, v232, v8, 0
    v_dot2_f32_bf16 v41, v233, v9, v41
    v_dot2_f32_bf16 v41, v234, v10, v41
    v_dot2_f32_bf16 v41, v235, v11, v41
    buffer_load_dwordx4 v[132:135], v2, s[8:11], s60 offen offset:3072 nt
    s_waitcnt vmcnt(5)
    v_dot2_f32_bf16 v42, v236, v8, 0
    v_dot2_f32_bf16 v42, v237, v9, v42
    v_dot2_f32_bf16 v42, v238, v10, v42
    v_dot2_f32_bf16 v42, v239, v11, v42
    s_xor_b32 s60, s63, 901120
    buffer_load_dwordx4 v[140:143], v2, s[8:11], s60 offen offset:0 nt
    v_add_f32_dpp v44, v40, v40 row_mirror row_mask:0xf bank_mask:0x3
    v_add_f32_dpp v44, v41, v41 row_mirror row_mask:0xf bank_mask:0xc
    s_waitcnt vmcnt(5)
    v_dot2_f32_bf16 v43, v240, v8, 0
    v_dot2_f32_bf16 v43, v241, v9, v43
    v_dot2_f32_bf16 v43, v242, v10, v43
    v_dot2_f32_bf16 v43, v243, v11, v43
    buffer_load_dwordx4 v[148:151], v2, s[8:11], s60 offen offset:1024 nt
    s_waitcnt vmcnt(5)
    v_dot2_f32_bf16 v40, v248, v8, 0
    v_dot2_f32_bf16 v40, v249, v9, v40
    v_dot2_f32_bf16 v40, v250, v10, v40
    v_dot2_f32_bf16 v40, v251, v11, v40
    buffer_load_dwordx4 v[152:155], v2, s[8:11], s60 offen offset:2048 nt
    v_add_f32_dpp v45, v42, v42 row_mirror row_mask:0xf bank_mask:0x3
    v_add_f32_dpp v45, v43, v43 row_mirror row_mask:0xf bank_mask:0xc
    v_add_f32_dpp v47, v44, v44 row_half_mirror row_mask:0xf bank_mask:0x5
    s_nop 0
    v_add_f32_dpp v47, v45, v45 row_half_mirror row_mask:0xf bank_mask:0xa
    v_cndmask_b32 v50, v46, v47, s[56:57]
    v_cndmask_b32 v51, v47, v46, s[56:57]
    s_nop 1
    v_add_f32_dpp v48, v51, v50 quad_perm:[2,3,0,1] row_mask:0xf bank_mask:0xf
    s_waitcnt vmcnt(5)
    v_dot2_f32_bf16 v41, v252, v8, 0
    v_dot2_f32_bf16 v41, v253, v9, v41
    v_dot2_f32_bf16 v41, v254, v10, v41
    v_dot2_f32_bf16 v41, v255, v11, v41
    buffer_load_dwordx4 v[156:159], v2, s[8:11], s60 offen offset:3072 nt
    s_waitcnt vmcnt(5)
    v_dot2_f32_bf16 v42, v128, v8, 0
    v_dot2_f32_bf16 v42, v129, v9, v42
    v_dot2_f32_bf16 v42, v130, v10, v42
    v_dot2_f32_bf16 v42, v131, v11, v42
    s_xor_b32 s60, s63, 917504
    buffer_load_dwordx4 v[168:171], v2, s[8:11], s60 offen offset:0 nt
    v_add_f32_dpp v44, v40, v40 row_mirror row_mask:0xf bank_mask:0x3
    v_add_f32_dpp v44, v41, v41 row_mirror row_mask:0xf bank_mask:0xc
    s_waitcnt vmcnt(5)
    v_dot2_f32_bf16 v43, v132, v8, 0
    v_dot2_f32_bf16 v43, v133, v9, v43
    v_dot2_f32_bf16 v43, v134, v10, v43
    v_dot2_f32_bf16 v43, v135, v11, v43
    buffer_load_dwordx4 v[172:175], v2, s[8:11], s60 offen offset:1024 nt
    s_waitcnt vmcnt(5)
    v_dot2_f32_bf16 v40, v140, v8, 0
    v_dot2_f32_bf16 v40, v141, v9, v40
    v_dot2_f32_bf16 v40, v142, v10, v40
    v_dot2_f32_bf16 v40, v143, v11, v40
    buffer_load_dwordx4 v[176:179], v2, s[8:11], s60 offen offset:2048 nt
    v_add_f32_dpp v45, v42, v42 row_mirror row_mask:0xf bank_mask:0x3
    v_add_f32_dpp v45, v43, v43 row_mirror row_mask:0xf bank_mask:0xc
    v_add_f32_dpp v46, v44, v44 row_half_mirror row_mask:0xf bank_mask:0x5
    s_nop 0
    v_add_f32_dpp v46, v45, v45 row_half_mirror row_mask:0xf bank_mask:0xa
    s_waitcnt vmcnt(5)
    v_dot2_f32_bf16 v41, v148, v8, 0
    v_dot2_f32_bf16 v41, v149, v9, v41
    v_dot2_f32_bf16 v41, v150, v10, v41
    v_dot2_f32_bf16 v41, v151, v11, v41
    buffer_load_dwordx4 v[180:183], v2, s[8:11], s60 offen offset:3072 nt
    s_waitcnt vmcnt(5)
    v_dot2_f32_bf16 v42, v152, v8, 0
    v_dot2_f32_bf16 v42, v153, v9, v42
    v_dot2_f32_bf16 v42, v154, v10, v42
    v_dot2_f32_bf16 v42, v155, v11, v42
    s_xor_b32 s60, s63, 933888
    buffer_load_dwordx4 v[64:67], v2, s[8:11], s60 offen offset:0 nt
    v_add_f32_dpp v44, v40, v40 row_mirror row_mask:0xf bank_mask:0x3
    v_add_f32_dpp v44, v41, v41 row_mirror row_mask:0xf bank_mask:0xc
    s_waitcnt vmcnt(5)
    v_dot2_f32_bf16 v43, v156, v8, 0
    v_dot2_f32_bf16 v43, v157, v9, v43
    v_dot2_f32_bf16 v43, v158, v10, v43
    v_dot2_f32_bf16 v43, v159, v11, v43
    buffer_load_dwordx4 v[68:71], v2, s[8:11], s60 offen offset:1024 nt
    s_waitcnt vmcnt(5)
    v_dot2_f32_bf16 v40, v168, v8, 0
    v_dot2_f32_bf16 v40, v169, v9, v40
    v_dot2_f32_bf16 v40, v170, v10, v40
    v_dot2_f32_bf16 v40, v171, v11, v40
    buffer_load_dwordx4 v[72:75], v2, s[8:11], s60 offen offset:2048 nt
    v_add_f32_dpp v45, v42, v42 row_mirror row_mask:0xf bank_mask:0x3
    v_add_f32_dpp v45, v43, v43 row_mirror row_mask:0xf bank_mask:0xc
    v_add_f32_dpp v47, v44, v44 row_half_mirror row_mask:0xf bank_mask:0x5
    s_nop 0
    v_add_f32_dpp v47, v45, v45 row_half_mirror row_mask:0xf bank_mask:0xa
    v_cndmask_b32 v50, v46, v47, s[56:57]
    v_cndmask_b32 v51, v47, v46, s[56:57]
    s_nop 1
    v_add_f32_dpp v49, v51, v50 quad_perm:[2,3,0,1] row_mask:0xf bank_mask:0xf
    v_cndmask_b32 v50, v48, v49, s[58:59]
    v_cndmask_b32 v51, v49, v48, s[58:59]
    s_nop 1
    v_add_f32_dpp v37, v51, v50 quad_perm:[1,0,3,2] row_mask:0xf bank_mask:0xf
    v_cvt_pk_bf16_f32 v37, v37, v37
    v_and_b32 v37, 0xffff0000, v37
    v_mul_f32 v37, s92, v37
    v_cvt_pk_bf16_f32 v37, v37, v37
    v_and_b32 v37, 0xffff0000, v37
    v_max_f32 v58, v58, v37
    s_waitcnt vmcnt(5)
    v_dot2_f32_bf16 v41, v172, v8, 0
    v_dot2_f32_bf16 v41, v173, v9, v41
    v_dot2_f32_bf16 v41, v174, v10, v41
    v_dot2_f32_bf16 v41, v175, v11, v41
    buffer_load_dwordx4 v[76:79], v2, s[8:11], s60 offen offset:3072 nt
    s_waitcnt vmcnt(5)
    v_dot2_f32_bf16 v42, v176, v8, 0
    v_dot2_f32_bf16 v42, v177, v9, v42
    v_dot2_f32_bf16 v42, v178, v10, v42
    v_dot2_f32_bf16 v42, v179, v11, v42
    s_xor_b32 s60, s63, 950272
    buffer_load_dwordx4 v[80:83], v2, s[8:11], s60 offen offset:0 nt
    v_add_f32_dpp v44, v40, v40 row_mirror row_mask:0xf bank_mask:0x3
    v_add_f32_dpp v44, v41, v41 row_mirror row_mask:0xf bank_mask:0xc
    s_waitcnt vmcnt(5)
    v_dot2_f32_bf16 v43, v180, v8, 0
    v_dot2_f32_bf16 v43, v181, v9, v43
    v_dot2_f32_bf16 v43, v182, v10, v43
    v_dot2_f32_bf16 v43, v183, v11, v43
    buffer_load_dwordx4 v[84:87], v2, s[8:11], s60 offen offset:1024 nt
    s_waitcnt vmcnt(5)
    v_dot2_f32_bf16 v40, v64, v8, 0
    v_dot2_f32_bf16 v40, v65, v9, v40
    v_dot2_f32_bf16 v40, v66, v10, v40
    v_dot2_f32_bf16 v40, v67, v11, v40
    buffer_load_dwordx4 v[88:91], v2, s[8:11], s60 offen offset:2048 nt
    v_add_f32_dpp v45, v42, v42 row_mirror row_mask:0xf bank_mask:0x3
    v_add_f32_dpp v45, v43, v43 row_mirror row_mask:0xf bank_mask:0xc
    v_add_f32_dpp v46, v44, v44 row_half_mirror row_mask:0xf bank_mask:0x5
    s_nop 0
    v_add_f32_dpp v46, v45, v45 row_half_mirror row_mask:0xf bank_mask:0xa
    s_waitcnt vmcnt(5)
    v_dot2_f32_bf16 v41, v68, v8, 0
    v_dot2_f32_bf16 v41, v69, v9, v41
    v_dot2_f32_bf16 v41, v70, v10, v41
    v_dot2_f32_bf16 v41, v71, v11, v41
    buffer_load_dwordx4 v[92:95], v2, s[8:11], s60 offen offset:3072 nt
    s_waitcnt vmcnt(5)
    v_dot2_f32_bf16 v42, v72, v8, 0
    v_dot2_f32_bf16 v42, v73, v9, v42
    v_dot2_f32_bf16 v42, v74, v10, v42
    v_dot2_f32_bf16 v42, v75, v11, v42
    s_xor_b32 s60, s63, 966656
    buffer_load_dwordx4 v[96:99], v2, s[8:11], s60 offen offset:0 nt
    v_add_f32_dpp v44, v40, v40 row_mirror row_mask:0xf bank_mask:0x3
    v_add_f32_dpp v44, v41, v41 row_mirror row_mask:0xf bank_mask:0xc
    s_waitcnt vmcnt(5)
    v_dot2_f32_bf16 v43, v76, v8, 0
    v_dot2_f32_bf16 v43, v77, v9, v43
    v_dot2_f32_bf16 v43, v78, v10, v43
    v_dot2_f32_bf16 v43, v79, v11, v43
    buffer_load_dwordx4 v[100:103], v2, s[8:11], s60 offen offset:1024 nt
    s_waitcnt vmcnt(5)
    v_dot2_f32_bf16 v40, v80, v8, 0
    v_dot2_f32_bf16 v40, v81, v9, v40
    v_dot2_f32_bf16 v40, v82, v10, v40
    v_dot2_f32_bf16 v40, v83, v11, v40
    buffer_load_dwordx4 v[104:107], v2, s[8:11], s60 offen offset:2048 nt
    v_add_f32_dpp v45, v42, v42 row_mirror row_mask:0xf bank_mask:0x3
    v_add_f32_dpp v45, v43, v43 row_mirror row_mask:0xf bank_mask:0xc
    v_add_f32_dpp v47, v44, v44 row_half_mirror row_mask:0xf bank_mask:0x5
    s_nop 0
    v_add_f32_dpp v47, v45, v45 row_half_mirror row_mask:0xf bank_mask:0xa
    v_cndmask_b32 v50, v46, v47, s[56:57]
    v_cndmask_b32 v51, v47, v46, s[56:57]
    s_nop 1
    v_add_f32_dpp v48, v51, v50 quad_perm:[2,3,0,1] row_mask:0xf bank_mask:0xf
    s_waitcnt vmcnt(5)
    v_dot2_f32_bf16 v41, v84, v8, 0
    v_dot2_f32_bf16 v41, v85, v9, v41
    v_dot2_f32_bf16 v41, v86, v10, v41
    v_dot2_f32_bf16 v41, v87, v11, v41
    buffer_load_dwordx4 v[108:111], v2, s[8:11], s60 offen offset:3072 nt
    s_waitcnt vmcnt(5)
    v_dot2_f32_bf16 v42, v88, v8, 0
    v_dot2_f32_bf16 v42, v89, v9, v42
    v_dot2_f32_bf16 v42, v90, v10, v42
    v_dot2_f32_bf16 v42, v91, v11, v42
    s_xor_b32 s60, s63, 983040
    buffer_load_dwordx4 v[112:115], v2, s[8:11], s60 offen offset:0 nt
    v_add_f32_dpp v44, v40, v40 row_mirror row_mask:0xf bank_mask:0x3
    v_add_f32_dpp v44, v41, v41 row_mirror row_mask:0xf bank_mask:0xc
    s_waitcnt vmcnt(5)
    v_dot2_f32_bf16 v43, v92, v8, 0
    v_dot2_f32_bf16 v43, v93, v9, v43
    v_dot2_f32_bf16 v43, v94, v10, v43
    v_dot2_f32_bf16 v43, v95, v11, v43
    buffer_load_dwordx4 v[116:119], v2, s[8:11], s60 offen offset:1024 nt
    s_waitcnt vmcnt(5)
    v_dot2_f32_bf16 v40, v96, v8, 0
    v_dot2_f32_bf16 v40, v97, v9, v40
    v_dot2_f32_bf16 v40, v98, v10, v40
    v_dot2_f32_bf16 v40, v99, v11, v40
    buffer_load_dwordx4 v[120:123], v2, s[8:11], s60 offen offset:2048 nt
    v_add_f32_dpp v45, v42, v42 row_mirror row_mask:0xf bank_mask:0x3
    v_add_f32_dpp v45, v43, v43 row_mirror row_mask:0xf bank_mask:0xc
    v_add_f32_dpp v46, v44, v44 row_half_mirror row_mask:0xf bank_mask:0x5
    s_nop 0
    v_add_f32_dpp v46, v45, v45 row_half_mirror row_mask:0xf bank_mask:0xa
    s_waitcnt vmcnt(5)
    v_dot2_f32_bf16 v41, v100, v8, 0
    v_dot2_f32_bf16 v41, v101, v9, v41
    v_dot2_f32_bf16 v41, v102, v10, v41
    v_dot2_f32_bf16 v41, v103, v11, v41
    buffer_load_dwordx4 v[124:127], v2, s[8:11], s60 offen offset:3072 nt
    s_waitcnt vmcnt(5)
    v_dot2_f32_bf16 v42, v104, v8, 0
    v_dot2_f32_bf16 v42, v105, v9, v42
    v_dot2_f32_bf16 v42, v106, v10, v42
    v_dot2_f32_bf16 v42, v107, v11, v42
    s_xor_b32 s60, s63, 999424
    buffer_load_dwordx4 v[144:147], v2, s[8:11], s60 offen offset:0 nt
    v_add_f32_dpp v44, v40, v40 row_mirror row_mask:0xf bank_mask:0x3
    v_add_f32_dpp v44, v41, v41 row_mirror row_mask:0xf bank_mask:0xc
    s_waitcnt vmcnt(5)
    v_dot2_f32_bf16 v43, v108, v8, 0
    v_dot2_f32_bf16 v43, v109, v9, v43
    v_dot2_f32_bf16 v43, v110, v10, v43
    v_dot2_f32_bf16 v43, v111, v11, v43
    buffer_load_dwordx4 v[164:167], v2, s[8:11], s60 offen offset:1024 nt
    s_waitcnt vmcnt(5)
    v_dot2_f32_bf16 v40, v112, v8, 0
    v_dot2_f32_bf16 v40, v113, v9, v40
    v_dot2_f32_bf16 v40, v114, v10, v40
    v_dot2_f32_bf16 v40, v115, v11, v40
    buffer_load_dwordx4 v[184:187], v2, s[8:11], s60 offen offset:2048 nt
    v_add_f32_dpp v45, v42, v42 row_mirror row_mask:0xf bank_mask:0x3
    v_add_f32_dpp v45, v43, v43 row_mirror row_mask:0xf bank_mask:0xc
    v_add_f32_dpp v47, v44, v44 row_half_mirror row_mask:0xf bank_mask:0x5
    s_nop 0
    v_add_f32_dpp v47, v45, v45 row_half_mirror row_mask:0xf bank_mask:0xa
    v_cndmask_b32 v50, v46, v47, s[56:57]
    v_cndmask_b32 v51, v47, v46, s[56:57]
    s_nop 1
    v_add_f32_dpp v49, v51, v50 quad_perm:[2,3,0,1] row_mask:0xf bank_mask:0xf
    v_cndmask_b32 v50, v48, v49, s[58:59]
    v_cndmask_b32 v51, v49, v48, s[58:59]
    s_nop 1
    v_add_f32_dpp v38, v51, v50 quad_perm:[1,0,3,2] row_mask:0xf bank_mask:0xf
    v_cvt_pk_bf16_f32 v38, v38, v38
    v_and_b32 v38, 0xffff0000, v38
    v_mul_f32 v38, s92, v38
    v_cvt_pk_bf16_f32 v38, v38, v38
    v_and_b32 v38, 0xffff0000, v38
    v_max_f32 v58, v58, v38
    s_waitcnt vmcnt(5)
    v_dot2_f32_bf16 v41, v116, v8, 0
    v_dot2_f32_bf16 v41, v117, v9, v41
    v_dot2_f32_bf16 v41, v118, v10, v41
    v_dot2_f32_bf16 v41, v119, v11, v41
    buffer_load_dwordx4 v[204:207], v2, s[8:11], s60 offen offset:3072 nt
    s_waitcnt vmcnt(5)
    v_dot2_f32_bf16 v42, v120, v8, 0
    v_dot2_f32_bf16 v42, v121, v9, v42
    v_dot2_f32_bf16 v42, v122, v10, v42
    v_dot2_f32_bf16 v42, v123, v11, v42
    s_xor_b32 s60, s63, 1015808
    buffer_load_dwordx4 v[224:227], v2, s[8:11], s60 offen offset:0 nt
    v_add_f32_dpp v44, v40, v40 row_mirror row_mask:0xf bank_mask:0x3
    v_add_f32_dpp v44, v41, v41 row_mirror row_mask:0xf bank_mask:0xc
    s_waitcnt vmcnt(5)
    v_dot2_f32_bf16 v43, v124, v8, 0
    v_dot2_f32_bf16 v43, v125, v9, v43
    v_dot2_f32_bf16 v43, v126, v10, v43
    v_dot2_f32_bf16 v43, v127, v11, v43
    buffer_load_dwordx4 v[244:247], v2, s[8:11], s60 offen offset:1024 nt
    s_waitcnt vmcnt(5)
    v_dot2_f32_bf16 v40, v144, v8, 0
    v_dot2_f32_bf16 v40, v145, v9, v40
    v_dot2_f32_bf16 v40, v146, v10, v40
    v_dot2_f32_bf16 v40, v147, v11, v40
    buffer_load_dwordx4 v[136:139], v2, s[8:11], s60 offen offset:2048 nt
    v_add_f32_dpp v45, v42, v42 row_mirror row_mask:0xf bank_mask:0x3
    v_add_f32_dpp v45, v43, v43 row_mirror row_mask:0xf bank_mask:0xc
    v_add_f32_dpp v46, v44, v44 row_half_mirror row_mask:0xf bank_mask:0x5
    s_nop 0
    v_add_f32_dpp v46, v45, v45 row_half_mirror row_mask:0xf bank_mask:0xa
    s_waitcnt vmcnt(5)
    v_dot2_f32_bf16 v41, v164, v8, 0
    v_dot2_f32_bf16 v41, v165, v9, v41
    v_dot2_f32_bf16 v41, v166, v10, v41
    v_dot2_f32_bf16 v41, v167, v11, v41
    buffer_load_dwordx4 v[160:163], v2, s[8:11], s60 offen offset:3072 nt
    s_waitcnt vmcnt(5)
    v_dot2_f32_bf16 v42, v184, v8, 0
    v_dot2_f32_bf16 v42, v185, v9, v42
    v_dot2_f32_bf16 v42, v186, v10, v42
    v_dot2_f32_bf16 v42, v187, v11, v42
    s_xor_b32 s60, s63, 1032192
    buffer_load_dwordx4 v[188:191], v2, s[8:11], s60 offen offset:0 nt
    v_add_f32_dpp v44, v40, v40 row_mirror row_mask:0xf bank_mask:0x3
    v_add_f32_dpp v44, v41, v41 row_mirror row_mask:0xf bank_mask:0xc
    s_waitcnt vmcnt(5)
    v_dot2_f32_bf16 v43, v204, v8, 0
    v_dot2_f32_bf16 v43, v205, v9, v43
    v_dot2_f32_bf16 v43, v206, v10, v43
    v_dot2_f32_bf16 v43, v207, v11, v43
    buffer_load_dwordx4 v[192:195], v2, s[8:11], s60 offen offset:1024 nt
    s_waitcnt vmcnt(5)
    v_dot2_f32_bf16 v40, v224, v8, 0
    v_dot2_f32_bf16 v40, v225, v9, v40
    v_dot2_f32_bf16 v40, v226, v10, v40
    v_dot2_f32_bf16 v40, v227, v11, v40
    buffer_load_dwordx4 v[196:199], v2, s[8:11], s60 offen offset:2048 nt
    v_add_f32_dpp v45, v42, v42 row_mirror row_mask:0xf bank_mask:0x3
    v_add_f32_dpp v45, v43, v43 row_mirror row_mask:0xf bank_mask:0xc
    v_add_f32_dpp v47, v44, v44 row_half_mirror row_mask:0xf bank_mask:0x5
    s_nop 0
    v_add_f32_dpp v47, v45, v45 row_half_mirror row_mask:0xf bank_mask:0xa
    v_cndmask_b32 v50, v46, v47, s[56:57]
    v_cndmask_b32 v51, v47, v46, s[56:57]
    s_nop 1
    v_add_f32_dpp v48, v51, v50 quad_perm:[2,3,0,1] row_mask:0xf bank_mask:0xf
    s_waitcnt vmcnt(5)
    v_dot2_f32_bf16 v41, v244, v8, 0
    v_dot2_f32_bf16 v41, v245, v9, v41
    v_dot2_f32_bf16 v41, v246, v10, v41
    v_dot2_f32_bf16 v41, v247, v11, v41
    buffer_load_dwordx4 v[200:203], v2, s[8:11], s60 offen offset:3072 nt
    s_waitcnt vmcnt(5)
    v_dot2_f32_bf16 v42, v136, v8, 0
    v_dot2_f32_bf16 v42, v137, v9, v42
    v_dot2_f32_bf16 v42, v138, v10, v42
    v_dot2_f32_bf16 v42, v139, v11, v42
    s_xor_b32 s60, s63, 0
    buffer_load_dwordx4 v[208:211], v2, s[12:15], s60 offen offset:0 nt
    v_add_f32_dpp v44, v40, v40 row_mirror row_mask:0xf bank_mask:0x3
    v_add_f32_dpp v44, v41, v41 row_mirror row_mask:0xf bank_mask:0xc
    s_waitcnt vmcnt(5)
    v_dot2_f32_bf16 v43, v160, v8, 0
    v_dot2_f32_bf16 v43, v161, v9, v43
    v_dot2_f32_bf16 v43, v162, v10, v43
    v_dot2_f32_bf16 v43, v163, v11, v43
    buffer_load_dwordx4 v[212:215], v2, s[12:15], s60 offen offset:1024 nt
    s_waitcnt vmcnt(5)
    v_dot2_f32_bf16 v40, v188, v8, 0
    v_dot2_f32_bf16 v40, v189, v9, v40
    v_dot2_f32_bf16 v40, v190, v10, v40
    v_dot2_f32_bf16 v40, v191, v11, v40
    buffer_load_dwordx4 v[216:219], v2, s[12:15], s60 offen offset:2048 nt
    v_add_f32_dpp v45, v42, v42 row_mirror row_mask:0xf bank_mask:0x3
    v_add_f32_dpp v45, v43, v43 row_mirror row_mask:0xf bank_mask:0xc
    v_add_f32_dpp v46, v44, v44 row_half_mirror row_mask:0xf bank_mask:0x5
    s_nop 0
    v_add_f32_dpp v46, v45, v45 row_half_mirror row_mask:0xf bank_mask:0xa
    s_waitcnt vmcnt(5)
    v_dot2_f32_bf16 v41, v192, v8, 0
    v_dot2_f32_bf16 v41, v193, v9, v41
    v_dot2_f32_bf16 v41, v194, v10, v41
    v_dot2_f32_bf16 v41, v195, v11, v41
    buffer_load_dwordx4 v[220:223], v2, s[12:15], s60 offen offset:3072 nt
    s_waitcnt vmcnt(5)
    v_dot2_f32_bf16 v42, v196, v8, 0
    v_dot2_f32_bf16 v42, v197, v9, v42
    v_dot2_f32_bf16 v42, v198, v10, v42
    v_dot2_f32_bf16 v42, v199, v11, v42
    s_xor_b32 s60, s63, 16384
    buffer_load_dwordx4 v[228:231], v2, s[12:15], s60 offen offset:0 nt
    v_add_f32_dpp v44, v40, v40 row_mirror row_mask:0xf bank_mask:0x3
    v_add_f32_dpp v44, v41, v41 row_mirror row_mask:0xf bank_mask:0xc
    s_waitcnt vmcnt(5)
    v_dot2_f32_bf16 v43, v200, v8, 0
    v_dot2_f32_bf16 v43, v201, v9, v43
    v_dot2_f32_bf16 v43, v202, v10, v43
    v_dot2_f32_bf16 v43, v203, v11, v43
    buffer_load_dwordx4 v[232:235], v2, s[12:15], s60 offen offset:1024 nt
    v_add_f32_dpp v45, v42, v42 row_mirror row_mask:0xf bank_mask:0x3
    s_nop 0
    v_add_f32_dpp v45, v43, v43 row_mirror row_mask:0xf bank_mask:0xc
    v_add_f32_dpp v47, v44, v44 row_half_mirror row_mask:0xf bank_mask:0x5
    s_nop 0
    v_add_f32_dpp v47, v45, v45 row_half_mirror row_mask:0xf bank_mask:0xa
    v_cndmask_b32 v50, v46, v47, s[56:57]
    v_cndmask_b32 v51, v47, v46, s[56:57]
    s_nop 1
    v_add_f32_dpp v49, v51, v50 quad_perm:[2,3,0,1] row_mask:0xf bank_mask:0xf
    v_cndmask_b32 v50, v48, v49, s[58:59]
    v_cndmask_b32 v51, v49, v48, s[58:59]
    s_nop 1
    v_add_f32_dpp v39, v51, v50 quad_perm:[1,0,3,2] row_mask:0xf bank_mask:0xf
    v_cvt_pk_bf16_f32 v39, v39, v39
    v_and_b32 v39, 0xffff0000, v39
    v_mul_f32 v39, s92, v39
    v_cvt_pk_bf16_f32 v39, v39, v39
    v_and_b32 v39, 0xffff0000, v39
    v_max_f32 v58, v58, v39
    s_nop 1
    v_max_f32_dpp v58, v58, v58 row_ror:8 row_mask:0xf bank_mask:0xf
    s_nop 1
    v_max_f32_dpp v58, v58, v58 row_ror:4 row_mask:0xf bank_mask:0xf
    s_nop 1
    v_max_f32_dpp v58, v58, v58 row_ror:2 row_mask:0xf bank_mask:0xf
    s_nop 1
    v_max_f32_dpp v58, v58, v58 row_ror:1 row_mask:0xf bank_mask:0xf
    s_nop 1
    v_max_f32_dpp v58, v58, v58 row_bcast:15 row_mask:0xa bank_mask:0xf
    s_nop 1
    v_max_f32_dpp v58, v58, v58 row_bcast:31 row_mask:0xc bank_mask:0xf
    s_nop 0
    v_readlane_b32 s54, v58, 63
    s_nop 1
    v_mov_b32 v58, s54
    v_mul_f32 v50, s91, v58
    s_waitcnt vmcnt(5)
    buffer_load_dwordx4 v[236:239], v2, s[12:15], s60 offen offset:2048 nt
    v_fma_f32 v40, v24, s91, -v50
    v_exp_f32 v40, v40
    v_fma_f32 v41, v25, s91, -v50
    v_exp_f32 v41, v41
    v_mov_b32 v59, v40
    v_fma_f32 v42, v26, s91, -v50
    v_exp_f32 v42, v42
    v_add_f32 v59, v59, v41
    v_fma_f32 v43, v27, s91, -v50
    v_exp_f32 v43, v43
    v_add_f32 v59, v59, v42
    v_fma_f32 v40, v28, s91, -v50
    v_exp_f32 v40, v40
    v_add_f32 v59, v59, v43
    v_fma_f32 v41, v29, s91, -v50
    v_exp_f32 v41, v41
    v_add_f32 v59, v59, v40
    v_fma_f32 v42, v30, s91, -v50
    v_exp_f32 v42, v42
    v_add_f32 v59, v59, v41
    v_fma_f32 v43, v31, s91, -v50
    v_exp_f32 v43, v43
    v_add_f32 v59, v59, v42
    v_fma_f32 v40, v32, s91, -v50
    v_exp_f32 v40, v40
    v_add_f32 v59, v59, v43
    v_fma_f32 v41, v33, s91, -v50
    v_exp_f32 v41, v41
    v_add_f32 v59, v59, v40
    v_fma_f32 v42, v34, s91, -v50
    v_exp_f32 v42, v42
    v_add_f32 v59, v59, v41
    v_fma_f32 v43, v35, s91, -v50
    v_exp_f32 v43, v43
    v_add_f32 v59, v59, v42
    v_fma_f32 v40, v36, s91, -v50
    v_exp_f32 v40, v40
    v_add_f32 v59, v59, v43
    v_fma_f32 v41, v37, s91, -v50
    v_exp_f32 v41, v41
    v_add_f32 v59, v59, v40
    v_fma_f32 v42, v38, s91, -v50
    v_exp_f32 v42, v42
    v_add_f32 v59, v59, v41
    v_fma_f32 v43, v39, s91, -v50
    v_exp_f32 v43, v43
    v_add_f32 v59, v59, v42
    v_add_f32 v59, v59, v43
    s_waitcnt vmcnt(5)
    buffer_load_dwordx4 v[240:243], v2, s[12:15], s60 offen offset:3072 nt
    v_add_f32_dpp v59, v59, v59 row_ror:8 row_mask:0xf bank_mask:0xf
    s_nop 1
    v_add_f32_dpp v59, v59, v59 row_ror:4 row_mask:0xf bank_mask:0xf
    s_nop 1
    v_add_f32_dpp v59, v59, v59 row_ror:2 row_mask:0xf bank_mask:0xf
    s_nop 1
    v_add_f32_dpp v59, v59, v59 row_ror:1 row_mask:0xf bank_mask:0xf
    s_nop 1
    v_add_f32_dpp v59, v59, v59 row_bcast:15 row_mask:0xa bank_mask:0xf
    s_nop 1
    v_add_f32_dpp v59, v59, v59 row_bcast:31 row_mask:0xc bank_mask:0xf
    s_nop 0
    v_readlane_b32 s55, v59, 63
    s_lshl_b32 s54, s3, 3
    s_nop 0
    v_mov_b32 v59, s55
    v_mov_b32 v50, s54
    s_mov_b64 exec, 1
    ds_write_b64 v50, v[58:59] offset:2176
    s_mov_b64 exec, -1
    v_and_b32 v50, 3, v1
    v_lshlrev_b32 v50, 3, v50
    s_waitcnt vmcnt(5)
    s_xor_b32 s60, s63, 32768
    buffer_load_dwordx4 v[248:251], v2, s[12:15], s60 offen offset:0 nt
    s_waitcnt vmcnt(5)
    buffer_load_dwordx4 v[252:255], v2, s[12:15], s60 offen offset:1024 nt
    s_waitcnt lgkmcnt(0)
    s_barrier
    ds_read_b64 v[44:45], v50 offset:2176
    s_waitcnt vmcnt(5)
    buffer_load_dwordx4 v[128:131], v2, s[12:15], s60 offen offset:2048 nt
    s_waitcnt lgkmcnt(0)
    v_max_f32_dpp v46, v44, v44 quad_perm:[1,0,3,2] row_mask:0xf bank_mask:0xf
    s_nop 1
    v_max_f32_dpp v46, v46, v46 quad_perm:[2,3,0,1] row_mask:0xf bank_mask:0xf
    v_sub_f32 v44, v44, v46
    v_mul_f32 v44, s91, v44
    v_exp_f32 v44, v44
    v_mul_f32 v50, s91, v46
    v_mul_f32 v44, v44, v45
    s_nop 1
    v_add_f32_dpp v44, v44, v44 quad_perm:[1,0,3,2] row_mask:0xf bank_mask:0xf
    s_nop 1
    v_add_f32_dpp v44, v44, v44 quad_perm:[2,3,0,1] row_mask:0xf bank_mask:0xf
    v_rcp_f32 v44, v44
    v_fma_f32 v24, v24, s91, -v50
    v_exp_f32 v24, v24
    s_nop 0
    v_mul_f32 v24, v24, v44
    v_cvt_pk_bf16_f32 v24, v24, v24
    s_nop 1
    v_and_b32_dpp v16, v24, v4 row_newbcast:0 row_mask:0xf bank_mask:0xf
    v_and_b32_dpp v17, v24, v5 row_newbcast:0 row_mask:0xf bank_mask:0xf
    v_and_b32_dpp v18, v24, v6 row_newbcast:0 row_mask:0xf bank_mask:0xf
    v_and_b32_dpp v19, v24, v7 row_newbcast:0 row_mask:0xf bank_mask:0xf
    s_nop 1
    v_mfma_f32_16x16x32_bf16 v[12:15], v[16:19], v[208:211], 0
    v_and_b32_dpp v20, v24, v4 row_newbcast:8 row_mask:0xf bank_mask:0xf
    v_and_b32_dpp v21, v24, v5 row_newbcast:8 row_mask:0xf bank_mask:0xf
    v_and_b32_dpp v22, v24, v6 row_newbcast:8 row_mask:0xf bank_mask:0xf
    v_and_b32_dpp v23, v24, v7 row_newbcast:8 row_mask:0xf bank_mask:0xf
    s_waitcnt vmcnt(5)
    buffer_load_dwordx4 v[132:135], v2, s[12:15], s60 offen offset:3072 nt
    v_mfma_f32_16x16x32_bf16 v[12:15], v[20:23], v[212:215], v[12:15]
    v_and_b32_dpp v16, v24, v4 row_newbcast:4 row_mask:0xf bank_mask:0xf
    v_and_b32_dpp v17, v24, v5 row_newbcast:4 row_mask:0xf bank_mask:0xf
    v_and_b32_dpp v18, v24, v6 row_newbcast:4 row_mask:0xf bank_mask:0xf
    v_and_b32_dpp v19, v24, v7 row_newbcast:4 row_mask:0xf bank_mask:0xf
    s_nop 1
    v_mfma_f32_16x16x32_bf16 v[12:15], v[16:19], v[216:219], v[12:15]
    v_and_b32_dpp v20, v24, v4 row_newbcast:12 row_mask:0xf bank_mask:0xf
    v_and_b32_dpp v21, v24, v5 row_newbcast:12 row_mask:0xf bank_mask:0xf
    v_and_b32_dpp v22, v24, v6 row_newbcast:12 row_mask:0xf bank_mask:0xf
    v_and_b32_dpp v23, v24, v7 row_newbcast:12 row_mask:0xf bank_mask:0xf
    s_nop 1
    v_mfma_f32_16x16x32_bf16 v[12:15], v[20:23], v[220:223], v[12:15]
    v_and_b32_dpp v16, v24, v4 row_newbcast:2 row_mask:0xf bank_mask:0xf
    v_and_b32_dpp v17, v24, v5 row_newbcast:2 row_mask:0xf bank_mask:0xf
    v_and_b32_dpp v18, v24, v6 row_newbcast:2 row_mask:0xf bank_mask:0xf
    v_and_b32_dpp v19, v24, v7 row_newbcast:2 row_mask:0xf bank_mask:0xf
    s_nop 1
    v_mfma_f32_16x16x32_bf16 v[12:15], v[16:19], v[228:231], v[12:15]
    v_and_b32_dpp v20, v24, v4 row_newbcast:10 row_mask:0xf bank_mask:0xf
    v_and_b32_dpp v21, v24, v5 row_newbcast:10 row_mask:0xf bank_mask:0xf
    v_and_b32_dpp v22, v24, v6 row_newbcast:10 row_mask:0xf bank_mask:0xf
    v_and_b32_dpp v23, v24, v7 row_newbcast:10 row_mask:0xf bank_mask:0xf
    s_waitcnt vmcnt(5)
    s_xor_b32 s60, s63, 49152
    buffer_load_dwordx4 v[140:143], v2, s[12:15], s60 offen offset:0 nt
    v_fma_f32 v25, v25, s91, -v50
    v_exp_f32 v25, v25
    s_nop 0
    v_mul_f32 v25, v25, v44
    v_cvt_pk_bf16_f32 v25, v25, v25
    v_mfma_f32_16x16x32_bf16 v[12:15], v[20:23], v[232:235], v[12:15]
    v_and_b32_dpp v16, v24, v4 row_newbcast:6 row_mask:0xf bank_mask:0xf
    v_and_b32_dpp v17, v24, v5 row_newbcast:6 row_mask:0xf bank_mask:0xf
    v_and_b32_dpp v18, v24, v6 row_newbcast:6 row_mask:0xf bank_mask:0xf
    v_and_b32_dpp v19, v24, v7 row_newbcast:6 row_mask:0xf bank_mask:0xf
    s_nop 1
    v_mfma_f32_16x16x32_bf16 v[12:15], v[16:19], v[236:239], v[12:15]
    v_and_b32_dpp v20, v24, v4 row_newbcast:14 row_mask:0xf bank_mask:0xf
    v_and_b32_dpp v21, v24, v5 row_newbcast:14 row_mask:0xf bank_mask:0xf
    v_and_b32_dpp v22, v24, v6 row_newbcast:14 row_mask:0xf bank_mask:0xf
    v_and_b32_dpp v23, v24, v7 row_newbcast:14 row_mask:0xf bank_mask:0xf
    s_waitcnt vmcnt(5)
    s_nop 0
    v_mfma_f32_16x16x32_bf16 v[12:15], v[20:23], v[240:243], v[12:15]
    v_and_b32_dpp v16, v24, v4 row_newbcast:1 row_mask:0xf bank_mask:0xf
    v_and_b32_dpp v17, v24, v5 row_newbcast:1 row_mask:0xf bank_mask:0xf
    v_and_b32_dpp v18, v24, v6 row_newbcast:1 row_mask:0xf bank_mask:0xf
    v_and_b32_dpp v19, v24, v7 row_newbcast:1 row_mask:0xf bank_mask:0xf
    buffer_load_dwordx4 v[148:151], v2, s[12:15], s60 offen offset:1024 nt
    s_waitcnt vmcnt(5)
    v_mfma_f32_16x16x32_bf16 v[12:15], v[16:19], v[248:251], v[12:15]
    v_and_b32_dpp v20, v24, v4 row_newbcast:9 row_mask:0xf bank_mask:0xf
    v_and_b32_dpp v21, v24, v5 row_newbcast:9 row_mask:0xf bank_mask:0xf
    v_and_b32_dpp v22, v24, v6 row_newbcast:9 row_mask:0xf bank_mask:0xf
    v_and_b32_dpp v23, v24, v7 row_newbcast:9 row_mask:0xf bank_mask:0xf
    buffer_load_dwordx4 v[152:155], v2, s[12:15], s60 offen offset:2048 nt
    s_waitcnt vmcnt(5)
    v_mfma_f32_16x16x32_bf16 v[12:15], v[20:23], v[252:255], v[12:15]
    v_and_b32_dpp v16, v24, v4 row_newbcast:5 row_mask:0xf bank_mask:0xf
    v_and_b32_dpp v17, v24, v5 row_newbcast:5 row_mask:0xf bank_mask:0xf
    v_and_b32_dpp v18, v24, v6 row_newbcast:5 row_mask:0xf bank_mask:0xf
    v_and_b32_dpp v19, v24, v7 row_newbcast:5 row_mask:0xf bank_mask:0xf
    buffer_load_dwordx4 v[156:159], v2, s[12:15], s60 offen offset:3072 nt
    s_waitcnt vmcnt(5)
    v_mfma_f32_16x16x32_bf16 v[12:15], v[16:19], v[128:131], v[12:15]
    v_and_b32_dpp v20, v24, v4 row_newbcast:13 row_mask:0xf bank_mask:0xf
    v_and_b32_dpp v21, v24, v5 row_newbcast:13 row_mask:0xf bank_mask:0xf
    v_and_b32_dpp v22, v24, v6 row_newbcast:13 row_mask:0xf bank_mask:0xf
    v_and_b32_dpp v23, v24, v7 row_newbcast:13 row_mask:0xf bank_mask:0xf
    s_xor_b32 s60, s63, 65536
    buffer_load_dwordx4 v[168:171], v2, s[12:15], s60 offen offset:0 nt
    s_waitcnt vmcnt(5)
    v_mfma_f32_16x16x32_bf16 v[12:15], v[20:23], v[132:135], v[12:15]
    v_and_b32_dpp v16, v24, v4 row_newbcast:3 row_mask:0xf bank_mask:0xf
    v_and_b32_dpp v17, v24, v5 row_newbcast:3 row_mask:0xf bank_mask:0xf
    v_and_b32_dpp v18, v24, v6 row_newbcast:3 row_mask:0xf bank_mask:0xf
    v_and_b32_dpp v19, v24, v7 row_newbcast:3 row_mask:0xf bank_mask:0xf
    buffer_load_dwordx4 v[172:175], v2, s[12:15], s60 offen offset:1024 nt
    s_waitcnt vmcnt(5)
    v_mfma_f32_16x16x32_bf16 v[12:15], v[16:19], v[140:143], v[12:15]
    v_and_b32_dpp v20, v24, v4 row_newbcast:11 row_mask:0xf bank_mask:0xf
    v_and_b32_dpp v21, v24, v5 row_newbcast:11 row_mask:0xf bank_mask:0xf
    v_and_b32_dpp v22, v24, v6 row_newbcast:11 row_mask:0xf bank_mask:0xf
    v_and_b32_dpp v23, v24, v7 row_newbcast:11 row_mask:0xf bank_mask:0xf
    buffer_load_dwordx4 v[176:179], v2, s[12:15], s60 offen offset:2048 nt
    s_waitcnt vmcnt(5)
    v_mfma_f32_16x16x32_bf16 v[12:15], v[20:23], v[148:151], v[12:15]
    v_and_b32_dpp v16, v24, v4 row_newbcast:7 row_mask:0xf bank_mask:0xf
    v_and_b32_dpp v17, v24, v5 row_newbcast:7 row_mask:0xf bank_mask:0xf
    v_and_b32_dpp v18, v24, v6 row_newbcast:7 row_mask:0xf bank_mask:0xf
    v_and_b32_dpp v19, v24, v7 row_newbcast:7 row_mask:0xf bank_mask:0xf
    buffer_load_dwordx4 v[180:183], v2, s[12:15], s60 offen offset:3072 nt
    s_waitcnt vmcnt(5)
    v_mfma_f32_16x16x32_bf16 v[12:15], v[16:19], v[152:155], v[12:15]
    v_and_b32_dpp v20, v24, v4 row_newbcast:15 row_mask:0xf bank_mask:0xf
    v_and_b32_dpp v21, v24, v5 row_newbcast:15 row_mask:0xf bank_mask:0xf
    v_and_b32_dpp v22, v24, v6 row_newbcast:15 row_mask:0xf bank_mask:0xf
    v_and_b32_dpp v23, v24, v7 row_newbcast:15 row_mask:0xf bank_mask:0xf
    s_xor_b32 s60, s63, 81920
    buffer_load_dwordx4 v[64:67], v2, s[12:15], s60 offen offset:0 nt
    s_waitcnt vmcnt(5)
    v_mfma_f32_16x16x32_bf16 v[12:15], v[20:23], v[156:159], v[12:15]
    v_and_b32_dpp v16, v25, v4 row_newbcast:0 row_mask:0xf bank_mask:0xf
    v_and_b32_dpp v17, v25, v5 row_newbcast:0 row_mask:0xf bank_mask:0xf
    v_and_b32_dpp v18, v25, v6 row_newbcast:0 row_mask:0xf bank_mask:0xf
    v_and_b32_dpp v19, v25, v7 row_newbcast:0 row_mask:0xf bank_mask:0xf
    buffer_load_dwordx4 v[68:71], v2, s[12:15], s60 offen offset:1024 nt
    s_waitcnt vmcnt(5)
    v_mfma_f32_16x16x32_bf16 v[12:15], v[16:19], v[168:171], v[12:15]
    v_and_b32_dpp v20, v25, v4 row_newbcast:8 row_mask:0xf bank_mask:0xf
    v_and_b32_dpp v21, v25, v5 row_newbcast:8 row_mask:0xf bank_mask:0xf
    v_and_b32_dpp v22, v25, v6 row_newbcast:8 row_mask:0xf bank_mask:0xf
    v_and_b32_dpp v23, v25, v7 row_newbcast:8 row_mask:0xf bank_mask:0xf
    buffer_load_dwordx4 v[72:75], v2, s[12:15], s60 offen offset:2048 nt
    s_waitcnt vmcnt(5)
    v_mfma_f32_16x16x32_bf16 v[12:15], v[20:23], v[172:175], v[12:15]
    v_and_b32_dpp v16, v25, v4 row_newbcast:4 row_mask:0xf bank_mask:0xf
    v_and_b32_dpp v17, v25, v5 row_newbcast:4 row_mask:0xf bank_mask:0xf
    v_and_b32_dpp v18, v25, v6 row_newbcast:4 row_mask:0xf bank_mask:0xf
    v_and_b32_dpp v19, v25, v7 row_newbcast:4 row_mask:0xf bank_mask:0xf
    buffer_load_dwordx4 v[76:79], v2, s[12:15], s60 offen offset:3072 nt
    s_waitcnt vmcnt(5)
    v_mfma_f32_16x16x32_bf16 v[12:15], v[16:19], v[176:179], v[12:15]
    v_and_b32_dpp v20, v25, v4 row_newbcast:12 row_mask:0xf bank_mask:0xf
    v_and_b32_dpp v21, v25, v5 row_newbcast:12 row_mask:0xf bank_mask:0xf
    v_and_b32_dpp v22, v25, v6 row_newbcast:12 row_mask:0xf bank_mask:0xf
    v_and_b32_dpp v23, v25, v7 row_newbcast:12 row_mask:0xf bank_mask:0xf
    s_xor_b32 s60, s63, 98304
    buffer_load_dwordx4 v[80:83], v2, s[12:15], s60 offen offset:0 nt
    s_waitcnt vmcnt(5)
    v_mfma_f32_16x16x32_bf16 v[12:15], v[20:23], v[180:183], v[12:15]
    v_and_b32_dpp v16, v25, v4 row_newbcast:2 row_mask:0xf bank_mask:0xf
    v_and_b32_dpp v17, v25, v5 row_newbcast:2 row_mask:0xf bank_mask:0xf
    v_and_b32_dpp v18, v25, v6 row_newbcast:2 row_mask:0xf bank_mask:0xf
    v_and_b32_dpp v19, v25, v7 row_newbcast:2 row_mask:0xf bank_mask:0xf
    buffer_load_dwordx4 v[84:87], v2, s[12:15], s60 offen offset:1024 nt
    s_waitcnt vmcnt(5)
    v_mfma_f32_16x16x32_bf16 v[12:15], v[16:19], v[64:67], v[12:15]
    v_and_b32_dpp v20, v25, v4 row_newbcast:10 row_mask:0xf bank_mask:0xf
    v_and_b32_dpp v21, v25, v5 row_newbcast:10 row_mask:0xf bank_mask:0xf
    v_and_b32_dpp v22, v25, v6 row_newbcast:10 row_mask:0xf bank_mask:0xf
    v_and_b32_dpp v23, v25, v7 row_newbcast:10 row_mask:0xf bank_mask:0xf
    buffer_load_dwordx4 v[88:91], v2, s[12:15], s60 offen offset:2048 nt
    v_fma_f32 v26, v26, s91, -v50
    v_exp_f32 v26, v26
    s_nop 0
    v_mul_f32 v26, v26, v44
    v_cvt_pk_bf16_f32 v26, v26, v26
    s_waitcnt vmcnt(5)
    v_mfma_f32_16x16x32_bf16 v[12:15], v[20:23], v[68:71], v[12:15]
    v_and_b32_dpp v16, v25, v4 row_newbcast:6 row_mask:0xf bank_mask:0xf
    v_and_b32_dpp v17, v25, v5 row_newbcast:6 row_mask:0xf bank_mask:0xf
    v_and_b32_dpp v18, v25, v6 row_newbcast:6 row_mask:0xf bank_mask:0xf
    v_and_b32_dpp v19, v25, v7 row_newbcast:6 row_mask:0xf bank_mask:0xf
    buffer_load_dwordx4 v[92:95], v2, s[12:15], s60 offen offset:3072 nt
    s_waitcnt vmcnt(5)
    v_mfma_f32_16x16x32_bf16 v[12:15], v[16:19], v[72:75], v[12:15]
    v_and_b32_dpp v20, v25, v4 row_newbcast:14 row_mask:0xf bank_mask:0xf
    v_and_b32_dpp v21, v25, v5 row_newbcast:14 row_mask:0xf bank_mask:0xf
    v_and_b32_dpp v22, v25, v6 row_newbcast:14 row_mask:0xf bank_mask:0xf
    v_and_b32_dpp v23, v25, v7 row_newbcast:14 row_mask:0xf bank_mask:0xf
    s_xor_b32 s60, s63, 114688
    buffer_load_dwordx4 v[96:99], v2, s[12:15], s60 offen offset:0 nt
    s_waitcnt vmcnt(5)
    v_mfma_f32_16x16x32_bf16 v[12:15], v[20:23], v[76:79], v[12:15]
    v_and_b32_dpp v16, v25, v4 row_newbcast:1 row_mask:0xf bank_mask:0xf
    v_and_b32_dpp v17, v25, v5 row_newbcast:1 row_mask:0xf bank_mask:0xf
    v_and_b32_dpp v18, v25, v6 row_newbcast:1 row_mask:0xf bank_mask:0xf
    v_and_b32_dpp v19, v25, v7 row_newbcast:1 row_mask:0xf bank_mask:0xf
    buffer_load_dwordx4 v[100:103], v2, s[12:15], s60 offen offset:1024 nt
    s_waitcnt vmcnt(5)
    v_mfma_f32_16x16x32_bf16 v[12:15], v[16:19], v[80:83], v[12:15]
    v_and_b32_dpp v20, v25, v4 row_newbcast:9 row_mask:0xf bank_mask:0xf
    v_and_b32_dpp v21, v25, v5 row_newbcast:9 row_mask:0xf bank_mask:0xf
    v_and_b32_dpp v22, v25, v6 row_newbcast:9 row_mask:0xf bank_mask:0xf
    v_and_b32_dpp v23, v25, v7 row_newbcast:9 row_mask:0xf bank_mask:0xf
    buffer_load_dwordx4 v[104:107], v2, s[12:15], s60 offen offset:2048 nt
    s_waitcnt vmcnt(5)
    v_mfma_f32_16x16x32_bf16 v[12:15], v[20:23], v[84:87], v[12:15]
    v_and_b32_dpp v16, v25, v4 row_newbcast:5 row_mask:0xf bank_mask:0xf
    v_and_b32_dpp v17, v25, v5 row_newbcast:5 row_mask:0xf bank_mask:0xf
    v_and_b32_dpp v18, v25, v6 row_newbcast:5 row_mask:0xf bank_mask:0xf
    v_and_b32_dpp v19, v25, v7 row_newbcast:5 row_mask:0xf bank_mask:0xf
    buffer_load_dwordx4 v[108:111], v2, s[12:15], s60 offen offset:3072 nt
    s_waitcnt vmcnt(5)
    v_mfma_f32_16x16x32_bf16 v[12:15], v[16:19], v[88:91], v[12:15]
    v_and_b32_dpp v20, v25, v4 row_newbcast:13 row_mask:0xf bank_mask:0xf
    v_and_b32_dpp v21, v25, v5 row_newbcast:13 row_mask:0xf bank_mask:0xf
    v_and_b32_dpp v22, v25, v6 row_newbcast:13 row_mask:0xf bank_mask:0xf
    v_and_b32_dpp v23, v25, v7 row_newbcast:13 row_mask:0xf bank_mask:0xf
    s_xor_b32 s60, s63, 131072
    buffer_load_dwordx4 v[112:115], v2, s[12:15], s60 offen offset:0 nt
    s_waitcnt vmcnt(5)
    v_mfma_f32_16x16x32_bf16 v[12:15], v[20:23], v[92:95], v[12:15]
    v_and_b32_dpp v16, v25, v4 row_newbcast:3 row_mask:0xf bank_mask:0xf
    v_and_b32_dpp v17, v25, v5 row_newbcast:3 row_mask:0xf bank_mask:0xf
    v_and_b32_dpp v18, v25, v6 row_newbcast:3 row_mask:0xf bank_mask:0xf
    v_and_b32_dpp v19, v25, v7 row_newbcast:3 row_mask:0xf bank_mask:0xf
    buffer_load_dwordx4 v[116:119], v2, s[12:15], s60 offen offset:1024 nt
    s_waitcnt vmcnt(5)
    v_mfma_f32_16x16x32_bf16 v[12:15], v[16:19], v[96:99], v[12:15]
    v_and_b32_dpp v20, v25, v4 row_newbcast:11 row_mask:0xf bank_mask:0xf
    v_and_b32_dpp v21, v25, v5 row_newbcast:11 row_mask:0xf bank_mask:0xf
    v_and_b32_dpp v22, v25, v6 row_newbcast:11 row_mask:0xf bank_mask:0xf
    v_and_b32_dpp v23, v25, v7 row_newbcast:11 row_mask:0xf bank_mask:0xf
    buffer_load_dwordx4 v[120:123], v2, s[12:15], s60 offen offset:2048 nt
    s_waitcnt vmcnt(5)
    v_mfma_f32_16x16x32_bf16 v[12:15], v[20:23], v[100:103], v[12:15]
    v_and_b32_dpp v16, v25, v4 row_newbcast:7 row_mask:0xf bank_mask:0xf
    v_and_b32_dpp v17, v25, v5 row_newbcast:7 row_mask:0xf bank_mask:0xf
    v_and_b32_dpp v18, v25, v6 row_newbcast:7 row_mask:0xf bank_mask:0xf
    v_and_b32_dpp v19, v25, v7 row_newbcast:7 row_mask:0xf bank_mask:0xf
    buffer_load_dwordx4 v[124:127], v2, s[12:15], s60 offen offset:3072 nt
    s_waitcnt vmcnt(5)
    v_mfma_f32_16x16x32_bf16 v[12:15], v[16:19], v[104:107], v[12:15]
    v_and_b32_dpp v20, v25, v4 row_newbcast:15 row_mask:0xf bank_mask:0xf
    v_and_b32_dpp v21, v25, v5 row_newbcast:15 row_mask:0xf bank_mask:0xf
    v_and_b32_dpp v22, v25, v6 row_newbcast:15 row_mask:0xf bank_mask:0xf
    v_and_b32_dpp v23, v25, v7 row_newbcast:15 row_mask:0xf bank_mask:0xf
    s_xor_b32 s60, s63, 147456
    buffer_load_dwordx4 v[144:147], v2, s[12:15], s60 offen offset:0 nt
    s_waitcnt vmcnt(5)
    v_mfma_f32_16x16x32_bf16 v[12:15], v[20:23], v[108:111], v[12:15]
    v_and_b32_dpp v16, v26, v4 row_newbcast:0 row_mask:0xf bank_mask:0xf
    v_and_b32_dpp v17, v26, v5 row_newbcast:0 row_mask:0xf bank_mask:0xf
    v_and_b32_dpp v18, v26, v6 row_newbcast:0 row_mask:0xf bank_mask:0xf
    v_and_b32_dpp v19, v26, v7 row_newbcast:0 row_mask:0xf bank_mask:0xf
    buffer_load_dwordx4 v[164:167], v2, s[12:15], s60 offen offset:1024 nt
    s_waitcnt vmcnt(5)
    v_mfma_f32_16x16x32_bf16 v[12:15], v[16:19], v[112:115], v[12:15]
    v_and_b32_dpp v20, v26, v4 row_newbcast:8 row_mask:0xf bank_mask:0xf
    v_and_b32_dpp v21, v26, v5 row_newbcast:8 row_mask:0xf bank_mask:0xf
    v_and_b32_dpp v22, v26, v6 row_newbcast:8 row_mask:0xf bank_mask:0xf
    v_and_b32_dpp v23, v26, v7 row_newbcast:8 row_mask:0xf bank_mask:0xf
    buffer_load_dwordx4 v[184:187], v2, s[12:15], s60 offen offset:2048 nt
    s_waitcnt vmcnt(5)
    v_mfma_f32_16x16x32_bf16 v[12:15], v[20:23], v[116:119], v[12:15]
    v_and_b32_dpp v16, v26, v4 row_newbcast:4 row_mask:0xf bank_mask:0xf
    v_and_b32_dpp v17, v26, v5 row_newbcast:4 row_mask:0xf bank_mask:0xf
    v_and_b32_dpp v18, v26, v6 row_newbcast:4 row_mask:0xf bank_mask:0xf
    v_and_b32_dpp v19, v26, v7 row_newbcast:4 row_mask:0xf bank_mask:0xf
    buffer_load_dwordx4 v[204:207], v2, s[12:15], s60 offen offset:3072 nt
    s_waitcnt vmcnt(5)
    v_mfma_f32_16x16x32_bf16 v[12:15], v[16:19], v[120:123], v[12:15]
    v_and_b32_dpp v20, v26, v4 row_newbcast:12 row_mask:0xf bank_mask:0xf
    v_and_b32_dpp v21, v26, v5 row_newbcast:12 row_mask:0xf bank_mask:0xf
    v_and_b32_dpp v22, v26, v6 row_newbcast:12 row_mask:0xf bank_mask:0xf
    v_and_b32_dpp v23, v26, v7 row_newbcast:12 row_mask:0xf bank_mask:0xf
    s_xor_b32 s60, s63, 163840
    buffer_load_dwordx4 v[224:227], v2, s[12:15], s60 offen offset:0 nt
    s_waitcnt vmcnt(5)
    v_mfma_f32_16x16x32_bf16 v[12:15], v[20:23], v[124:127], v[12:15]
    v_and_b32_dpp v16, v26, v4 row_newbcast:2 row_mask:0xf bank_mask:0xf
    v_and_b32_dpp v17, v26, v5 row_newbcast:2 row_mask:0xf bank_mask:0xf
    v_and_b32_dpp v18, v26, v6 row_newbcast:2 row_mask:0xf bank_mask:0xf
    v_and_b32_dpp v19, v26, v7 row_newbcast:2 row_mask:0xf bank_mask:0xf
    buffer_load_dwordx4 v[244:247], v2, s[12:15], s60 offen offset:1024 nt
    s_waitcnt vmcnt(5)
    v_mfma_f32_16x16x32_bf16 v[12:15], v[16:19], v[144:147], v[12:15]
    v_and_b32_dpp v20, v26, v4 row_newbcast:10 row_mask:0xf bank_mask:0xf
    v_and_b32_dpp v21, v26, v5 row_newbcast:10 row_mask:0xf bank_mask:0xf
    v_and_b32_dpp v22, v26, v6 row_newbcast:10 row_mask:0xf bank_mask:0xf
    v_and_b32_dpp v23, v26, v7 row_newbcast:10 row_mask:0xf bank_mask:0xf
    buffer_load_dwordx4 v[136:139], v2, s[12:15], s60 offen offset:2048 nt
    v_fma_f32 v27, v27, s91, -v50
    v_exp_f32 v27, v27
    s_nop 0
    v_mul_f32 v27, v27, v44
    v_cvt_pk_bf16_f32 v27, v27, v27
    s_waitcnt vmcnt(5)
    v_mfma_f32_16x16x32_bf16 v[12:15], v[20:23], v[164:167], v[12:15]
    v_and_b32_dpp v16, v26, v4 row_newbcast:6 row_mask:0xf bank_mask:0xf
    v_and_b32_dpp v17, v26, v5 row_newbcast:6 row_mask:0xf bank_mask:0xf
    v_and_b32_dpp v18, v26, v6 row_newbcast:6 row_mask:0xf bank_mask:0xf
    v_and_b32_dpp v19, v26, v7 row_newbcast:6 row_mask:0xf bank_mask:0xf
    buffer_load_dwordx4 v[160:163], v2, s[12:15], s60 offen offset:3072 nt
    s_waitcnt vmcnt(5)
    v_mfma_f32_16x16x32_bf16 v[12:15], v[16:19], v[184:187], v[12:15]
    v_and_b32_dpp v20, v26, v4 row_newbcast:14 row_mask:0xf bank_mask:0xf
    v_and_b32_dpp v21, v26, v5 row_newbcast:14 row_mask:0xf bank_mask:0xf
    v_and_b32_dpp v22, v26, v6 row_newbcast:14 row_mask:0xf bank_mask:0xf
    v_and_b32_dpp v23, v26, v7 row_newbcast:14 row_mask:0xf bank_mask:0xf
    s_xor_b32 s60, s63, 180224
    buffer_load_dwordx4 v[188:191], v2, s[12:15], s60 offen offset:0 nt
    s_waitcnt vmcnt(5)
    v_mfma_f32_16x16x32_bf16 v[12:15], v[20:23], v[204:207], v[12:15]
    v_and_b32_dpp v16, v26, v4 row_newbcast:1 row_mask:0xf bank_mask:0xf
    v_and_b32_dpp v17, v26, v5 row_newbcast:1 row_mask:0xf bank_mask:0xf
    v_and_b32_dpp v18, v26, v6 row_newbcast:1 row_mask:0xf bank_mask:0xf
    v_and_b32_dpp v19, v26, v7 row_newbcast:1 row_mask:0xf bank_mask:0xf
    buffer_load_dwordx4 v[192:195], v2, s[12:15], s60 offen offset:1024 nt
    s_waitcnt vmcnt(5)
    v_mfma_f32_16x16x32_bf16 v[12:15], v[16:19], v[224:227], v[12:15]
    v_and_b32_dpp v20, v26, v4 row_newbcast:9 row_mask:0xf bank_mask:0xf
    v_and_b32_dpp v21, v26, v5 row_newbcast:9 row_mask:0xf bank_mask:0xf
    v_and_b32_dpp v22, v26, v6 row_newbcast:9 row_mask:0xf bank_mask:0xf
    v_and_b32_dpp v23, v26, v7 row_newbcast:9 row_mask:0xf bank_mask:0xf
    buffer_load_dwordx4 v[196:199], v2, s[12:15], s60 offen offset:2048 nt
    s_waitcnt vmcnt(5)
    v_mfma_f32_16x16x32_bf16 v[12:15], v[20:23], v[244:247], v[12:15]
    v_and_b32_dpp v16, v26, v4 row_newbcast:5 row_mask:0xf bank_mask:0xf
    v_and_b32_dpp v17, v26, v5 row_newbcast:5 row_mask:0xf bank_mask:0xf
    v_and_b32_dpp v18, v26, v6 row_newbcast:5 row_mask:0xf bank_mask:0xf
    v_and_b32_dpp v19, v26, v7 row_newbcast:5 row_mask:0xf bank_mask:0xf
    buffer_load_dwordx4 v[200:203], v2, s[12:15], s60 offen offset:3072 nt
    s_waitcnt vmcnt(5)
    v_mfma_f32_16x16x32_bf16 v[12:15], v[16:19], v[136:139], v[12:15]
    v_and_b32_dpp v20, v26, v4 row_newbcast:13 row_mask:0xf bank_mask:0xf
    v_and_b32_dpp v21, v26, v5 row_newbcast:13 row_mask:0xf bank_mask:0xf
    v_and_b32_dpp v22, v26, v6 row_newbcast:13 row_mask:0xf bank_mask:0xf
    v_and_b32_dpp v23, v26, v7 row_newbcast:13 row_mask:0xf bank_mask:0xf
    s_xor_b32 s60, s63, 196608
    buffer_load_dwordx4 v[208:211], v2, s[12:15], s60 offen offset:0 nt
    s_waitcnt vmcnt(5)
    v_mfma_f32_16x16x32_bf16 v[12:15], v[20:23], v[160:163], v[12:15]
    v_and_b32_dpp v16, v26, v4 row_newbcast:3 row_mask:0xf bank_mask:0xf
    v_and_b32_dpp v17, v26, v5 row_newbcast:3 row_mask:0xf bank_mask:0xf
    v_and_b32_dpp v18, v26, v6 row_newbcast:3 row_mask:0xf bank_mask:0xf
    v_and_b32_dpp v19, v26, v7 row_newbcast:3 row_mask:0xf bank_mask:0xf
    buffer_load_dwordx4 v[212:215], v2, s[12:15], s60 offen offset:1024 nt
    s_waitcnt vmcnt(5)
    v_mfma_f32_16x16x32_bf16 v[12:15], v[16:19], v[188:191], v[12:15]
    v_and_b32_dpp v20, v26, v4 row_newbcast:11 row_mask:0xf bank_mask:0xf
    v_and_b32_dpp v21, v26, v5 row_newbcast:11 row_mask:0xf bank_mask:0xf
    v_and_b32_dpp v22, v26, v6 row_newbcast:11 row_mask:0xf bank_mask:0xf
    v_and_b32_dpp v23, v26, v7 row_newbcast:11 row_mask:0xf bank_mask:0xf
    buffer_load_dwordx4 v[216:219], v2, s[12:15], s60 offen offset:2048 nt
    s_waitcnt vmcnt(5)
    v_mfma_f32_16x16x32_bf16 v[12:15], v[20:23], v[192:195], v[12:15]
    v_and_b32_dpp v16, v26, v4 row_newbcast:7 row_mask:0xf bank_mask:0xf
    v_and_b32_dpp v17, v26, v5 row_newbcast:7 row_mask:0xf bank_mask:0xf
    v_and_b32_dpp v18, v26, v6 row_newbcast:7 row_mask:0xf bank_mask:0xf
    v_and_b32_dpp v19, v26, v7 row_newbcast:7 row_mask:0xf bank_mask:0xf
    buffer_load_dwordx4 v[220:223], v2, s[12:15], s60 offen offset:3072 nt
    s_waitcnt vmcnt(5)
    v_mfma_f32_16x16x32_bf16 v[12:15], v[16:19], v[196:199], v[12:15]
    v_and_b32_dpp v20, v26, v4 row_newbcast:15 row_mask:0xf bank_mask:0xf
    v_and_b32_dpp v21, v26, v5 row_newbcast:15 row_mask:0xf bank_mask:0xf
    v_and_b32_dpp v22, v26, v6 row_newbcast:15 row_mask:0xf bank_mask:0xf
    v_and_b32_dpp v23, v26, v7 row_newbcast:15 row_mask:0xf bank_mask:0xf
    s_xor_b32 s60, s63, 212992
    buffer_load_dwordx4 v[228:231], v2, s[12:15], s60 offen offset:0 nt
    s_waitcnt vmcnt(5)
    v_mfma_f32_16x16x32_bf16 v[12:15], v[20:23], v[200:203], v[12:15]
    v_and_b32_dpp v16, v27, v4 row_newbcast:0 row_mask:0xf bank_mask:0xf
    v_and_b32_dpp v17, v27, v5 row_newbcast:0 row_mask:0xf bank_mask:0xf
    v_and_b32_dpp v18, v27, v6 row_newbcast:0 row_mask:0xf bank_mask:0xf
    v_and_b32_dpp v19, v27, v7 row_newbcast:0 row_mask:0xf bank_mask:0xf
    buffer_load_dwordx4 v[232:235], v2, s[12:15], s60 offen offset:1024 nt
    s_waitcnt vmcnt(5)
    v_mfma_f32_16x16x32_bf16 v[12:15], v[16:19], v[208:211], v[12:15]
    v_and_b32_dpp v20, v27, v4 row_newbcast:8 row_mask:0xf bank_mask:0xf
    v_and_b32_dpp v21, v27, v5 row_newbcast:8 row_mask:0xf bank_mask:0xf
    v_and_b32_dpp v22, v27, v6 row_newbcast:8 row_mask:0xf bank_mask:0xf
    v_and_b32_dpp v23, v27, v7 row_newbcast:8 row_mask:0xf bank_mask:0xf
    buffer_load_dwordx4 v[236:239], v2, s[12:15], s60 offen offset:2048 nt
    s_waitcnt vmcnt(5)
    v_mfma_f32_16x16x32_bf16 v[12:15], v[20:23], v[212:215], v[12:15]
    v_and_b32_dpp v16, v27, v4 row_newbcast:4 row_mask:0xf bank_mask:0xf
    v_and_b32_dpp v17, v27, v5 row_newbcast:4 row_mask:0xf bank_mask:0xf
    v_and_b32_dpp v18, v27, v6 row_newbcast:4 row_mask:0xf bank_mask:0xf
    v_and_b32_dpp v19, v27, v7 row_newbcast:4 row_mask:0xf bank_mask:0xf
    buffer_load_dwordx4 v[240:243], v2, s[12:15], s60 offen offset:3072 nt
    s_waitcnt vmcnt(5)
    v_mfma_f32_16x16x32_bf16 v[12:15], v[16:19], v[216:219], v[12:15]
    v_and_b32_dpp v20, v27, v4 row_newbcast:12 row_mask:0xf bank_mask:0xf
    v_and_b32_dpp v21, v27, v5 row_newbcast:12 row_mask:0xf bank_mask:0xf
    v_and_b32_dpp v22, v27, v6 row_newbcast:12 row_mask:0xf bank_mask:0xf
    v_and_b32_dpp v23, v27, v7 row_newbcast:12 row_mask:0xf bank_mask:0xf
    s_xor_b32 s60, s63, 229376
    buffer_load_dwordx4 v[248:251], v2, s[12:15], s60 offen offset:0 nt
    s_waitcnt vmcnt(5)
    v_mfma_f32_16x16x32_bf16 v[12:15], v[20:23], v[220:223], v[12:15]
    v_and_b32_dpp v16, v27, v4 row_newbcast:2 row_mask:0xf bank_mask:0xf
    v_and_b32_dpp v17, v27, v5 row_newbcast:2 row_mask:0xf bank_mask:0xf
    v_and_b32_dpp v18, v27, v6 row_newbcast:2 row_mask:0xf bank_mask:0xf
    v_and_b32_dpp v19, v27, v7 row_newbcast:2 row_mask:0xf bank_mask:0xf
    buffer_load_dwordx4 v[252:255], v2, s[12:15], s60 offen offset:1024 nt
    s_waitcnt vmcnt(5)
    v_mfma_f32_16x16x32_bf16 v[12:15], v[16:19], v[228:231], v[12:15]
    v_and_b32_dpp v20, v27, v4 row_newbcast:10 row_mask:0xf bank_mask:0xf
    v_and_b32_dpp v21, v27, v5 row_newbcast:10 row_mask:0xf bank_mask:0xf
    v_and_b32_dpp v22, v27, v6 row_newbcast:10 row_mask:0xf bank_mask:0xf
    v_and_b32_dpp v23, v27, v7 row_newbcast:10 row_mask:0xf bank_mask:0xf
    buffer_load_dwordx4 v[128:131], v2, s[12:15], s60 offen offset:2048 nt
    v_fma_f32 v28, v28, s91, -v50
    v_exp_f32 v28, v28
    s_nop 0
    v_mul_f32 v28, v28, v44
    v_cvt_pk_bf16_f32 v28, v28, v28
    s_waitcnt vmcnt(5)
    v_mfma_f32_16x16x32_bf16 v[12:15], v[20:23], v[232:235], v[12:15]
    v_and_b32_dpp v16, v27, v4 row_newbcast:6 row_mask:0xf bank_mask:0xf
    v_and_b32_dpp v17, v27, v5 row_newbcast:6 row_mask:0xf bank_mask:0xf
    v_and_b32_dpp v18, v27, v6 row_newbcast:6 row_mask:0xf bank_mask:0xf
    v_and_b32_dpp v19, v27, v7 row_newbcast:6 row_mask:0xf bank_mask:0xf
    buffer_load_dwordx4 v[132:135], v2, s[12:15], s60 offen offset:3072 nt
    s_waitcnt vmcnt(5)
    v_mfma_f32_16x16x32_bf16 v[12:15], v[16:19], v[236:239], v[12:15]
    v_and_b32_dpp v20, v27, v4 row_newbcast:14 row_mask:0xf bank_mask:0xf
    v_and_b32_dpp v21, v27, v5 row_newbcast:14 row_mask:0xf bank_mask:0xf
    v_and_b32_dpp v22, v27, v6 row_newbcast:14 row_mask:0xf bank_mask:0xf
    v_and_b32_dpp v23, v27, v7 row_newbcast:14 row_mask:0xf bank_mask:0xf
    s_xor_b32 s60, s63, 245760
    buffer_load_dwordx4 v[140:143], v2, s[12:15], s60 offen offset:0 nt
    s_waitcnt vmcnt(5)
    v_mfma_f32_16x16x32_bf16 v[12:15], v[20:23], v[240:243], v[12:15]
    v_and_b32_dpp v16, v27, v4 row_newbcast:1 row_mask:0xf bank_mask:0xf
    v_and_b32_dpp v17, v27, v5 row_newbcast:1 row_mask:0xf bank_mask:0xf
    v_and_b32_dpp v18, v27, v6 row_newbcast:1 row_mask:0xf bank_mask:0xf
    v_and_b32_dpp v19, v27, v7 row_newbcast:1 row_mask:0xf bank_mask:0xf
    buffer_load_dwordx4 v[148:151], v2, s[12:15], s60 offen offset:1024 nt
    s_waitcnt vmcnt(5)
    v_mfma_f32_16x16x32_bf16 v[12:15], v[16:19], v[248:251], v[12:15]
    v_and_b32_dpp v20, v27, v4 row_newbcast:9 row_mask:0xf bank_mask:0xf
    v_and_b32_dpp v21, v27, v5 row_newbcast:9 row_mask:0xf bank_mask:0xf
    v_and_b32_dpp v22, v27, v6 row_newbcast:9 row_mask:0xf bank_mask:0xf
    v_and_b32_dpp v23, v27, v7 row_newbcast:9 row_mask:0xf bank_mask:0xf
    buffer_load_dwordx4 v[152:155], v2, s[12:15], s60 offen offset:2048 nt
    s_waitcnt vmcnt(5)
    v_mfma_f32_16x16x32_bf16 v[12:15], v[20:23], v[252:255], v[12:15]
    v_and_b32_dpp v16, v27, v4 row_newbcast:5 row_mask:0xf bank_mask:0xf
    v_and_b32_dpp v17, v27, v5 row_newbcast:5 row_mask:0xf bank_mask:0xf
    v_and_b32_dpp v18, v27, v6 row_newbcast:5 row_mask:0xf bank_mask:0xf
    v_and_b32_dpp v19, v27, v7 row_newbcast:5 row_mask:0xf bank_mask:0xf
    buffer_load_dwordx4 v[156:159], v2, s[12:15], s60 offen offset:3072 nt
    s_waitcnt vmcnt(5)
    v_mfma_f32_16x16x32_bf16 v[12:15], v[16:19], v[128:131], v[12:15]
    v_and_b32_dpp v20, v27, v4 row_newbcast:13 row_mask:0xf bank_mask:0xf
    v_and_b32_dpp v21, v27, v5 row_newbcast:13 row_mask:0xf bank_mask:0xf
    v_and_b32_dpp v22, v27, v6 row_newbcast:13 row_mask:0xf bank_mask:0xf
    v_and_b32_dpp v23, v27, v7 row_newbcast:13 row_mask:0xf bank_mask:0xf
    s_xor_b32 s60, s63, 262144
    buffer_load_dwordx4 v[168:171], v2, s[12:15], s60 offen offset:0 nt
    s_waitcnt vmcnt(5)
    v_mfma_f32_16x16x32_bf16 v[12:15], v[20:23], v[132:135], v[12:15]
    v_and_b32_dpp v16, v27, v4 row_newbcast:3 row_mask:0xf bank_mask:0xf
    v_and_b32_dpp v17, v27, v5 row_newbcast:3 row_mask:0xf bank_mask:0xf
    v_and_b32_dpp v18, v27, v6 row_newbcast:3 row_mask:0xf bank_mask:0xf
    v_and_b32_dpp v19, v27, v7 row_newbcast:3 row_mask:0xf bank_mask:0xf
    buffer_load_dwordx4 v[172:175], v2, s[12:15], s60 offen offset:1024 nt
    s_waitcnt vmcnt(5)
    v_mfma_f32_16x16x32_bf16 v[12:15], v[16:19], v[140:143], v[12:15]
    v_and_b32_dpp v20, v27, v4 row_newbcast:11 row_mask:0xf bank_mask:0xf
    v_and_b32_dpp v21, v27, v5 row_newbcast:11 row_mask:0xf bank_mask:0xf
    v_and_b32_dpp v22, v27, v6 row_newbcast:11 row_mask:0xf bank_mask:0xf
    v_and_b32_dpp v23, v27, v7 row_newbcast:11 row_mask:0xf bank_mask:0xf
    buffer_load_dwordx4 v[176:179], v2, s[12:15], s60 offen offset:2048 nt
    s_waitcnt vmcnt(5)
    v_mfma_f32_16x16x32_bf16 v[12:15], v[20:23], v[148:151], v[12:15]
    v_and_b32_dpp v16, v27, v4 row_newbcast:7 row_mask:0xf bank_mask:0xf
    v_and_b32_dpp v17, v27, v5 row_newbcast:7 row_mask:0xf bank_mask:0xf
    v_and_b32_dpp v18, v27, v6 row_newbcast:7 row_mask:0xf bank_mask:0xf
    v_and_b32_dpp v19, v27, v7 row_newbcast:7 row_mask:0xf bank_mask:0xf
    buffer_load_dwordx4 v[180:183], v2, s[12:15], s60 offen offset:3072 nt
    s_waitcnt vmcnt(5)
    v_mfma_f32_16x16x32_bf16 v[12:15], v[16:19], v[152:155], v[12:15]
    v_and_b32_dpp v20, v27, v4 row_newbcast:15 row_mask:0xf bank_mask:0xf
    v_and_b32_dpp v21, v27, v5 row_newbcast:15 row_mask:0xf bank_mask:0xf
    v_and_b32_dpp v22, v27, v6 row_newbcast:15 row_mask:0xf bank_mask:0xf
    v_and_b32_dpp v23, v27, v7 row_newbcast:15 row_mask:0xf bank_mask:0xf
    s_xor_b32 s60, s63, 278528
    buffer_load_dwordx4 v[64:67], v2, s[12:15], s60 offen offset:0 nt
    s_waitcnt vmcnt(5)
    v_mfma_f32_16x16x32_bf16 v[12:15], v[20:23], v[156:159], v[12:15]
    v_and_b32_dpp v16, v28, v4 row_newbcast:0 row_mask:0xf bank_mask:0xf
    v_and_b32_dpp v17, v28, v5 row_newbcast:0 row_mask:0xf bank_mask:0xf
    v_and_b32_dpp v18, v28, v6 row_newbcast:0 row_mask:0xf bank_mask:0xf
    v_and_b32_dpp v19, v28, v7 row_newbcast:0 row_mask:0xf bank_mask:0xf
    buffer_load_dwordx4 v[68:71], v2, s[12:15], s60 offen offset:1024 nt
    s_waitcnt vmcnt(5)
    v_mfma_f32_16x16x32_bf16 v[12:15], v[16:19], v[168:171], v[12:15]
    v_and_b32_dpp v20, v28, v4 row_newbcast:8 row_mask:0xf bank_mask:0xf
    v_and_b32_dpp v21, v28, v5 row_newbcast:8 row_mask:0xf bank_mask:0xf
    v_and_b32_dpp v22, v28, v6 row_newbcast:8 row_mask:0xf bank_mask:0xf
    v_and_b32_dpp v23, v28, v7 row_newbcast:8 row_mask:0xf bank_mask:0xf
    buffer_load_dwordx4 v[72:75], v2, s[12:15], s60 offen offset:2048 nt
    s_waitcnt vmcnt(5)
    v_mfma_f32_16x16x32_bf16 v[12:15], v[20:23], v[172:175], v[12:15]
    v_and_b32_dpp v16, v28, v4 row_newbcast:4 row_mask:0xf bank_mask:0xf
    v_and_b32_dpp v17, v28, v5 row_newbcast:4 row_mask:0xf bank_mask:0xf
    v_and_b32_dpp v18, v28, v6 row_newbcast:4 row_mask:0xf bank_mask:0xf
    v_and_b32_dpp v19, v28, v7 row_newbcast:4 row_mask:0xf bank_mask:0xf
    buffer_load_dwordx4 v[76:79], v2, s[12:15], s60 offen offset:3072 nt
    s_waitcnt vmcnt(5)
    v_mfma_f32_16x16x32_bf16 v[12:15], v[16:19], v[176:179], v[12:15]
    v_and_b32_dpp v20, v28, v4 row_newbcast:12 row_mask:0xf bank_mask:0xf
    v_and_b32_dpp v21, v28, v5 row_newbcast:12 row_mask:0xf bank_mask:0xf
    v_and_b32_dpp v22, v28, v6 row_newbcast:12 row_mask:0xf bank_mask:0xf
    v_and_b32_dpp v23, v28, v7 row_newbcast:12 row_mask:0xf bank_mask:0xf
    s_xor_b32 s60, s63, 294912
    buffer_load_dwordx4 v[80:83], v2, s[12:15], s60 offen offset:0 nt
    s_waitcnt vmcnt(5)
    v_mfma_f32_16x16x32_bf16 v[12:15], v[20:23], v[180:183], v[12:15]
    v_and_b32_dpp v16, v28, v4 row_newbcast:2 row_mask:0xf bank_mask:0xf
    v_and_b32_dpp v17, v28, v5 row_newbcast:2 row_mask:0xf bank_mask:0xf
    v_and_b32_dpp v18, v28, v6 row_newbcast:2 row_mask:0xf bank_mask:0xf
    v_and_b32_dpp v19, v28, v7 row_newbcast:2 row_mask:0xf bank_mask:0xf
    buffer_load_dwordx4 v[84:87], v2, s[12:15], s60 offen offset:1024 nt
    s_waitcnt vmcnt(5)
    v_mfma_f32_16x16x32_bf16 v[12:15], v[16:19], v[64:67], v[12:15]
    v_and_b32_dpp v20, v28, v4 row_newbcast:10 row_mask:0xf bank_mask:0xf
    v_and_b32_dpp v21, v28, v5 row_newbcast:10 row_mask:0xf bank_mask:0xf
    v_and_b32_dpp v22, v28, v6 row_newbcast:10 row_mask:0xf bank_mask:0xf
    v_and_b32_dpp v23, v28, v7 row_newbcast:10 row_mask:0xf bank_mask:0xf
    buffer_load_dwordx4 v[88:91], v2, s[12:15], s60 offen offset:2048 nt
    v_fma_f32 v29, v29, s91, -v50
    v_exp_f32 v29, v29
    s_nop 0
    v_mul_f32 v29, v29, v44
    v_cvt_pk_bf16_f32 v29, v29, v29
    s_waitcnt vmcnt(5)
    v_mfma_f32_16x16x32_bf16 v[12:15], v[20:23], v[68:71], v[12:15]
    v_and_b32_dpp v16, v28, v4 row_newbcast:6 row_mask:0xf bank_mask:0xf
    v_and_b32_dpp v17, v28, v5 row_newbcast:6 row_mask:0xf bank_mask:0xf
    v_and_b32_dpp v18, v28, v6 row_newbcast:6 row_mask:0xf bank_mask:0xf
    v_and_b32_dpp v19, v28, v7 row_newbcast:6 row_mask:0xf bank_mask:0xf
    buffer_load_dwordx4 v[92:95], v2, s[12:15], s60 offen offset:3072 nt
    s_waitcnt vmcnt(5)
    v_mfma_f32_16x16x32_bf16 v[12:15], v[16:19], v[72:75], v[12:15]
    v_and_b32_dpp v20, v28, v4 row_newbcast:14 row_mask:0xf bank_mask:0xf
    v_and_b32_dpp v21, v28, v5 row_newbcast:14 row_mask:0xf bank_mask:0xf
    v_and_b32_dpp v22, v28, v6 row_newbcast:14 row_mask:0xf bank_mask:0xf
    v_and_b32_dpp v23, v28, v7 row_newbcast:14 row_mask:0xf bank_mask:0xf
    s_xor_b32 s60, s63, 311296
    buffer_load_dwordx4 v[96:99], v2, s[12:15], s60 offen offset:0 nt
    s_waitcnt vmcnt(5)
    v_mfma_f32_16x16x32_bf16 v[12:15], v[20:23], v[76:79], v[12:15]
    v_and_b32_dpp v16, v28, v4 row_newbcast:1 row_mask:0xf bank_mask:0xf
    v_and_b32_dpp v17, v28, v5 row_newbcast:1 row_mask:0xf bank_mask:0xf
    v_and_b32_dpp v18, v28, v6 row_newbcast:1 row_mask:0xf bank_mask:0xf
    v_and_b32_dpp v19, v28, v7 row_newbcast:1 row_mask:0xf bank_mask:0xf
    buffer_load_dwordx4 v[100:103], v2, s[12:15], s60 offen offset:1024 nt
    s_waitcnt vmcnt(5)
    v_mfma_f32_16x16x32_bf16 v[12:15], v[16:19], v[80:83], v[12:15]
    v_and_b32_dpp v20, v28, v4 row_newbcast:9 row_mask:0xf bank_mask:0xf
    v_and_b32_dpp v21, v28, v5 row_newbcast:9 row_mask:0xf bank_mask:0xf
    v_and_b32_dpp v22, v28, v6 row_newbcast:9 row_mask:0xf bank_mask:0xf
    v_and_b32_dpp v23, v28, v7 row_newbcast:9 row_mask:0xf bank_mask:0xf
    buffer_load_dwordx4 v[104:107], v2, s[12:15], s60 offen offset:2048 nt
    s_waitcnt vmcnt(5)
    v_mfma_f32_16x16x32_bf16 v[12:15], v[20:23], v[84:87], v[12:15]
    v_and_b32_dpp v16, v28, v4 row_newbcast:5 row_mask:0xf bank_mask:0xf
    v_and_b32_dpp v17, v28, v5 row_newbcast:5 row_mask:0xf bank_mask:0xf
    v_and_b32_dpp v18, v28, v6 row_newbcast:5 row_mask:0xf bank_mask:0xf
    v_and_b32_dpp v19, v28, v7 row_newbcast:5 row_mask:0xf bank_mask:0xf
    buffer_load_dwordx4 v[108:111], v2, s[12:15], s60 offen offset:3072 nt
    s_waitcnt vmcnt(5)
    v_mfma_f32_16x16x32_bf16 v[12:15], v[16:19], v[88:91], v[12:15]
    v_and_b32_dpp v20, v28, v4 row_newbcast:13 row_mask:0xf bank_mask:0xf
    v_and_b32_dpp v21, v28, v5 row_newbcast:13 row_mask:0xf bank_mask:0xf
    v_and_b32_dpp v22, v28, v6 row_newbcast:13 row_mask:0xf bank_mask:0xf
    v_and_b32_dpp v23, v28, v7 row_newbcast:13 row_mask:0xf bank_mask:0xf
    s_xor_b32 s60, s63, 327680
    buffer_load_dwordx4 v[112:115], v2, s[12:15], s60 offen offset:0 nt
    s_waitcnt vmcnt(5)
    v_mfma_f32_16x16x32_bf16 v[12:15], v[20:23], v[92:95], v[12:15]
    v_and_b32_dpp v16, v28, v4 row_newbcast:3 row_mask:0xf bank_mask:0xf
    v_and_b32_dpp v17, v28, v5 row_newbcast:3 row_mask:0xf bank_mask:0xf
    v_and_b32_dpp v18, v28, v6 row_newbcast:3 row_mask:0xf bank_mask:0xf
    v_and_b32_dpp v19, v28, v7 row_newbcast:3 row_mask:0xf bank_mask:0xf
    buffer_load_dwordx4 v[116:119], v2, s[12:15], s60 offen offset:1024 nt
    s_waitcnt vmcnt(5)
    v_mfma_f32_16x16x32_bf16 v[12:15], v[16:19], v[96:99], v[12:15]
    v_and_b32_dpp v20, v28, v4 row_newbcast:11 row_mask:0xf bank_mask:0xf
    v_and_b32_dpp v21, v28, v5 row_newbcast:11 row_mask:0xf bank_mask:0xf
    v_and_b32_dpp v22, v28, v6 row_newbcast:11 row_mask:0xf bank_mask:0xf
    v_and_b32_dpp v23, v28, v7 row_newbcast:11 row_mask:0xf bank_mask:0xf
    buffer_load_dwordx4 v[120:123], v2, s[12:15], s60 offen offset:2048 nt
    s_waitcnt vmcnt(5)
    v_mfma_f32_16x16x32_bf16 v[12:15], v[20:23], v[100:103], v[12:15]
    v_and_b32_dpp v16, v28, v4 row_newbcast:7 row_mask:0xf bank_mask:0xf
    v_and_b32_dpp v17, v28, v5 row_newbcast:7 row_mask:0xf bank_mask:0xf
    v_and_b32_dpp v18, v28, v6 row_newbcast:7 row_mask:0xf bank_mask:0xf
    v_and_b32_dpp v19, v28, v7 row_newbcast:7 row_mask:0xf bank_mask:0xf
    buffer_load_dwordx4 v[124:127], v2, s[12:15], s60 offen offset:3072 nt
    s_waitcnt vmcnt(5)
    v_mfma_f32_16x16x32_bf16 v[12:15], v[16:19], v[104:107], v[12:15]
    v_and_b32_dpp v20, v28, v4 row_newbcast:15 row_mask:0xf bank_mask:0xf
    v_and_b32_dpp v21, v28, v5 row_newbcast:15 row_mask:0xf bank_mask:0xf
    v_and_b32_dpp v22, v28, v6 row_newbcast:15 row_mask:0xf bank_mask:0xf
    v_and_b32_dpp v23, v28, v7 row_newbcast:15 row_mask:0xf bank_mask:0xf
    s_xor_b32 s60, s63, 344064
    buffer_load_dwordx4 v[144:147], v2, s[12:15], s60 offen offset:0 nt
    s_waitcnt vmcnt(5)
    v_mfma_f32_16x16x32_bf16 v[12:15], v[20:23], v[108:111], v[12:15]
    v_and_b32_dpp v16, v29, v4 row_newbcast:0 row_mask:0xf bank_mask:0xf
    v_and_b32_dpp v17, v29, v5 row_newbcast:0 row_mask:0xf bank_mask:0xf
    v_and_b32_dpp v18, v29, v6 row_newbcast:0 row_mask:0xf bank_mask:0xf
    v_and_b32_dpp v19, v29, v7 row_newbcast:0 row_mask:0xf bank_mask:0xf
    buffer_load_dwordx4 v[164:167], v2, s[12:15], s60 offen offset:1024 nt
    s_waitcnt vmcnt(5)
    v_mfma_f32_16x16x32_bf16 v[12:15], v[16:19], v[112:115], v[12:15]
    v_and_b32_dpp v20, v29, v4 row_newbcast:8 row_mask:0xf bank_mask:0xf
    v_and_b32_dpp v21, v29, v5 row_newbcast:8 row_mask:0xf bank_mask:0xf
    v_and_b32_dpp v22, v29, v6 row_newbcast:8 row_mask:0xf bank_mask:0xf
    v_and_b32_dpp v23, v29, v7 row_newbcast:8 row_mask:0xf bank_mask:0xf
    buffer_load_dwordx4 v[184:187], v2, s[12:15], s60 offen offset:2048 nt
    s_waitcnt vmcnt(5)
    v_mfma_f32_16x16x32_bf16 v[12:15], v[20:23], v[116:119], v[12:15]
    v_and_b32_dpp v16, v29, v4 row_newbcast:4 row_mask:0xf bank_mask:0xf
    v_and_b32_dpp v17, v29, v5 row_newbcast:4 row_mask:0xf bank_mask:0xf
    v_and_b32_dpp v18, v29, v6 row_newbcast:4 row_mask:0xf bank_mask:0xf
    v_and_b32_dpp v19, v29, v7 row_newbcast:4 row_mask:0xf bank_mask:0xf
    buffer_load_dwordx4 v[204:207], v2, s[12:15], s60 offen offset:3072 nt
    s_waitcnt vmcnt(5)
    v_mfma_f32_16x16x32_bf16 v[12:15], v[16:19], v[120:123], v[12:15]
    v_and_b32_dpp v20, v29, v4 row_newbcast:12 row_mask:0xf bank_mask:0xf
    v_and_b32_dpp v21, v29, v5 row_newbcast:12 row_mask:0xf bank_mask:0xf
    v_and_b32_dpp v22, v29, v6 row_newbcast:12 row_mask:0xf bank_mask:0xf
    v_and_b32_dpp v23, v29, v7 row_newbcast:12 row_mask:0xf bank_mask:0xf
    s_xor_b32 s60, s63, 360448
    buffer_load_dwordx4 v[224:227], v2, s[12:15], s60 offen offset:0 nt
    s_waitcnt vmcnt(5)
    v_mfma_f32_16x16x32_bf16 v[12:15], v[20:23], v[124:127], v[12:15]
    v_and_b32_dpp v16, v29, v4 row_newbcast:2 row_mask:0xf bank_mask:0xf
    v_and_b32_dpp v17, v29, v5 row_newbcast:2 row_mask:0xf bank_mask:0xf
    v_and_b32_dpp v18, v29, v6 row_newbcast:2 row_mask:0xf bank_mask:0xf
    v_and_b32_dpp v19, v29, v7 row_newbcast:2 row_mask:0xf bank_mask:0xf
    buffer_load_dwordx4 v[244:247], v2, s[12:15], s60 offen offset:1024 nt
    s_waitcnt vmcnt(5)
    v_mfma_f32_16x16x32_bf16 v[12:15], v[16:19], v[144:147], v[12:15]
    v_and_b32_dpp v20, v29, v4 row_newbcast:10 row_mask:0xf bank_mask:0xf
    v_and_b32_dpp v21, v29, v5 row_newbcast:10 row_mask:0xf bank_mask:0xf
    v_and_b32_dpp v22, v29, v6 row_newbcast:10 row_mask:0xf bank_mask:0xf
    v_and_b32_dpp v23, v29, v7 row_newbcast:10 row_mask:0xf bank_mask:0xf
    buffer_load_dwordx4 v[136:139], v2, s[12:15], s60 offen offset:2048 nt
    v_fma_f32 v30, v30, s91, -v50
    v_exp_f32 v30, v30
    s_nop 0
    v_mul_f32 v30, v30, v44
    v_cvt_pk_bf16_f32 v30, v30, v30
    s_waitcnt vmcnt(5)
    v_mfma_f32_16x16x32_bf16 v[12:15], v[20:23], v[164:167], v[12:15]
    v_and_b32_dpp v16, v29, v4 row_newbcast:6 row_mask:0xf bank_mask:0xf
    v_and_b32_dpp v17, v29, v5 row_newbcast:6 row_mask:0xf bank_mask:0xf
    v_and_b32_dpp v18, v29, v6 row_newbcast:6 row_mask:0xf bank_mask:0xf
    v_and_b32_dpp v19, v29, v7 row_newbcast:6 row_mask:0xf bank_mask:0xf
    buffer_load_dwordx4 v[160:163], v2, s[12:15], s60 offen offset:3072 nt
    s_waitcnt vmcnt(5)
    v_mfma_f32_16x16x32_bf16 v[12:15], v[16:19], v[184:187], v[12:15]
    v_and_b32_dpp v20, v29, v4 row_newbcast:14 row_mask:0xf bank_mask:0xf
    v_and_b32_dpp v21, v29, v5 row_newbcast:14 row_mask:0xf bank_mask:0xf
    v_and_b32_dpp v22, v29, v6 row_newbcast:14 row_mask:0xf bank_mask:0xf
    v_and_b32_dpp v23, v29, v7 row_newbcast:14 row_mask:0xf bank_mask:0xf
    s_xor_b32 s60, s63, 376832
    buffer_load_dwordx4 v[188:191], v2, s[12:15], s60 offen offset:0 nt
    s_waitcnt vmcnt(5)
    v_mfma_f32_16x16x32_bf16 v[12:15], v[20:23], v[204:207], v[12:15]
    v_and_b32_dpp v16, v29, v4 row_newbcast:1 row_mask:0xf bank_mask:0xf
    v_and_b32_dpp v17, v29, v5 row_newbcast:1 row_mask:0xf bank_mask:0xf
    v_and_b32_dpp v18, v29, v6 row_newbcast:1 row_mask:0xf bank_mask:0xf
    v_and_b32_dpp v19, v29, v7 row_newbcast:1 row_mask:0xf bank_mask:0xf
    buffer_load_dwordx4 v[192:195], v2, s[12:15], s60 offen offset:1024 nt
    s_waitcnt vmcnt(5)
    v_mfma_f32_16x16x32_bf16 v[12:15], v[16:19], v[224:227], v[12:15]
    v_and_b32_dpp v20, v29, v4 row_newbcast:9 row_mask:0xf bank_mask:0xf
    v_and_b32_dpp v21, v29, v5 row_newbcast:9 row_mask:0xf bank_mask:0xf
    v_and_b32_dpp v22, v29, v6 row_newbcast:9 row_mask:0xf bank_mask:0xf
    v_and_b32_dpp v23, v29, v7 row_newbcast:9 row_mask:0xf bank_mask:0xf
    buffer_load_dwordx4 v[196:199], v2, s[12:15], s60 offen offset:2048 nt
    s_waitcnt vmcnt(5)
    v_mfma_f32_16x16x32_bf16 v[12:15], v[20:23], v[244:247], v[12:15]
    v_and_b32_dpp v16, v29, v4 row_newbcast:5 row_mask:0xf bank_mask:0xf
    v_and_b32_dpp v17, v29, v5 row_newbcast:5 row_mask:0xf bank_mask:0xf
    v_and_b32_dpp v18, v29, v6 row_newbcast:5 row_mask:0xf bank_mask:0xf
    v_and_b32_dpp v19, v29, v7 row_newbcast:5 row_mask:0xf bank_mask:0xf
    buffer_load_dwordx4 v[200:203], v2, s[12:15], s60 offen offset:3072 nt
    s_waitcnt vmcnt(5)
    v_mfma_f32_16x16x32_bf16 v[12:15], v[16:19], v[136:139], v[12:15]
    v_and_b32_dpp v20, v29, v4 row_newbcast:13 row_mask:0xf bank_mask:0xf
    v_and_b32_dpp v21, v29, v5 row_newbcast:13 row_mask:0xf bank_mask:0xf
    v_and_b32_dpp v22, v29, v6 row_newbcast:13 row_mask:0xf bank_mask:0xf
    v_and_b32_dpp v23, v29, v7 row_newbcast:13 row_mask:0xf bank_mask:0xf
    s_xor_b32 s60, s63, 393216
    buffer_load_dwordx4 v[208:211], v2, s[12:15], s60 offen offset:0 nt
    s_waitcnt vmcnt(5)
    v_mfma_f32_16x16x32_bf16 v[12:15], v[20:23], v[160:163], v[12:15]
    v_and_b32_dpp v16, v29, v4 row_newbcast:3 row_mask:0xf bank_mask:0xf
    v_and_b32_dpp v17, v29, v5 row_newbcast:3 row_mask:0xf bank_mask:0xf
    v_and_b32_dpp v18, v29, v6 row_newbcast:3 row_mask:0xf bank_mask:0xf
    v_and_b32_dpp v19, v29, v7 row_newbcast:3 row_mask:0xf bank_mask:0xf
    buffer_load_dwordx4 v[212:215], v2, s[12:15], s60 offen offset:1024 nt
    s_waitcnt vmcnt(5)
    v_mfma_f32_16x16x32_bf16 v[12:15], v[16:19], v[188:191], v[12:15]
    v_and_b32_dpp v20, v29, v4 row_newbcast:11 row_mask:0xf bank_mask:0xf
    v_and_b32_dpp v21, v29, v5 row_newbcast:11 row_mask:0xf bank_mask:0xf
    v_and_b32_dpp v22, v29, v6 row_newbcast:11 row_mask:0xf bank_mask:0xf
    v_and_b32_dpp v23, v29, v7 row_newbcast:11 row_mask:0xf bank_mask:0xf
    buffer_load_dwordx4 v[216:219], v2, s[12:15], s60 offen offset:2048 nt
    s_waitcnt vmcnt(5)
    v_mfma_f32_16x16x32_bf16 v[12:15], v[20:23], v[192:195], v[12:15]
    v_and_b32_dpp v16, v29, v4 row_newbcast:7 row_mask:0xf bank_mask:0xf
    v_and_b32_dpp v17, v29, v5 row_newbcast:7 row_mask:0xf bank_mask:0xf
    v_and_b32_dpp v18, v29, v6 row_newbcast:7 row_mask:0xf bank_mask:0xf
    v_and_b32_dpp v19, v29, v7 row_newbcast:7 row_mask:0xf bank_mask:0xf
    buffer_load_dwordx4 v[220:223], v2, s[12:15], s60 offen offset:3072 nt
    s_waitcnt vmcnt(5)
    v_mfma_f32_16x16x32_bf16 v[12:15], v[16:19], v[196:199], v[12:15]
    v_and_b32_dpp v20, v29, v4 row_newbcast:15 row_mask:0xf bank_mask:0xf
    v_and_b32_dpp v21, v29, v5 row_newbcast:15 row_mask:0xf bank_mask:0xf
    v_and_b32_dpp v22, v29, v6 row_newbcast:15 row_mask:0xf bank_mask:0xf
    v_and_b32_dpp v23, v29, v7 row_newbcast:15 row_mask:0xf bank_mask:0xf
    s_xor_b32 s60, s63, 409600
    buffer_load_dwordx4 v[228:231], v2, s[12:15], s60 offen offset:0 nt
    s_waitcnt vmcnt(5)
    v_mfma_f32_16x16x32_bf16 v[12:15], v[20:23], v[200:203], v[12:15]
    v_and_b32_dpp v16, v30, v4 row_newbcast:0 row_mask:0xf bank_mask:0xf
    v_and_b32_dpp v17, v30, v5 row_newbcast:0 row_mask:0xf bank_mask:0xf
    v_and_b32_dpp v18, v30, v6 row_newbcast:0 row_mask:0xf bank_mask:0xf
    v_and_b32_dpp v19, v30, v7 row_newbcast:0 row_mask:0xf bank_mask:0xf
    buffer_load_dwordx4 v[232:235], v2, s[12:15], s60 offen offset:1024 nt
    s_waitcnt vmcnt(5)
    v_mfma_f32_16x16x32_bf16 v[12:15], v[16:19], v[208:211], v[12:15]
    v_and_b32_dpp v20, v30, v4 row_newbcast:8 row_mask:0xf bank_mask:0xf
    v_and_b32_dpp v21, v30, v5 row_newbcast:8 row_mask:0xf bank_mask:0xf
    v_and_b32_dpp v22, v30, v6 row_newbcast:8 row_mask:0xf bank_mask:0xf
    v_and_b32_dpp v23, v30, v7 row_newbcast:8 row_mask:0xf bank_mask:0xf
    buffer_load_dwordx4 v[236:239], v2, s[12:15], s60 offen offset:2048 nt
    s_waitcnt vmcnt(5)
    v_mfma_f32_16x16x32_bf16 v[12:15], v[20:23], v[212:215], v[12:15]
    v_and_b32_dpp v16, v30, v4 row_newbcast:4 row_mask:0xf bank_mask:0xf
    v_and_b32_dpp v17, v30, v5 row_newbcast:4 row_mask:0xf bank_mask:0xf
    v_and_b32_dpp v18, v30, v6 row_newbcast:4 row_mask:0xf bank_mask:0xf
    v_and_b32_dpp v19, v30, v7 row_newbcast:4 row_mask:0xf bank_mask:0xf
    buffer_load_dwordx4 v[240:243], v2, s[12:15], s60 offen offset:3072 nt
    s_waitcnt vmcnt(5)
    v_mfma_f32_16x16x32_bf16 v[12:15], v[16:19], v[216:219], v[12:15]
    v_and_b32_dpp v20, v30, v4 row_newbcast:12 row_mask:0xf bank_mask:0xf
    v_and_b32_dpp v21, v30, v5 row_newbcast:12 row_mask:0xf bank_mask:0xf
    v_and_b32_dpp v22, v30, v6 row_newbcast:12 row_mask:0xf bank_mask:0xf
    v_and_b32_dpp v23, v30, v7 row_newbcast:12 row_mask:0xf bank_mask:0xf
    s_xor_b32 s60, s63, 425984
    buffer_load_dwordx4 v[248:251], v2, s[12:15], s60 offen offset:0 nt
    s_waitcnt vmcnt(5)
    v_mfma_f32_16x16x32_bf16 v[12:15], v[20:23], v[220:223], v[12:15]
    v_and_b32_dpp v16, v30, v4 row_newbcast:2 row_mask:0xf bank_mask:0xf
    v_and_b32_dpp v17, v30, v5 row_newbcast:2 row_mask:0xf bank_mask:0xf
    v_and_b32_dpp v18, v30, v6 row_newbcast:2 row_mask:0xf bank_mask:0xf
    v_and_b32_dpp v19, v30, v7 row_newbcast:2 row_mask:0xf bank_mask:0xf
    buffer_load_dwordx4 v[252:255], v2, s[12:15], s60 offen offset:1024 nt
    s_waitcnt vmcnt(5)
    v_mfma_f32_16x16x32_bf16 v[12:15], v[16:19], v[228:231], v[12:15]
    v_and_b32_dpp v20, v30, v4 row_newbcast:10 row_mask:0xf bank_mask:0xf
    v_and_b32_dpp v21, v30, v5 row_newbcast:10 row_mask:0xf bank_mask:0xf
    v_and_b32_dpp v22, v30, v6 row_newbcast:10 row_mask:0xf bank_mask:0xf
    v_and_b32_dpp v23, v30, v7 row_newbcast:10 row_mask:0xf bank_mask:0xf
    buffer_load_dwordx4 v[128:131], v2, s[12:15], s60 offen offset:2048 nt
    v_fma_f32 v31, v31, s91, -v50
    v_exp_f32 v31, v31
    s_nop 0
    v_mul_f32 v31, v31, v44
    v_cvt_pk_bf16_f32 v31, v31, v31
    s_waitcnt vmcnt(5)
    v_mfma_f32_16x16x32_bf16 v[12:15], v[20:23], v[232:235], v[12:15]
    v_and_b32_dpp v16, v30, v4 row_newbcast:6 row_mask:0xf bank_mask:0xf
    v_and_b32_dpp v17, v30, v5 row_newbcast:6 row_mask:0xf bank_mask:0xf
    v_and_b32_dpp v18, v30, v6 row_newbcast:6 row_mask:0xf bank_mask:0xf
    v_and_b32_dpp v19, v30, v7 row_newbcast:6 row_mask:0xf bank_mask:0xf
    buffer_load_dwordx4 v[132:135], v2, s[12:15], s60 offen offset:3072 nt
    s_waitcnt vmcnt(5)
    v_mfma_f32_16x16x32_bf16 v[12:15], v[16:19], v[236:239], v[12:15]
    v_and_b32_dpp v20, v30, v4 row_newbcast:14 row_mask:0xf bank_mask:0xf
    v_and_b32_dpp v21, v30, v5 row_newbcast:14 row_mask:0xf bank_mask:0xf
    v_and_b32_dpp v22, v30, v6 row_newbcast:14 row_mask:0xf bank_mask:0xf
    v_and_b32_dpp v23, v30, v7 row_newbcast:14 row_mask:0xf bank_mask:0xf
    s_xor_b32 s60, s63, 442368
    buffer_load_dwordx4 v[140:143], v2, s[12:15], s60 offen offset:0 nt
    s_waitcnt vmcnt(5)
    v_mfma_f32_16x16x32_bf16 v[12:15], v[20:23], v[240:243], v[12:15]
    v_and_b32_dpp v16, v30, v4 row_newbcast:1 row_mask:0xf bank_mask:0xf
    v_and_b32_dpp v17, v30, v5 row_newbcast:1 row_mask:0xf bank_mask:0xf
    v_and_b32_dpp v18, v30, v6 row_newbcast:1 row_mask:0xf bank_mask:0xf
    v_and_b32_dpp v19, v30, v7 row_newbcast:1 row_mask:0xf bank_mask:0xf
    buffer_load_dwordx4 v[148:151], v2, s[12:15], s60 offen offset:1024 nt
    s_waitcnt vmcnt(5)
    v_mfma_f32_16x16x32_bf16 v[12:15], v[16:19], v[248:251], v[12:15]
    v_and_b32_dpp v20, v30, v4 row_newbcast:9 row_mask:0xf bank_mask:0xf
    v_and_b32_dpp v21, v30, v5 row_newbcast:9 row_mask:0xf bank_mask:0xf
    v_and_b32_dpp v22, v30, v6 row_newbcast:9 row_mask:0xf bank_mask:0xf
    v_and_b32_dpp v23, v30, v7 row_newbcast:9 row_mask:0xf bank_mask:0xf
    buffer_load_dwordx4 v[152:155], v2, s[12:15], s60 offen offset:2048 nt
    s_waitcnt vmcnt(5)
    v_mfma_f32_16x16x32_bf16 v[12:15], v[20:23], v[252:255], v[12:15]
    v_and_b32_dpp v16, v30, v4 row_newbcast:5 row_mask:0xf bank_mask:0xf
    v_and_b32_dpp v17, v30, v5 row_newbcast:5 row_mask:0xf bank_mask:0xf
    v_and_b32_dpp v18, v30, v6 row_newbcast:5 row_mask:0xf bank_mask:0xf
    v_and_b32_dpp v19, v30, v7 row_newbcast:5 row_mask:0xf bank_mask:0xf
    buffer_load_dwordx4 v[156:159], v2, s[12:15], s60 offen offset:3072 nt
    s_waitcnt vmcnt(5)
    v_mfma_f32_16x16x32_bf16 v[12:15], v[16:19], v[128:131], v[12:15]
    v_and_b32_dpp v20, v30, v4 row_newbcast:13 row_mask:0xf bank_mask:0xf
    v_and_b32_dpp v21, v30, v5 row_newbcast:13 row_mask:0xf bank_mask:0xf
    v_and_b32_dpp v22, v30, v6 row_newbcast:13 row_mask:0xf bank_mask:0xf
    v_and_b32_dpp v23, v30, v7 row_newbcast:13 row_mask:0xf bank_mask:0xf
    s_xor_b32 s60, s63, 458752
    buffer_load_dwordx4 v[168:171], v2, s[12:15], s60 offen offset:0 nt
    s_waitcnt vmcnt(5)
    v_mfma_f32_16x16x32_bf16 v[12:15], v[20:23], v[132:135], v[12:15]
    v_and_b32_dpp v16, v30, v4 row_newbcast:3 row_mask:0xf bank_mask:0xf
    v_and_b32_dpp v17, v30, v5 row_newbcast:3 row_mask:0xf bank_mask:0xf
    v_and_b32_dpp v18, v30, v6 row_newbcast:3 row_mask:0xf bank_mask:0xf
    v_and_b32_dpp v19, v30, v7 row_newbcast:3 row_mask:0xf bank_mask:0xf
    buffer_load_dwordx4 v[172:175], v2, s[12:15], s60 offen offset:1024 nt
    s_waitcnt vmcnt(5)
    v_mfma_f32_16x16x32_bf16 v[12:15], v[16:19], v[140:143], v[12:15]
    v_and_b32_dpp v20, v30, v4 row_newbcast:11 row_mask:0xf bank_mask:0xf
    v_and_b32_dpp v21, v30, v5 row_newbcast:11 row_mask:0xf bank_mask:0xf
    v_and_b32_dpp v22, v30, v6 row_newbcast:11 row_mask:0xf bank_mask:0xf
    v_and_b32_dpp v23, v30, v7 row_newbcast:11 row_mask:0xf bank_mask:0xf
    buffer_load_dwordx4 v[176:179], v2, s[12:15], s60 offen offset:2048 nt
    s_waitcnt vmcnt(5)
    v_mfma_f32_16x16x32_bf16 v[12:15], v[20:23], v[148:151], v[12:15]
    v_and_b32_dpp v16, v30, v4 row_newbcast:7 row_mask:0xf bank_mask:0xf
    v_and_b32_dpp v17, v30, v5 row_newbcast:7 row_mask:0xf bank_mask:0xf
    v_and_b32_dpp v18, v30, v6 row_newbcast:7 row_mask:0xf bank_mask:0xf
    v_and_b32_dpp v19, v30, v7 row_newbcast:7 row_mask:0xf bank_mask:0xf
    buffer_load_dwordx4 v[180:183], v2, s[12:15], s60 offen offset:3072 nt
    s_waitcnt vmcnt(5)
    v_mfma_f32_16x16x32_bf16 v[12:15], v[16:19], v[152:155], v[12:15]
    v_and_b32_dpp v20, v30, v4 row_newbcast:15 row_mask:0xf bank_mask:0xf
    v_and_b32_dpp v21, v30, v5 row_newbcast:15 row_mask:0xf bank_mask:0xf
    v_and_b32_dpp v22, v30, v6 row_newbcast:15 row_mask:0xf bank_mask:0xf
    v_and_b32_dpp v23, v30, v7 row_newbcast:15 row_mask:0xf bank_mask:0xf
    s_xor_b32 s60, s63, 475136
    buffer_load_dwordx4 v[64:67], v2, s[12:15], s60 offen offset:0 nt
    s_waitcnt vmcnt(5)
    v_mfma_f32_16x16x32_bf16 v[12:15], v[20:23], v[156:159], v[12:15]
    v_and_b32_dpp v16, v31, v4 row_newbcast:0 row_mask:0xf bank_mask:0xf
    v_and_b32_dpp v17, v31, v5 row_newbcast:0 row_mask:0xf bank_mask:0xf
    v_and_b32_dpp v18, v31, v6 row_newbcast:0 row_mask:0xf bank_mask:0xf
    v_and_b32_dpp v19, v31, v7 row_newbcast:0 row_mask:0xf bank_mask:0xf
    buffer_load_dwordx4 v[68:71], v2, s[12:15], s60 offen offset:1024 nt
    s_waitcnt vmcnt(5)
    v_mfma_f32_16x16x32_bf16 v[12:15], v[16:19], v[168:171], v[12:15]
    v_and_b32_dpp v20, v31, v4 row_newbcast:8 row_mask:0xf bank_mask:0xf
    v_and_b32_dpp v21, v31, v5 row_newbcast:8 row_mask:0xf bank_mask:0xf
    v_and_b32_dpp v22, v31, v6 row_newbcast:8 row_mask:0xf bank_mask:0xf
    v_and_b32_dpp v23, v31, v7 row_newbcast:8 row_mask:0xf bank_mask:0xf
    buffer_load_dwordx4 v[72:75], v2, s[12:15], s60 offen offset:2048 nt
    s_waitcnt vmcnt(5)
    v_mfma_f32_16x16x32_bf16 v[12:15], v[20:23], v[172:175], v[12:15]
    v_and_b32_dpp v16, v31, v4 row_newbcast:4 row_mask:0xf bank_mask:0xf
    v_and_b32_dpp v17, v31, v5 row_newbcast:4 row_mask:0xf bank_mask:0xf
    v_and_b32_dpp v18, v31, v6 row_newbcast:4 row_mask:0xf bank_mask:0xf
    v_and_b32_dpp v19, v31, v7 row_newbcast:4 row_mask:0xf bank_mask:0xf
    buffer_load_dwordx4 v[76:79], v2, s[12:15], s60 offen offset:3072 nt
    s_waitcnt vmcnt(5)
    v_mfma_f32_16x16x32_bf16 v[12:15], v[16:19], v[176:179], v[12:15]
    v_and_b32_dpp v20, v31, v4 row_newbcast:12 row_mask:0xf bank_mask:0xf
    v_and_b32_dpp v21, v31, v5 row_newbcast:12 row_mask:0xf bank_mask:0xf
    v_and_b32_dpp v22, v31, v6 row_newbcast:12 row_mask:0xf bank_mask:0xf
    v_and_b32_dpp v23, v31, v7 row_newbcast:12 row_mask:0xf bank_mask:0xf
    s_xor_b32 s60, s63, 491520
    buffer_load_dwordx4 v[80:83], v2, s[12:15], s60 offen offset:0 nt
    s_waitcnt vmcnt(5)
    v_mfma_f32_16x16x32_bf16 v[12:15], v[20:23], v[180:183], v[12:15]
    v_and_b32_dpp v16, v31, v4 row_newbcast:2 row_mask:0xf bank_mask:0xf
    v_and_b32_dpp v17, v31, v5 row_newbcast:2 row_mask:0xf bank_mask:0xf
    v_and_b32_dpp v18, v31, v6 row_newbcast:2 row_mask:0xf bank_mask:0xf
    v_and_b32_dpp v19, v31, v7 row_newbcast:2 row_mask:0xf bank_mask:0xf
    buffer_load_dwordx4 v[84:87], v2, s[12:15], s60 offen offset:1024 nt
    s_waitcnt vmcnt(5)
    v_mfma_f32_16x16x32_bf16 v[12:15], v[16:19], v[64:67], v[12:15]
    v_and_b32_dpp v20, v31, v4 row_newbcast:10 row_mask:0xf bank_mask:0xf
    v_and_b32_dpp v21, v31, v5 row_newbcast:10 row_mask:0xf bank_mask:0xf
    v_and_b32_dpp v22, v31, v6 row_newbcast:10 row_mask:0xf bank_mask:0xf
    v_and_b32_dpp v23, v31, v7 row_newbcast:10 row_mask:0xf bank_mask:0xf
    buffer_load_dwordx4 v[88:91], v2, s[12:15], s60 offen offset:2048 nt
    v_fma_f32 v32, v32, s91, -v50
    v_exp_f32 v32, v32
    s_nop 0
    v_mul_f32 v32, v32, v44
    v_cvt_pk_bf16_f32 v32, v32, v32
    s_waitcnt vmcnt(5)
    v_mfma_f32_16x16x32_bf16 v[12:15], v[20:23], v[68:71], v[12:15]
    v_and_b32_dpp v16, v31, v4 row_newbcast:6 row_mask:0xf bank_mask:0xf
    v_and_b32_dpp v17, v31, v5 row_newbcast:6 row_mask:0xf bank_mask:0xf
    v_and_b32_dpp v18, v31, v6 row_newbcast:6 row_mask:0xf bank_mask:0xf
    v_and_b32_dpp v19, v31, v7 row_newbcast:6 row_mask:0xf bank_mask:0xf
    buffer_load_dwordx4 v[92:95], v2, s[12:15], s60 offen offset:3072 nt
    s_waitcnt vmcnt(5)
    v_mfma_f32_16x16x32_bf16 v[12:15], v[16:19], v[72:75], v[12:15]
    v_and_b32_dpp v20, v31, v4 row_newbcast:14 row_mask:0xf bank_mask:0xf
    v_and_b32_dpp v21, v31, v5 row_newbcast:14 row_mask:0xf bank_mask:0xf
    v_and_b32_dpp v22, v31, v6 row_newbcast:14 row_mask:0xf bank_mask:0xf
    v_and_b32_dpp v23, v31, v7 row_newbcast:14 row_mask:0xf bank_mask:0xf
    s_xor_b32 s60, s63, 507904
    buffer_load_dwordx4 v[96:99], v2, s[12:15], s60 offen offset:0 nt
    s_waitcnt vmcnt(5)
    v_mfma_f32_16x16x32_bf16 v[12:15], v[20:23], v[76:79], v[12:15]
    v_and_b32_dpp v16, v31, v4 row_newbcast:1 row_mask:0xf bank_mask:0xf
    v_and_b32_dpp v17, v31, v5 row_newbcast:1 row_mask:0xf bank_mask:0xf
    v_and_b32_dpp v18, v31, v6 row_newbcast:1 row_mask:0xf bank_mask:0xf
    v_and_b32_dpp v19, v31, v7 row_newbcast:1 row_mask:0xf bank_mask:0xf
    buffer_load_dwordx4 v[100:103], v2, s[12:15], s60 offen offset:1024 nt
    s_waitcnt vmcnt(5)
    v_mfma_f32_16x16x32_bf16 v[12:15], v[16:19], v[80:83], v[12:15]
    v_and_b32_dpp v20, v31, v4 row_newbcast:9 row_mask:0xf bank_mask:0xf
    v_and_b32_dpp v21, v31, v5 row_newbcast:9 row_mask:0xf bank_mask:0xf
    v_and_b32_dpp v22, v31, v6 row_newbcast:9 row_mask:0xf bank_mask:0xf
    v_and_b32_dpp v23, v31, v7 row_newbcast:9 row_mask:0xf bank_mask:0xf
    buffer_load_dwordx4 v[104:107], v2, s[12:15], s60 offen offset:2048 nt
    s_waitcnt vmcnt(5)
    v_mfma_f32_16x16x32_bf16 v[12:15], v[20:23], v[84:87], v[12:15]
    v_and_b32_dpp v16, v31, v4 row_newbcast:5 row_mask:0xf bank_mask:0xf
    v_and_b32_dpp v17, v31, v5 row_newbcast:5 row_mask:0xf bank_mask:0xf
    v_and_b32_dpp v18, v31, v6 row_newbcast:5 row_mask:0xf bank_mask:0xf
    v_and_b32_dpp v19, v31, v7 row_newbcast:5 row_mask:0xf bank_mask:0xf
    buffer_load_dwordx4 v[108:111], v2, s[12:15], s60 offen offset:3072 nt
    s_waitcnt vmcnt(5)
    v_mfma_f32_16x16x32_bf16 v[12:15], v[16:19], v[88:91], v[12:15]
    v_and_b32_dpp v20, v31, v4 row_newbcast:13 row_mask:0xf bank_mask:0xf
    v_and_b32_dpp v21, v31, v5 row_newbcast:13 row_mask:0xf bank_mask:0xf
    v_and_b32_dpp v22, v31, v6 row_newbcast:13 row_mask:0xf bank_mask:0xf
    v_and_b32_dpp v23, v31, v7 row_newbcast:13 row_mask:0xf bank_mask:0xf
    s_xor_b32 s60, s63, 524288
    buffer_load_dwordx4 v[112:115], v2, s[12:15], s60 offen offset:0 nt
    s_waitcnt vmcnt(5)
    v_mfma_f32_16x16x32_bf16 v[12:15], v[20:23], v[92:95], v[12:15]
    v_and_b32_dpp v16, v31, v4 row_newbcast:3 row_mask:0xf bank_mask:0xf
    v_and_b32_dpp v17, v31, v5 row_newbcast:3 row_mask:0xf bank_mask:0xf
    v_and_b32_dpp v18, v31, v6 row_newbcast:3 row_mask:0xf bank_mask:0xf
    v_and_b32_dpp v19, v31, v7 row_newbcast:3 row_mask:0xf bank_mask:0xf
    buffer_load_dwordx4 v[116:119], v2, s[12:15], s60 offen offset:1024 nt
    s_waitcnt vmcnt(5)
    v_mfma_f32_16x16x32_bf16 v[12:15], v[16:19], v[96:99], v[12:15]
    v_and_b32_dpp v20, v31, v4 row_newbcast:11 row_mask:0xf bank_mask:0xf
    v_and_b32_dpp v21, v31, v5 row_newbcast:11 row_mask:0xf bank_mask:0xf
    v_and_b32_dpp v22, v31, v6 row_newbcast:11 row_mask:0xf bank_mask:0xf
    v_and_b32_dpp v23, v31, v7 row_newbcast:11 row_mask:0xf bank_mask:0xf
    buffer_load_dwordx4 v[120:123], v2, s[12:15], s60 offen offset:2048 nt
    s_waitcnt vmcnt(5)
    v_mfma_f32_16x16x32_bf16 v[12:15], v[20:23], v[100:103], v[12:15]
    v_and_b32_dpp v16, v31, v4 row_newbcast:7 row_mask:0xf bank_mask:0xf
    v_and_b32_dpp v17, v31, v5 row_newbcast:7 row_mask:0xf bank_mask:0xf
    v_and_b32_dpp v18, v31, v6 row_newbcast:7 row_mask:0xf bank_mask:0xf
    v_and_b32_dpp v19, v31, v7 row_newbcast:7 row_mask:0xf bank_mask:0xf
    buffer_load_dwordx4 v[124:127], v2, s[12:15], s60 offen offset:3072 nt
    s_waitcnt vmcnt(5)
    v_mfma_f32_16x16x32_bf16 v[12:15], v[16:19], v[104:107], v[12:15]
    v_and_b32_dpp v20, v31, v4 row_newbcast:15 row_mask:0xf bank_mask:0xf
    v_and_b32_dpp v21, v31, v5 row_newbcast:15 row_mask:0xf bank_mask:0xf
    v_and_b32_dpp v22, v31, v6 row_newbcast:15 row_mask:0xf bank_mask:0xf
    v_and_b32_dpp v23, v31, v7 row_newbcast:15 row_mask:0xf bank_mask:0xf
    s_xor_b32 s60, s63, 540672
    buffer_load_dwordx4 v[144:147], v2, s[12:15], s60 offen offset:0 nt
    s_waitcnt vmcnt(5)
    v_mfma_f32_16x16x32_bf16 v[12:15], v[20:23], v[108:111], v[12:15]
    v_and_b32_dpp v16, v32, v4 row_newbcast:0 row_mask:0xf bank_mask:0xf
    v_and_b32_dpp v17, v32, v5 row_newbcast:0 row_mask:0xf bank_mask:0xf
    v_and_b32_dpp v18, v32, v6 row_newbcast:0 row_mask:0xf bank_mask:0xf
    v_and_b32_dpp v19, v32, v7 row_newbcast:0 row_mask:0xf bank_mask:0xf
    buffer_load_dwordx4 v[164:167], v2, s[12:15], s60 offen offset:1024 nt
    s_waitcnt vmcnt(5)
    v_mfma_f32_16x16x32_bf16 v[12:15], v[16:19], v[112:115], v[12:15]
    v_and_b32_dpp v20, v32, v4 row_newbcast:8 row_mask:0xf bank_mask:0xf
    v_and_b32_dpp v21, v32, v5 row_newbcast:8 row_mask:0xf bank_mask:0xf
    v_and_b32_dpp v22, v32, v6 row_newbcast:8 row_mask:0xf bank_mask:0xf
    v_and_b32_dpp v23, v32, v7 row_newbcast:8 row_mask:0xf bank_mask:0xf
    buffer_load_dwordx4 v[184:187], v2, s[12:15], s60 offen offset:2048 nt
    s_waitcnt vmcnt(5)
    v_mfma_f32_16x16x32_bf16 v[12:15], v[20:23], v[116:119], v[12:15]
    v_and_b32_dpp v16, v32, v4 row_newbcast:4 row_mask:0xf bank_mask:0xf
    v_and_b32_dpp v17, v32, v5 row_newbcast:4 row_mask:0xf bank_mask:0xf
    v_and_b32_dpp v18, v32, v6 row_newbcast:4 row_mask:0xf bank_mask:0xf
    v_and_b32_dpp v19, v32, v7 row_newbcast:4 row_mask:0xf bank_mask:0xf
    buffer_load_dwordx4 v[204:207], v2, s[12:15], s60 offen offset:3072 nt
    s_waitcnt vmcnt(5)
    v_mfma_f32_16x16x32_bf16 v[12:15], v[16:19], v[120:123], v[12:15]
    v_and_b32_dpp v20, v32, v4 row_newbcast:12 row_mask:0xf bank_mask:0xf
    v_and_b32_dpp v21, v32, v5 row_newbcast:12 row_mask:0xf bank_mask:0xf
    v_and_b32_dpp v22, v32, v6 row_newbcast:12 row_mask:0xf bank_mask:0xf
    v_and_b32_dpp v23, v32, v7 row_newbcast:12 row_mask:0xf bank_mask:0xf
    s_xor_b32 s60, s63, 557056
    buffer_load_dwordx4 v[224:227], v2, s[12:15], s60 offen offset:0 nt
    s_waitcnt vmcnt(5)
    v_mfma_f32_16x16x32_bf16 v[12:15], v[20:23], v[124:127], v[12:15]
    v_and_b32_dpp v16, v32, v4 row_newbcast:2 row_mask:0xf bank_mask:0xf
    v_and_b32_dpp v17, v32, v5 row_newbcast:2 row_mask:0xf bank_mask:0xf
    v_and_b32_dpp v18, v32, v6 row_newbcast:2 row_mask:0xf bank_mask:0xf
    v_and_b32_dpp v19, v32, v7 row_newbcast:2 row_mask:0xf bank_mask:0xf
    buffer_load_dwordx4 v[244:247], v2, s[12:15], s60 offen offset:1024 nt
    s_waitcnt vmcnt(5)
    v_mfma_f32_16x16x32_bf16 v[12:15], v[16:19], v[144:147], v[12:15]
    v_and_b32_dpp v20, v32, v4 row_newbcast:10 row_mask:0xf bank_mask:0xf
    v_and_b32_dpp v21, v32, v5 row_newbcast:10 row_mask:0xf bank_mask:0xf
    v_and_b32_dpp v22, v32, v6 row_newbcast:10 row_mask:0xf bank_mask:0xf
    v_and_b32_dpp v23, v32, v7 row_newbcast:10 row_mask:0xf bank_mask:0xf
    buffer_load_dwordx4 v[136:139], v2, s[12:15], s60 offen offset:2048 nt
    v_fma_f32 v33, v33, s91, -v50
    v_exp_f32 v33, v33
    s_nop 0
    v_mul_f32 v33, v33, v44
    v_cvt_pk_bf16_f32 v33, v33, v33
    s_waitcnt vmcnt(5)
    v_mfma_f32_16x16x32_bf16 v[12:15], v[20:23], v[164:167], v[12:15]
    v_and_b32_dpp v16, v32, v4 row_newbcast:6 row_mask:0xf bank_mask:0xf
    v_and_b32_dpp v17, v32, v5 row_newbcast:6 row_mask:0xf bank_mask:0xf
    v_and_b32_dpp v18, v32, v6 row_newbcast:6 row_mask:0xf bank_mask:0xf
    v_and_b32_dpp v19, v32, v7 row_newbcast:6 row_mask:0xf bank_mask:0xf
    buffer_load_dwordx4 v[160:163], v2, s[12:15], s60 offen offset:3072 nt
    s_waitcnt vmcnt(5)
    v_mfma_f32_16x16x32_bf16 v[12:15], v[16:19], v[184:187], v[12:15]
    v_and_b32_dpp v20, v32, v4 row_newbcast:14 row_mask:0xf bank_mask:0xf
    v_and_b32_dpp v21, v32, v5 row_newbcast:14 row_mask:0xf bank_mask:0xf
    v_and_b32_dpp v22, v32, v6 row_newbcast:14 row_mask:0xf bank_mask:0xf
    v_and_b32_dpp v23, v32, v7 row_newbcast:14 row_mask:0xf bank_mask:0xf
    s_xor_b32 s60, s63, 573440
    buffer_load_dwordx4 v[188:191], v2, s[12:15], s60 offen offset:0 nt
    s_waitcnt vmcnt(5)
    v_mfma_f32_16x16x32_bf16 v[12:15], v[20:23], v[204:207], v[12:15]
    v_and_b32_dpp v16, v32, v4 row_newbcast:1 row_mask:0xf bank_mask:0xf
    v_and_b32_dpp v17, v32, v5 row_newbcast:1 row_mask:0xf bank_mask:0xf
    v_and_b32_dpp v18, v32, v6 row_newbcast:1 row_mask:0xf bank_mask:0xf
    v_and_b32_dpp v19, v32, v7 row_newbcast:1 row_mask:0xf bank_mask:0xf
    buffer_load_dwordx4 v[192:195], v2, s[12:15], s60 offen offset:1024 nt
    s_waitcnt vmcnt(5)
    v_mfma_f32_16x16x32_bf16 v[12:15], v[16:19], v[224:227], v[12:15]
    v_and_b32_dpp v20, v32, v4 row_newbcast:9 row_mask:0xf bank_mask:0xf
    v_and_b32_dpp v21, v32, v5 row_newbcast:9 row_mask:0xf bank_mask:0xf
    v_and_b32_dpp v22, v32, v6 row_newbcast:9 row_mask:0xf bank_mask:0xf
    v_and_b32_dpp v23, v32, v7 row_newbcast:9 row_mask:0xf bank_mask:0xf
    buffer_load_dwordx4 v[196:199], v2, s[12:15], s60 offen offset:2048 nt
    s_waitcnt vmcnt(5)
    v_mfma_f32_16x16x32_bf16 v[12:15], v[20:23], v[244:247], v[12:15]
    v_and_b32_dpp v16, v32, v4 row_newbcast:5 row_mask:0xf bank_mask:0xf
    v_and_b32_dpp v17, v32, v5 row_newbcast:5 row_mask:0xf bank_mask:0xf
    v_and_b32_dpp v18, v32, v6 row_newbcast:5 row_mask:0xf bank_mask:0xf
    v_and_b32_dpp v19, v32, v7 row_newbcast:5 row_mask:0xf bank_mask:0xf
    buffer_load_dwordx4 v[200:203], v2, s[12:15], s60 offen offset:3072 nt
    s_waitcnt vmcnt(5)
    v_mfma_f32_16x16x32_bf16 v[12:15], v[16:19], v[136:139], v[12:15]
    v_and_b32_dpp v20, v32, v4 row_newbcast:13 row_mask:0xf bank_mask:0xf
    v_and_b32_dpp v21, v32, v5 row_newbcast:13 row_mask:0xf bank_mask:0xf
    v_and_b32_dpp v22, v32, v6 row_newbcast:13 row_mask:0xf bank_mask:0xf
    v_and_b32_dpp v23, v32, v7 row_newbcast:13 row_mask:0xf bank_mask:0xf
    s_xor_b32 s60, s63, 589824
    buffer_load_dwordx4 v[208:211], v2, s[12:15], s60 offen offset:0 nt
    s_waitcnt vmcnt(5)
    v_mfma_f32_16x16x32_bf16 v[12:15], v[20:23], v[160:163], v[12:15]
    v_and_b32_dpp v16, v32, v4 row_newbcast:3 row_mask:0xf bank_mask:0xf
    v_and_b32_dpp v17, v32, v5 row_newbcast:3 row_mask:0xf bank_mask:0xf
    v_and_b32_dpp v18, v32, v6 row_newbcast:3 row_mask:0xf bank_mask:0xf
    v_and_b32_dpp v19, v32, v7 row_newbcast:3 row_mask:0xf bank_mask:0xf
    buffer_load_dwordx4 v[212:215], v2, s[12:15], s60 offen offset:1024 nt
    s_waitcnt vmcnt(5)
    v_mfma_f32_16x16x32_bf16 v[12:15], v[16:19], v[188:191], v[12:15]
    v_and_b32_dpp v20, v32, v4 row_newbcast:11 row_mask:0xf bank_mask:0xf
    v_and_b32_dpp v21, v32, v5 row_newbcast:11 row_mask:0xf bank_mask:0xf
    v_and_b32_dpp v22, v32, v6 row_newbcast:11 row_mask:0xf bank_mask:0xf
    v_and_b32_dpp v23, v32, v7 row_newbcast:11 row_mask:0xf bank_mask:0xf
    buffer_load_dwordx4 v[216:219], v2, s[12:15], s60 offen offset:2048 nt
    s_waitcnt vmcnt(5)
    v_mfma_f32_16x16x32_bf16 v[12:15], v[20:23], v[192:195], v[12:15]
    v_and_b32_dpp v16, v32, v4 row_newbcast:7 row_mask:0xf bank_mask:0xf
    v_and_b32_dpp v17, v32, v5 row_newbcast:7 row_mask:0xf bank_mask:0xf
    v_and_b32_dpp v18, v32, v6 row_newbcast:7 row_mask:0xf bank_mask:0xf
    v_and_b32_dpp v19, v32, v7 row_newbcast:7 row_mask:0xf bank_mask:0xf
    buffer_load_dwordx4 v[220:223], v2, s[12:15], s60 offen offset:3072 nt
    s_waitcnt vmcnt(5)
    v_mfma_f32_16x16x32_bf16 v[12:15], v[16:19], v[196:199], v[12:15]
    v_and_b32_dpp v20, v32, v4 row_newbcast:15 row_mask:0xf bank_mask:0xf
    v_and_b32_dpp v21, v32, v5 row_newbcast:15 row_mask:0xf bank_mask:0xf
    v_and_b32_dpp v22, v32, v6 row_newbcast:15 row_mask:0xf bank_mask:0xf
    v_and_b32_dpp v23, v32, v7 row_newbcast:15 row_mask:0xf bank_mask:0xf
    s_xor_b32 s60, s63, 606208
    buffer_load_dwordx4 v[228:231], v2, s[12:15], s60 offen offset:0 nt
    s_waitcnt vmcnt(5)
    v_mfma_f32_16x16x32_bf16 v[12:15], v[20:23], v[200:203], v[12:15]
    v_and_b32_dpp v16, v33, v4 row_newbcast:0 row_mask:0xf bank_mask:0xf
    v_and_b32_dpp v17, v33, v5 row_newbcast:0 row_mask:0xf bank_mask:0xf
    v_and_b32_dpp v18, v33, v6 row_newbcast:0 row_mask:0xf bank_mask:0xf
    v_and_b32_dpp v19, v33, v7 row_newbcast:0 row_mask:0xf bank_mask:0xf
    buffer_load_dwordx4 v[232:235], v2, s[12:15], s60 offen offset:1024 nt
    s_waitcnt vmcnt(5)
    v_mfma_f32_16x16x32_bf16 v[12:15], v[16:19], v[208:211], v[12:15]
    v_and_b32_dpp v20, v33, v4 row_newbcast:8 row_mask:0xf bank_mask:0xf
    v_and_b32_dpp v21, v33, v5 row_newbcast:8 row_mask:0xf bank_mask:0xf
    v_and_b32_dpp v22, v33, v6 row_newbcast:8 row_mask:0xf bank_mask:0xf
    v_and_b32_dpp v23, v33, v7 row_newbcast:8 row_mask:0xf bank_mask:0xf
    buffer_load_dwordx4 v[236:239], v2, s[12:15], s60 offen offset:2048 nt
    s_waitcnt vmcnt(5)
    v_mfma_f32_16x16x32_bf16 v[12:15], v[20:23], v[212:215], v[12:15]
    v_and_b32_dpp v16, v33, v4 row_newbcast:4 row_mask:0xf bank_mask:0xf
    v_and_b32_dpp v17, v33, v5 row_newbcast:4 row_mask:0xf bank_mask:0xf
    v_and_b32_dpp v18, v33, v6 row_newbcast:4 row_mask:0xf bank_mask:0xf
    v_and_b32_dpp v19, v33, v7 row_newbcast:4 row_mask:0xf bank_mask:0xf
    buffer_load_dwordx4 v[240:243], v2, s[12:15], s60 offen offset:3072 nt
    s_waitcnt vmcnt(5)
    v_mfma_f32_16x16x32_bf16 v[12:15], v[16:19], v[216:219], v[12:15]
    v_and_b32_dpp v20, v33, v4 row_newbcast:12 row_mask:0xf bank_mask:0xf
    v_and_b32_dpp v21, v33, v5 row_newbcast:12 row_mask:0xf bank_mask:0xf
    v_and_b32_dpp v22, v33, v6 row_newbcast:12 row_mask:0xf bank_mask:0xf
    v_and_b32_dpp v23, v33, v7 row_newbcast:12 row_mask:0xf bank_mask:0xf
    s_xor_b32 s60, s63, 622592
    buffer_load_dwordx4 v[248:251], v2, s[12:15], s60 offen offset:0 nt
    s_waitcnt vmcnt(5)
    v_mfma_f32_16x16x32_bf16 v[12:15], v[20:23], v[220:223], v[12:15]
    v_and_b32_dpp v16, v33, v4 row_newbcast:2 row_mask:0xf bank_mask:0xf
    v_and_b32_dpp v17, v33, v5 row_newbcast:2 row_mask:0xf bank_mask:0xf
    v_and_b32_dpp v18, v33, v6 row_newbcast:2 row_mask:0xf bank_mask:0xf
    v_and_b32_dpp v19, v33, v7 row_newbcast:2 row_mask:0xf bank_mask:0xf
    buffer_load_dwordx4 v[252:255], v2, s[12:15], s60 offen offset:1024 nt
    s_waitcnt vmcnt(5)
    v_mfma_f32_16x16x32_bf16 v[12:15], v[16:19], v[228:231], v[12:15]
    v_and_b32_dpp v20, v33, v4 row_newbcast:10 row_mask:0xf bank_mask:0xf
    v_and_b32_dpp v21, v33, v5 row_newbcast:10 row_mask:0xf bank_mask:0xf
    v_and_b32_dpp v22, v33, v6 row_newbcast:10 row_mask:0xf bank_mask:0xf
    v_and_b32_dpp v23, v33, v7 row_newbcast:10 row_mask:0xf bank_mask:0xf
    buffer_load_dwordx4 v[128:131], v2, s[12:15], s60 offen offset:2048 nt
    v_fma_f32 v34, v34, s91, -v50
    v_exp_f32 v34, v34
    s_nop 0
    v_mul_f32 v34, v34, v44
    v_cvt_pk_bf16_f32 v34, v34, v34
    s_waitcnt vmcnt(5)
    v_mfma_f32_16x16x32_bf16 v[12:15], v[20:23], v[232:235], v[12:15]
    v_and_b32_dpp v16, v33, v4 row_newbcast:6 row_mask:0xf bank_mask:0xf
    v_and_b32_dpp v17, v33, v5 row_newbcast:6 row_mask:0xf bank_mask:0xf
    v_and_b32_dpp v18, v33, v6 row_newbcast:6 row_mask:0xf bank_mask:0xf
    v_and_b32_dpp v19, v33, v7 row_newbcast:6 row_mask:0xf bank_mask:0xf
    buffer_load_dwordx4 v[132:135], v2, s[12:15], s60 offen offset:3072 nt
    s_waitcnt vmcnt(5)
    v_mfma_f32_16x16x32_bf16 v[12:15], v[16:19], v[236:239], v[12:15]
    v_and_b32_dpp v20, v33, v4 row_newbcast:14 row_mask:0xf bank_mask:0xf
    v_and_b32_dpp v21, v33, v5 row_newbcast:14 row_mask:0xf bank_mask:0xf
    v_and_b32_dpp v22, v33, v6 row_newbcast:14 row_mask:0xf bank_mask:0xf
    v_and_b32_dpp v23, v33, v7 row_newbcast:14 row_mask:0xf bank_mask:0xf
    s_xor_b32 s60, s63, 638976
    buffer_load_dwordx4 v[140:143], v2, s[12:15], s60 offen offset:0 nt
    s_waitcnt vmcnt(5)
    v_mfma_f32_16x16x32_bf16 v[12:15], v[20:23], v[240:243], v[12:15]
    v_and_b32_dpp v16, v33, v4 row_newbcast:1 row_mask:0xf bank_mask:0xf
    v_and_b32_dpp v17, v33, v5 row_newbcast:1 row_mask:0xf bank_mask:0xf
    v_and_b32_dpp v18, v33, v6 row_newbcast:1 row_mask:0xf bank_mask:0xf
    v_and_b32_dpp v19, v33, v7 row_newbcast:1 row_mask:0xf bank_mask:0xf
    buffer_load_dwordx4 v[148:151], v2, s[12:15], s60 offen offset:1024 nt
    s_waitcnt vmcnt(5)
    v_mfma_f32_16x16x32_bf16 v[12:15], v[16:19], v[248:251], v[12:15]
    v_and_b32_dpp v20, v33, v4 row_newbcast:9 row_mask:0xf bank_mask:0xf
    v_and_b32_dpp v21, v33, v5 row_newbcast:9 row_mask:0xf bank_mask:0xf
    v_and_b32_dpp v22, v33, v6 row_newbcast:9 row_mask:0xf bank_mask:0xf
    v_and_b32_dpp v23, v33, v7 row_newbcast:9 row_mask:0xf bank_mask:0xf
    buffer_load_dwordx4 v[152:155], v2, s[12:15], s60 offen offset:2048 nt
    s_waitcnt vmcnt(5)
    v_mfma_f32_16x16x32_bf16 v[12:15], v[20:23], v[252:255], v[12:15]
    v_and_b32_dpp v16, v33, v4 row_newbcast:5 row_mask:0xf bank_mask:0xf
    v_and_b32_dpp v17, v33, v5 row_newbcast:5 row_mask:0xf bank_mask:0xf
    v_and_b32_dpp v18, v33, v6 row_newbcast:5 row_mask:0xf bank_mask:0xf
    v_and_b32_dpp v19, v33, v7 row_newbcast:5 row_mask:0xf bank_mask:0xf
    buffer_load_dwordx4 v[156:159], v2, s[12:15], s60 offen offset:3072 nt
    s_waitcnt vmcnt(5)
    v_mfma_f32_16x16x32_bf16 v[12:15], v[16:19], v[128:131], v[12:15]
    v_and_b32_dpp v20, v33, v4 row_newbcast:13 row_mask:0xf bank_mask:0xf
    v_and_b32_dpp v21, v33, v5 row_newbcast:13 row_mask:0xf bank_mask:0xf
    v_and_b32_dpp v22, v33, v6 row_newbcast:13 row_mask:0xf bank_mask:0xf
    v_and_b32_dpp v23, v33, v7 row_newbcast:13 row_mask:0xf bank_mask:0xf
    s_xor_b32 s60, s63, 655360
    buffer_load_dwordx4 v[168:171], v2, s[12:15], s60 offen offset:0 nt
    s_waitcnt vmcnt(5)
    v_mfma_f32_16x16x32_bf16 v[12:15], v[20:23], v[132:135], v[12:15]
    v_and_b32_dpp v16, v33, v4 row_newbcast:3 row_mask:0xf bank_mask:0xf
    v_and_b32_dpp v17, v33, v5 row_newbcast:3 row_mask:0xf bank_mask:0xf
    v_and_b32_dpp v18, v33, v6 row_newbcast:3 row_mask:0xf bank_mask:0xf
    v_and_b32_dpp v19, v33, v7 row_newbcast:3 row_mask:0xf bank_mask:0xf
    buffer_load_dwordx4 v[172:175], v2, s[12:15], s60 offen offset:1024 nt
    s_waitcnt vmcnt(5)
    v_mfma_f32_16x16x32_bf16 v[12:15], v[16:19], v[140:143], v[12:15]
    v_and_b32_dpp v20, v33, v4 row_newbcast:11 row_mask:0xf bank_mask:0xf
    v_and_b32_dpp v21, v33, v5 row_newbcast:11 row_mask:0xf bank_mask:0xf
    v_and_b32_dpp v22, v33, v6 row_newbcast:11 row_mask:0xf bank_mask:0xf
    v_and_b32_dpp v23, v33, v7 row_newbcast:11 row_mask:0xf bank_mask:0xf
    buffer_load_dwordx4 v[176:179], v2, s[12:15], s60 offen offset:2048 nt
    s_waitcnt vmcnt(5)
    v_mfma_f32_16x16x32_bf16 v[12:15], v[20:23], v[148:151], v[12:15]
    v_and_b32_dpp v16, v33, v4 row_newbcast:7 row_mask:0xf bank_mask:0xf
    v_and_b32_dpp v17, v33, v5 row_newbcast:7 row_mask:0xf bank_mask:0xf
    v_and_b32_dpp v18, v33, v6 row_newbcast:7 row_mask:0xf bank_mask:0xf
    v_and_b32_dpp v19, v33, v7 row_newbcast:7 row_mask:0xf bank_mask:0xf
    buffer_load_dwordx4 v[180:183], v2, s[12:15], s60 offen offset:3072 nt
    s_waitcnt vmcnt(5)
    v_mfma_f32_16x16x32_bf16 v[12:15], v[16:19], v[152:155], v[12:15]
    v_and_b32_dpp v20, v33, v4 row_newbcast:15 row_mask:0xf bank_mask:0xf
    v_and_b32_dpp v21, v33, v5 row_newbcast:15 row_mask:0xf bank_mask:0xf
    v_and_b32_dpp v22, v33, v6 row_newbcast:15 row_mask:0xf bank_mask:0xf
    v_and_b32_dpp v23, v33, v7 row_newbcast:15 row_mask:0xf bank_mask:0xf
    s_xor_b32 s60, s63, 671744
    buffer_load_dwordx4 v[64:67], v2, s[12:15], s60 offen offset:0 nt
    s_waitcnt vmcnt(5)
    v_mfma_f32_16x16x32_bf16 v[12:15], v[20:23], v[156:159], v[12:15]
    v_and_b32_dpp v16, v34, v4 row_newbcast:0 row_mask:0xf bank_mask:0xf
    v_and_b32_dpp v17, v34, v5 row_newbcast:0 row_mask:0xf bank_mask:0xf
    v_and_b32_dpp v18, v34, v6 row_newbcast:0 row_mask:0xf bank_mask:0xf
    v_and_b32_dpp v19, v34, v7 row_newbcast:0 row_mask:0xf bank_mask:0xf
    buffer_load_dwordx4 v[68:71], v2, s[12:15], s60 offen offset:1024 nt
    s_waitcnt vmcnt(5)
    v_mfma_f32_16x16x32_bf16 v[12:15], v[16:19], v[168:171], v[12:15]
    v_and_b32_dpp v20, v34, v4 row_newbcast:8 row_mask:0xf bank_mask:0xf
    v_and_b32_dpp v21, v34, v5 row_newbcast:8 row_mask:0xf bank_mask:0xf
    v_and_b32_dpp v22, v34, v6 row_newbcast:8 row_mask:0xf bank_mask:0xf
    v_and_b32_dpp v23, v34, v7 row_newbcast:8 row_mask:0xf bank_mask:0xf
    buffer_load_dwordx4 v[72:75], v2, s[12:15], s60 offen offset:2048 nt
    s_waitcnt vmcnt(5)
    v_mfma_f32_16x16x32_bf16 v[12:15], v[20:23], v[172:175], v[12:15]
    v_and_b32_dpp v16, v34, v4 row_newbcast:4 row_mask:0xf bank_mask:0xf
    v_and_b32_dpp v17, v34, v5 row_newbcast:4 row_mask:0xf bank_mask:0xf
    v_and_b32_dpp v18, v34, v6 row_newbcast:4 row_mask:0xf bank_mask:0xf
    v_and_b32_dpp v19, v34, v7 row_newbcast:4 row_mask:0xf bank_mask:0xf
    buffer_load_dwordx4 v[76:79], v2, s[12:15], s60 offen offset:3072 nt
    s_waitcnt vmcnt(5)
    v_mfma_f32_16x16x32_bf16 v[12:15], v[16:19], v[176:179], v[12:15]
    v_and_b32_dpp v20, v34, v4 row_newbcast:12 row_mask:0xf bank_mask:0xf
    v_and_b32_dpp v21, v34, v5 row_newbcast:12 row_mask:0xf bank_mask:0xf
    v_and_b32_dpp v22, v34, v6 row_newbcast:12 row_mask:0xf bank_mask:0xf
    v_and_b32_dpp v23, v34, v7 row_newbcast:12 row_mask:0xf bank_mask:0xf
    s_xor_b32 s60, s63, 688128
    buffer_load_dwordx4 v[80:83], v2, s[12:15], s60 offen offset:0 nt
    s_waitcnt vmcnt(5)
    v_mfma_f32_16x16x32_bf16 v[12:15], v[20:23], v[180:183], v[12:15]
    v_and_b32_dpp v16, v34, v4 row_newbcast:2 row_mask:0xf bank_mask:0xf
    v_and_b32_dpp v17, v34, v5 row_newbcast:2 row_mask:0xf bank_mask:0xf
    v_and_b32_dpp v18, v34, v6 row_newbcast:2 row_mask:0xf bank_mask:0xf
    v_and_b32_dpp v19, v34, v7 row_newbcast:2 row_mask:0xf bank_mask:0xf
    buffer_load_dwordx4 v[84:87], v2, s[12:15], s60 offen offset:1024 nt
    s_waitcnt vmcnt(5)
    v_mfma_f32_16x16x32_bf16 v[12:15], v[16:19], v[64:67], v[12:15]
    v_and_b32_dpp v20, v34, v4 row_newbcast:10 row_mask:0xf bank_mask:0xf
    v_and_b32_dpp v21, v34, v5 row_newbcast:10 row_mask:0xf bank_mask:0xf
    v_and_b32_dpp v22, v34, v6 row_newbcast:10 row_mask:0xf bank_mask:0xf
    v_and_b32_dpp v23, v34, v7 row_newbcast:10 row_mask:0xf bank_mask:0xf
    buffer_load_dwordx4 v[88:91], v2, s[12:15], s60 offen offset:2048 nt
    v_fma_f32 v35, v35, s91, -v50
    v_exp_f32 v35, v35
    s_nop 0
    v_mul_f32 v35, v35, v44
    v_cvt_pk_bf16_f32 v35, v35, v35
    s_waitcnt vmcnt(5)
    v_mfma_f32_16x16x32_bf16 v[12:15], v[20:23], v[68:71], v[12:15]
    v_and_b32_dpp v16, v34, v4 row_newbcast:6 row_mask:0xf bank_mask:0xf
    v_and_b32_dpp v17, v34, v5 row_newbcast:6 row_mask:0xf bank_mask:0xf
    v_and_b32_dpp v18, v34, v6 row_newbcast:6 row_mask:0xf bank_mask:0xf
    v_and_b32_dpp v19, v34, v7 row_newbcast:6 row_mask:0xf bank_mask:0xf
    buffer_load_dwordx4 v[92:95], v2, s[12:15], s60 offen offset:3072 nt
    s_waitcnt vmcnt(5)
    v_mfma_f32_16x16x32_bf16 v[12:15], v[16:19], v[72:75], v[12:15]
    v_and_b32_dpp v20, v34, v4 row_newbcast:14 row_mask:0xf bank_mask:0xf
    v_and_b32_dpp v21, v34, v5 row_newbcast:14 row_mask:0xf bank_mask:0xf
    v_and_b32_dpp v22, v34, v6 row_newbcast:14 row_mask:0xf bank_mask:0xf
    v_and_b32_dpp v23, v34, v7 row_newbcast:14 row_mask:0xf bank_mask:0xf
    s_xor_b32 s60, s63, 704512
    buffer_load_dwordx4 v[96:99], v2, s[12:15], s60 offen offset:0 nt
    s_waitcnt vmcnt(5)
    v_mfma_f32_16x16x32_bf16 v[12:15], v[20:23], v[76:79], v[12:15]
    v_and_b32_dpp v16, v34, v4 row_newbcast:1 row_mask:0xf bank_mask:0xf
    v_and_b32_dpp v17, v34, v5 row_newbcast:1 row_mask:0xf bank_mask:0xf
    v_and_b32_dpp v18, v34, v6 row_newbcast:1 row_mask:0xf bank_mask:0xf
    v_and_b32_dpp v19, v34, v7 row_newbcast:1 row_mask:0xf bank_mask:0xf
    buffer_load_dwordx4 v[100:103], v2, s[12:15], s60 offen offset:1024 nt
    s_waitcnt vmcnt(5)
    v_mfma_f32_16x16x32_bf16 v[12:15], v[16:19], v[80:83], v[12:15]
    v_and_b32_dpp v20, v34, v4 row_newbcast:9 row_mask:0xf bank_mask:0xf
    v_and_b32_dpp v21, v34, v5 row_newbcast:9 row_mask:0xf bank_mask:0xf
    v_and_b32_dpp v22, v34, v6 row_newbcast:9 row_mask:0xf bank_mask:0xf
    v_and_b32_dpp v23, v34, v7 row_newbcast:9 row_mask:0xf bank_mask:0xf
    buffer_load_dwordx4 v[104:107], v2, s[12:15], s60 offen offset:2048 nt
    s_waitcnt vmcnt(5)
    v_mfma_f32_16x16x32_bf16 v[12:15], v[20:23], v[84:87], v[12:15]
    v_and_b32_dpp v16, v34, v4 row_newbcast:5 row_mask:0xf bank_mask:0xf
    v_and_b32_dpp v17, v34, v5 row_newbcast:5 row_mask:0xf bank_mask:0xf
    v_and_b32_dpp v18, v34, v6 row_newbcast:5 row_mask:0xf bank_mask:0xf
    v_and_b32_dpp v19, v34, v7 row_newbcast:5 row_mask:0xf bank_mask:0xf
    buffer_load_dwordx4 v[108:111], v2, s[12:15], s60 offen offset:3072 nt
    s_waitcnt vmcnt(5)
    v_mfma_f32_16x16x32_bf16 v[12:15], v[16:19], v[88:91], v[12:15]
    v_and_b32_dpp v20, v34, v4 row_newbcast:13 row_mask:0xf bank_mask:0xf
    v_and_b32_dpp v21, v34, v5 row_newbcast:13 row_mask:0xf bank_mask:0xf
    v_and_b32_dpp v22, v34, v6 row_newbcast:13 row_mask:0xf bank_mask:0xf
    v_and_b32_dpp v23, v34, v7 row_newbcast:13 row_mask:0xf bank_mask:0xf
    s_xor_b32 s60, s63, 720896
    buffer_load_dwordx4 v[112:115], v2, s[12:15], s60 offen offset:0 nt
    s_waitcnt vmcnt(5)
    v_mfma_f32_16x16x32_bf16 v[12:15], v[20:23], v[92:95], v[12:15]
    v_and_b32_dpp v16, v34, v4 row_newbcast:3 row_mask:0xf bank_mask:0xf
    v_and_b32_dpp v17, v34, v5 row_newbcast:3 row_mask:0xf bank_mask:0xf
    v_and_b32_dpp v18, v34, v6 row_newbcast:3 row_mask:0xf bank_mask:0xf
    v_and_b32_dpp v19, v34, v7 row_newbcast:3 row_mask:0xf bank_mask:0xf
    buffer_load_dwordx4 v[116:119], v2, s[12:15], s60 offen offset:1024 nt
    s_waitcnt vmcnt(5)
    v_mfma_f32_16x16x32_bf16 v[12:15], v[16:19], v[96:99], v[12:15]
    v_and_b32_dpp v20, v34, v4 row_newbcast:11 row_mask:0xf bank_mask:0xf
    v_and_b32_dpp v21, v34, v5 row_newbcast:11 row_mask:0xf bank_mask:0xf
    v_and_b32_dpp v22, v34, v6 row_newbcast:11 row_mask:0xf bank_mask:0xf
    v_and_b32_dpp v23, v34, v7 row_newbcast:11 row_mask:0xf bank_mask:0xf
    buffer_load_dwordx4 v[120:123], v2, s[12:15], s60 offen offset:2048 nt
    s_waitcnt vmcnt(5)
    v_mfma_f32_16x16x32_bf16 v[12:15], v[20:23], v[100:103], v[12:15]
    v_and_b32_dpp v16, v34, v4 row_newbcast:7 row_mask:0xf bank_mask:0xf
    v_and_b32_dpp v17, v34, v5 row_newbcast:7 row_mask:0xf bank_mask:0xf
    v_and_b32_dpp v18, v34, v6 row_newbcast:7 row_mask:0xf bank_mask:0xf
    v_and_b32_dpp v19, v34, v7 row_newbcast:7 row_mask:0xf bank_mask:0xf
    buffer_load_dwordx4 v[124:127], v2, s[12:15], s60 offen offset:3072 nt
    s_waitcnt vmcnt(5)
    v_mfma_f32_16x16x32_bf16 v[12:15], v[16:19], v[104:107], v[12:15]
    v_and_b32_dpp v20, v34, v4 row_newbcast:15 row_mask:0xf bank_mask:0xf
    v_and_b32_dpp v21, v34, v5 row_newbcast:15 row_mask:0xf bank_mask:0xf
    v_and_b32_dpp v22, v34, v6 row_newbcast:15 row_mask:0xf bank_mask:0xf
    v_and_b32_dpp v23, v34, v7 row_newbcast:15 row_mask:0xf bank_mask:0xf
    s_xor_b32 s60, s63, 737280
    buffer_load_dwordx4 v[144:147], v2, s[12:15], s60 offen offset:0 nt
    s_waitcnt vmcnt(5)
    v_mfma_f32_16x16x32_bf16 v[12:15], v[20:23], v[108:111], v[12:15]
    v_and_b32_dpp v16, v35, v4 row_newbcast:0 row_mask:0xf bank_mask:0xf
    v_and_b32_dpp v17, v35, v5 row_newbcast:0 row_mask:0xf bank_mask:0xf
    v_and_b32_dpp v18, v35, v6 row_newbcast:0 row_mask:0xf bank_mask:0xf
    v_and_b32_dpp v19, v35, v7 row_newbcast:0 row_mask:0xf bank_mask:0xf
    buffer_load_dwordx4 v[164:167], v2, s[12:15], s60 offen offset:1024 nt
    s_waitcnt vmcnt(5)
    v_mfma_f32_16x16x32_bf16 v[12:15], v[16:19], v[112:115], v[12:15]
    v_and_b32_dpp v20, v35, v4 row_newbcast:8 row_mask:0xf bank_mask:0xf
    v_and_b32_dpp v21, v35, v5 row_newbcast:8 row_mask:0xf bank_mask:0xf
    v_and_b32_dpp v22, v35, v6 row_newbcast:8 row_mask:0xf bank_mask:0xf
    v_and_b32_dpp v23, v35, v7 row_newbcast:8 row_mask:0xf bank_mask:0xf
    buffer_load_dwordx4 v[184:187], v2, s[12:15], s60 offen offset:2048 nt
    s_waitcnt vmcnt(5)
    v_mfma_f32_16x16x32_bf16 v[12:15], v[20:23], v[116:119], v[12:15]
    v_and_b32_dpp v16, v35, v4 row_newbcast:4 row_mask:0xf bank_mask:0xf
    v_and_b32_dpp v17, v35, v5 row_newbcast:4 row_mask:0xf bank_mask:0xf
    v_and_b32_dpp v18, v35, v6 row_newbcast:4 row_mask:0xf bank_mask:0xf
    v_and_b32_dpp v19, v35, v7 row_newbcast:4 row_mask:0xf bank_mask:0xf
    buffer_load_dwordx4 v[204:207], v2, s[12:15], s60 offen offset:3072 nt
    s_waitcnt vmcnt(5)
    v_mfma_f32_16x16x32_bf16 v[12:15], v[16:19], v[120:123], v[12:15]
    v_and_b32_dpp v20, v35, v4 row_newbcast:12 row_mask:0xf bank_mask:0xf
    v_and_b32_dpp v21, v35, v5 row_newbcast:12 row_mask:0xf bank_mask:0xf
    v_and_b32_dpp v22, v35, v6 row_newbcast:12 row_mask:0xf bank_mask:0xf
    v_and_b32_dpp v23, v35, v7 row_newbcast:12 row_mask:0xf bank_mask:0xf
    s_xor_b32 s60, s63, 753664
    buffer_load_dwordx4 v[224:227], v2, s[12:15], s60 offen offset:0 nt
    s_waitcnt vmcnt(5)
    v_mfma_f32_16x16x32_bf16 v[12:15], v[20:23], v[124:127], v[12:15]
    v_and_b32_dpp v16, v35, v4 row_newbcast:2 row_mask:0xf bank_mask:0xf
    v_and_b32_dpp v17, v35, v5 row_newbcast:2 row_mask:0xf bank_mask:0xf
    v_and_b32_dpp v18, v35, v6 row_newbcast:2 row_mask:0xf bank_mask:0xf
    v_and_b32_dpp v19, v35, v7 row_newbcast:2 row_mask:0xf bank_mask:0xf
    buffer_load_dwordx4 v[244:247], v2, s[12:15], s60 offen offset:1024 nt
    s_waitcnt vmcnt(5)
    v_mfma_f32_16x16x32_bf16 v[12:15], v[16:19], v[144:147], v[12:15]
    v_and_b32_dpp v20, v35, v4 row_newbcast:10 row_mask:0xf bank_mask:0xf
    v_and_b32_dpp v21, v35, v5 row_newbcast:10 row_mask:0xf bank_mask:0xf
    v_and_b32_dpp v22, v35, v6 row_newbcast:10 row_mask:0xf bank_mask:0xf
    v_and_b32_dpp v23, v35, v7 row_newbcast:10 row_mask:0xf bank_mask:0xf
    buffer_load_dwordx4 v[136:139], v2, s[12:15], s60 offen offset:2048 nt
    v_fma_f32 v36, v36, s91, -v50
    v_exp_f32 v36, v36
    s_nop 0
    v_mul_f32 v36, v36, v44
    v_cvt_pk_bf16_f32 v36, v36, v36
    s_waitcnt vmcnt(5)
    v_mfma_f32_16x16x32_bf16 v[12:15], v[20:23], v[164:167], v[12:15]
    v_and_b32_dpp v16, v35, v4 row_newbcast:6 row_mask:0xf bank_mask:0xf
    v_and_b32_dpp v17, v35, v5 row_newbcast:6 row_mask:0xf bank_mask:0xf
    v_and_b32_dpp v18, v35, v6 row_newbcast:6 row_mask:0xf bank_mask:0xf
    v_and_b32_dpp v19, v35, v7 row_newbcast:6 row_mask:0xf bank_mask:0xf
    buffer_load_dwordx4 v[160:163], v2, s[12:15], s60 offen offset:3072 nt
    s_waitcnt vmcnt(5)
    v_mfma_f32_16x16x32_bf16 v[12:15], v[16:19], v[184:187], v[12:15]
    v_and_b32_dpp v20, v35, v4 row_newbcast:14 row_mask:0xf bank_mask:0xf
    v_and_b32_dpp v21, v35, v5 row_newbcast:14 row_mask:0xf bank_mask:0xf
    v_and_b32_dpp v22, v35, v6 row_newbcast:14 row_mask:0xf bank_mask:0xf
    v_and_b32_dpp v23, v35, v7 row_newbcast:14 row_mask:0xf bank_mask:0xf
    s_xor_b32 s60, s63, 770048
    buffer_load_dwordx4 v[188:191], v2, s[12:15], s60 offen offset:0 nt
    s_waitcnt vmcnt(5)
    v_mfma_f32_16x16x32_bf16 v[12:15], v[20:23], v[204:207], v[12:15]
    v_and_b32_dpp v16, v35, v4 row_newbcast:1 row_mask:0xf bank_mask:0xf
    v_and_b32_dpp v17, v35, v5 row_newbcast:1 row_mask:0xf bank_mask:0xf
    v_and_b32_dpp v18, v35, v6 row_newbcast:1 row_mask:0xf bank_mask:0xf
    v_and_b32_dpp v19, v35, v7 row_newbcast:1 row_mask:0xf bank_mask:0xf
    buffer_load_dwordx4 v[192:195], v2, s[12:15], s60 offen offset:1024 nt
    s_waitcnt vmcnt(5)
    v_mfma_f32_16x16x32_bf16 v[12:15], v[16:19], v[224:227], v[12:15]
    v_and_b32_dpp v20, v35, v4 row_newbcast:9 row_mask:0xf bank_mask:0xf
    v_and_b32_dpp v21, v35, v5 row_newbcast:9 row_mask:0xf bank_mask:0xf
    v_and_b32_dpp v22, v35, v6 row_newbcast:9 row_mask:0xf bank_mask:0xf
    v_and_b32_dpp v23, v35, v7 row_newbcast:9 row_mask:0xf bank_mask:0xf
    buffer_load_dwordx4 v[196:199], v2, s[12:15], s60 offen offset:2048 nt
    s_waitcnt vmcnt(5)
    v_mfma_f32_16x16x32_bf16 v[12:15], v[20:23], v[244:247], v[12:15]
    v_and_b32_dpp v16, v35, v4 row_newbcast:5 row_mask:0xf bank_mask:0xf
    v_and_b32_dpp v17, v35, v5 row_newbcast:5 row_mask:0xf bank_mask:0xf
    v_and_b32_dpp v18, v35, v6 row_newbcast:5 row_mask:0xf bank_mask:0xf
    v_and_b32_dpp v19, v35, v7 row_newbcast:5 row_mask:0xf bank_mask:0xf
    buffer_load_dwordx4 v[200:203], v2, s[12:15], s60 offen offset:3072 nt
    s_waitcnt vmcnt(5)
    v_mfma_f32_16x16x32_bf16 v[12:15], v[16:19], v[136:139], v[12:15]
    v_and_b32_dpp v20, v35, v4 row_newbcast:13 row_mask:0xf bank_mask:0xf
    v_and_b32_dpp v21, v35, v5 row_newbcast:13 row_mask:0xf bank_mask:0xf
    v_and_b32_dpp v22, v35, v6 row_newbcast:13 row_mask:0xf bank_mask:0xf
    v_and_b32_dpp v23, v35, v7 row_newbcast:13 row_mask:0xf bank_mask:0xf
    s_xor_b32 s60, s63, 786432
    buffer_load_dwordx4 v[208:211], v2, s[12:15], s60 offen offset:0 nt
    s_waitcnt vmcnt(5)
    v_mfma_f32_16x16x32_bf16 v[12:15], v[20:23], v[160:163], v[12:15]
    v_and_b32_dpp v16, v35, v4 row_newbcast:3 row_mask:0xf bank_mask:0xf
    v_and_b32_dpp v17, v35, v5 row_newbcast:3 row_mask:0xf bank_mask:0xf
    v_and_b32_dpp v18, v35, v6 row_newbcast:3 row_mask:0xf bank_mask:0xf
    v_and_b32_dpp v19, v35, v7 row_newbcast:3 row_mask:0xf bank_mask:0xf
    buffer_load_dwordx4 v[212:215], v2, s[12:15], s60 offen offset:1024 nt
    s_waitcnt vmcnt(5)
    v_mfma_f32_16x16x32_bf16 v[12:15], v[16:19], v[188:191], v[12:15]
    v_and_b32_dpp v20, v35, v4 row_newbcast:11 row_mask:0xf bank_mask:0xf
    v_and_b32_dpp v21, v35, v5 row_newbcast:11 row_mask:0xf bank_mask:0xf
    v_and_b32_dpp v22, v35, v6 row_newbcast:11 row_mask:0xf bank_mask:0xf
    v_and_b32_dpp v23, v35, v7 row_newbcast:11 row_mask:0xf bank_mask:0xf
    buffer_load_dwordx4 v[216:219], v2, s[12:15], s60 offen offset:2048 nt
    s_waitcnt vmcnt(5)
    v_mfma_f32_16x16x32_bf16 v[12:15], v[20:23], v[192:195], v[12:15]
    v_and_b32_dpp v16, v35, v4 row_newbcast:7 row_mask:0xf bank_mask:0xf
    v_and_b32_dpp v17, v35, v5 row_newbcast:7 row_mask:0xf bank_mask:0xf
    v_and_b32_dpp v18, v35, v6 row_newbcast:7 row_mask:0xf bank_mask:0xf
    v_and_b32_dpp v19, v35, v7 row_newbcast:7 row_mask:0xf bank_mask:0xf
    buffer_load_dwordx4 v[220:223], v2, s[12:15], s60 offen offset:3072 nt
    s_waitcnt vmcnt(5)
    v_mfma_f32_16x16x32_bf16 v[12:15], v[16:19], v[196:199], v[12:15]
    v_and_b32_dpp v20, v35, v4 row_newbcast:15 row_mask:0xf bank_mask:0xf
    v_and_b32_dpp v21, v35, v5 row_newbcast:15 row_mask:0xf bank_mask:0xf
    v_and_b32_dpp v22, v35, v6 row_newbcast:15 row_mask:0xf bank_mask:0xf
    v_and_b32_dpp v23, v35, v7 row_newbcast:15 row_mask:0xf bank_mask:0xf
    s_xor_b32 s60, s63, 802816
    buffer_load_dwordx4 v[228:231], v2, s[12:15], s60 offen offset:0 nt
    s_waitcnt vmcnt(5)
    v_mfma_f32_16x16x32_bf16 v[12:15], v[20:23], v[200:203], v[12:15]
    v_and_b32_dpp v16, v36, v4 row_newbcast:0 row_mask:0xf bank_mask:0xf
    v_and_b32_dpp v17, v36, v5 row_newbcast:0 row_mask:0xf bank_mask:0xf
    v_and_b32_dpp v18, v36, v6 row_newbcast:0 row_mask:0xf bank_mask:0xf
    v_and_b32_dpp v19, v36, v7 row_newbcast:0 row_mask:0xf bank_mask:0xf
    buffer_load_dwordx4 v[232:235], v2, s[12:15], s60 offen offset:1024 nt
    s_waitcnt vmcnt(5)
    v_mfma_f32_16x16x32_bf16 v[12:15], v[16:19], v[208:211], v[12:15]
    v_and_b32_dpp v20, v36, v4 row_newbcast:8 row_mask:0xf bank_mask:0xf
    v_and_b32_dpp v21, v36, v5 row_newbcast:8 row_mask:0xf bank_mask:0xf
    v_and_b32_dpp v22, v36, v6 row_newbcast:8 row_mask:0xf bank_mask:0xf
    v_and_b32_dpp v23, v36, v7 row_newbcast:8 row_mask:0xf bank_mask:0xf
    buffer_load_dwordx4 v[236:239], v2, s[12:15], s60 offen offset:2048 nt
    s_waitcnt vmcnt(5)
    v_mfma_f32_16x16x32_bf16 v[12:15], v[20:23], v[212:215], v[12:15]
    v_and_b32_dpp v16, v36, v4 row_newbcast:4 row_mask:0xf bank_mask:0xf
    v_and_b32_dpp v17, v36, v5 row_newbcast:4 row_mask:0xf bank_mask:0xf
    v_and_b32_dpp v18, v36, v6 row_newbcast:4 row_mask:0xf bank_mask:0xf
    v_and_b32_dpp v19, v36, v7 row_newbcast:4 row_mask:0xf bank_mask:0xf
    buffer_load_dwordx4 v[240:243], v2, s[12:15], s60 offen offset:3072 nt
    s_waitcnt vmcnt(5)
    v_mfma_f32_16x16x32_bf16 v[12:15], v[16:19], v[216:219], v[12:15]
    v_and_b32_dpp v20, v36, v4 row_newbcast:12 row_mask:0xf bank_mask:0xf
    v_and_b32_dpp v21, v36, v5 row_newbcast:12 row_mask:0xf bank_mask:0xf
    v_and_b32_dpp v22, v36, v6 row_newbcast:12 row_mask:0xf bank_mask:0xf
    v_and_b32_dpp v23, v36, v7 row_newbcast:12 row_mask:0xf bank_mask:0xf
    s_xor_b32 s60, s63, 819200
    buffer_load_dwordx4 v[248:251], v2, s[12:15], s60 offen offset:0 nt
    s_waitcnt vmcnt(5)
    v_mfma_f32_16x16x32_bf16 v[12:15], v[20:23], v[220:223], v[12:15]
    v_and_b32_dpp v16, v36, v4 row_newbcast:2 row_mask:0xf bank_mask:0xf
    v_and_b32_dpp v17, v36, v5 row_newbcast:2 row_mask:0xf bank_mask:0xf
    v_and_b32_dpp v18, v36, v6 row_newbcast:2 row_mask:0xf bank_mask:0xf
    v_and_b32_dpp v19, v36, v7 row_newbcast:2 row_mask:0xf bank_mask:0xf
    buffer_load_dwordx4 v[252:255], v2, s[12:15], s60 offen offset:1024 nt
    s_waitcnt vmcnt(5)
    v_mfma_f32_16x16x32_bf16 v[12:15], v[16:19], v[228:231], v[12:15]
    v_and_b32_dpp v20, v36, v4 row_newbcast:10 row_mask:0xf bank_mask:0xf
    v_and_b32_dpp v21, v36, v5 row_newbcast:10 row_mask:0xf bank_mask:0xf
    v_and_b32_dpp v22, v36, v6 row_newbcast:10 row_mask:0xf bank_mask:0xf
    v_and_b32_dpp v23, v36, v7 row_newbcast:10 row_mask:0xf bank_mask:0xf
    buffer_load_dwordx4 v[128:131], v2, s[12:15], s60 offen offset:2048 nt
    v_fma_f32 v37, v37, s91, -v50
    v_exp_f32 v37, v37
    s_nop 0
    v_mul_f32 v37, v37, v44
    v_cvt_pk_bf16_f32 v37, v37, v37
    s_waitcnt vmcnt(5)
    v_mfma_f32_16x16x32_bf16 v[12:15], v[20:23], v[232:235], v[12:15]
    v_and_b32_dpp v16, v36, v4 row_newbcast:6 row_mask:0xf bank_mask:0xf
    v_and_b32_dpp v17, v36, v5 row_newbcast:6 row_mask:0xf bank_mask:0xf
    v_and_b32_dpp v18, v36, v6 row_newbcast:6 row_mask:0xf bank_mask:0xf
    v_and_b32_dpp v19, v36, v7 row_newbcast:6 row_mask:0xf bank_mask:0xf
    buffer_load_dwordx4 v[132:135], v2, s[12:15], s60 offen offset:3072 nt
    s_waitcnt vmcnt(5)
    v_mfma_f32_16x16x32_bf16 v[12:15], v[16:19], v[236:239], v[12:15]
    v_and_b32_dpp v20, v36, v4 row_newbcast:14 row_mask:0xf bank_mask:0xf
    v_and_b32_dpp v21, v36, v5 row_newbcast:14 row_mask:0xf bank_mask:0xf
    v_and_b32_dpp v22, v36, v6 row_newbcast:14 row_mask:0xf bank_mask:0xf
    v_and_b32_dpp v23, v36, v7 row_newbcast:14 row_mask:0xf bank_mask:0xf
    s_xor_b32 s60, s63, 835584
    buffer_load_dwordx4 v[140:143], v2, s[12:15], s60 offen offset:0 nt
    s_waitcnt vmcnt(5)
    v_mfma_f32_16x16x32_bf16 v[12:15], v[20:23], v[240:243], v[12:15]
    v_and_b32_dpp v16, v36, v4 row_newbcast:1 row_mask:0xf bank_mask:0xf
    v_and_b32_dpp v17, v36, v5 row_newbcast:1 row_mask:0xf bank_mask:0xf
    v_and_b32_dpp v18, v36, v6 row_newbcast:1 row_mask:0xf bank_mask:0xf
    v_and_b32_dpp v19, v36, v7 row_newbcast:1 row_mask:0xf bank_mask:0xf
    buffer_load_dwordx4 v[148:151], v2, s[12:15], s60 offen offset:1024 nt
    s_waitcnt vmcnt(5)
    v_mfma_f32_16x16x32_bf16 v[12:15], v[16:19], v[248:251], v[12:15]
    v_and_b32_dpp v20, v36, v4 row_newbcast:9 row_mask:0xf bank_mask:0xf
    v_and_b32_dpp v21, v36, v5 row_newbcast:9 row_mask:0xf bank_mask:0xf
    v_and_b32_dpp v22, v36, v6 row_newbcast:9 row_mask:0xf bank_mask:0xf
    v_and_b32_dpp v23, v36, v7 row_newbcast:9 row_mask:0xf bank_mask:0xf
    buffer_load_dwordx4 v[152:155], v2, s[12:15], s60 offen offset:2048 nt
    s_waitcnt vmcnt(5)
    v_mfma_f32_16x16x32_bf16 v[12:15], v[20:23], v[252:255], v[12:15]
    v_and_b32_dpp v16, v36, v4 row_newbcast:5 row_mask:0xf bank_mask:0xf
    v_and_b32_dpp v17, v36, v5 row_newbcast:5 row_mask:0xf bank_mask:0xf
    v_and_b32_dpp v18, v36, v6 row_newbcast:5 row_mask:0xf bank_mask:0xf
    v_and_b32_dpp v19, v36, v7 row_newbcast:5 row_mask:0xf bank_mask:0xf
    buffer_load_dwordx4 v[156:159], v2, s[12:15], s60 offen offset:3072 nt
    s_waitcnt vmcnt(5)
    v_mfma_f32_16x16x32_bf16 v[12:15], v[16:19], v[128:131], v[12:15]
    v_and_b32_dpp v20, v36, v4 row_newbcast:13 row_mask:0xf bank_mask:0xf
    v_and_b32_dpp v21, v36, v5 row_newbcast:13 row_mask:0xf bank_mask:0xf
    v_and_b32_dpp v22, v36, v6 row_newbcast:13 row_mask:0xf bank_mask:0xf
    v_and_b32_dpp v23, v36, v7 row_newbcast:13 row_mask:0xf bank_mask:0xf
    s_xor_b32 s60, s63, 851968
    buffer_load_dwordx4 v[168:171], v2, s[12:15], s60 offen offset:0 nt
    s_waitcnt vmcnt(5)
    v_mfma_f32_16x16x32_bf16 v[12:15], v[20:23], v[132:135], v[12:15]
    v_and_b32_dpp v16, v36, v4 row_newbcast:3 row_mask:0xf bank_mask:0xf
    v_and_b32_dpp v17, v36, v5 row_newbcast:3 row_mask:0xf bank_mask:0xf
    v_and_b32_dpp v18, v36, v6 row_newbcast:3 row_mask:0xf bank_mask:0xf
    v_and_b32_dpp v19, v36, v7 row_newbcast:3 row_mask:0xf bank_mask:0xf
    buffer_load_dwordx4 v[172:175], v2, s[12:15], s60 offen offset:1024 nt
    s_waitcnt vmcnt(5)
    v_mfma_f32_16x16x32_bf16 v[12:15], v[16:19], v[140:143], v[12:15]
    v_and_b32_dpp v20, v36, v4 row_newbcast:11 row_mask:0xf bank_mask:0xf
    v_and_b32_dpp v21, v36, v5 row_newbcast:11 row_mask:0xf bank_mask:0xf
    v_and_b32_dpp v22, v36, v6 row_newbcast:11 row_mask:0xf bank_mask:0xf
    v_and_b32_dpp v23, v36, v7 row_newbcast:11 row_mask:0xf bank_mask:0xf
    buffer_load_dwordx4 v[176:179], v2, s[12:15], s60 offen offset:2048 nt
    s_waitcnt vmcnt(5)
    v_mfma_f32_16x16x32_bf16 v[12:15], v[20:23], v[148:151], v[12:15]
    v_and_b32_dpp v16, v36, v4 row_newbcast:7 row_mask:0xf bank_mask:0xf
    v_and_b32_dpp v17, v36, v5 row_newbcast:7 row_mask:0xf bank_mask:0xf
    v_and_b32_dpp v18, v36, v6 row_newbcast:7 row_mask:0xf bank_mask:0xf
    v_and_b32_dpp v19, v36, v7 row_newbcast:7 row_mask:0xf bank_mask:0xf
    buffer_load_dwordx4 v[180:183], v2, s[12:15], s60 offen offset:3072 nt
    s_waitcnt vmcnt(5)
    v_mfma_f32_16x16x32_bf16 v[12:15], v[16:19], v[152:155], v[12:15]
    v_and_b32_dpp v20, v36, v4 row_newbcast:15 row_mask:0xf bank_mask:0xf
    v_and_b32_dpp v21, v36, v5 row_newbcast:15 row_mask:0xf bank_mask:0xf
    v_and_b32_dpp v22, v36, v6 row_newbcast:15 row_mask:0xf bank_mask:0xf
    v_and_b32_dpp v23, v36, v7 row_newbcast:15 row_mask:0xf bank_mask:0xf
    s_xor_b32 s60, s63, 868352
    buffer_load_dwordx4 v[64:67], v2, s[12:15], s60 offen offset:0 nt
    s_waitcnt vmcnt(5)
    v_mfma_f32_16x16x32_bf16 v[12:15], v[20:23], v[156:159], v[12:15]
    v_and_b32_dpp v16, v37, v4 row_newbcast:0 row_mask:0xf bank_mask:0xf
    v_and_b32_dpp v17, v37, v5 row_newbcast:0 row_mask:0xf bank_mask:0xf
    v_and_b32_dpp v18, v37, v6 row_newbcast:0 row_mask:0xf bank_mask:0xf
    v_and_b32_dpp v19, v37, v7 row_newbcast:0 row_mask:0xf bank_mask:0xf
    buffer_load_dwordx4 v[68:71], v2, s[12:15], s60 offen offset:1024 nt
    s_waitcnt vmcnt(5)
    v_mfma_f32_16x16x32_bf16 v[12:15], v[16:19], v[168:171], v[12:15]
    v_and_b32_dpp v20, v37, v4 row_newbcast:8 row_mask:0xf bank_mask:0xf
    v_and_b32_dpp v21, v37, v5 row_newbcast:8 row_mask:0xf bank_mask:0xf
    v_and_b32_dpp v22, v37, v6 row_newbcast:8 row_mask:0xf bank_mask:0xf
    v_and_b32_dpp v23, v37, v7 row_newbcast:8 row_mask:0xf bank_mask:0xf
    buffer_load_dwordx4 v[72:75], v2, s[12:15], s60 offen offset:2048 nt
    s_waitcnt vmcnt(5)
    v_mfma_f32_16x16x32_bf16 v[12:15], v[20:23], v[172:175], v[12:15]
    v_and_b32_dpp v16, v37, v4 row_newbcast:4 row_mask:0xf bank_mask:0xf
    v_and_b32_dpp v17, v37, v5 row_newbcast:4 row_mask:0xf bank_mask:0xf
    v_and_b32_dpp v18, v37, v6 row_newbcast:4 row_mask:0xf bank_mask:0xf
    v_and_b32_dpp v19, v37, v7 row_newbcast:4 row_mask:0xf bank_mask:0xf
    buffer_load_dwordx4 v[76:79], v2, s[12:15], s60 offen offset:3072 nt
    s_waitcnt vmcnt(5)
    v_mfma_f32_16x16x32_bf16 v[12:15], v[16:19], v[176:179], v[12:15]
    v_and_b32_dpp v20, v37, v4 row_newbcast:12 row_mask:0xf bank_mask:0xf
    v_and_b32_dpp v21, v37, v5 row_newbcast:12 row_mask:0xf bank_mask:0xf
    v_and_b32_dpp v22, v37, v6 row_newbcast:12 row_mask:0xf bank_mask:0xf
    v_and_b32_dpp v23, v37, v7 row_newbcast:12 row_mask:0xf bank_mask:0xf
    s_xor_b32 s60, s63, 884736
    buffer_load_dwordx4 v[80:83], v2, s[12:15], s60 offen offset:0 nt
    s_waitcnt vmcnt(5)
    v_mfma_f32_16x16x32_bf16 v[12:15], v[20:23], v[180:183], v[12:15]
    v_and_b32_dpp v16, v37, v4 row_newbcast:2 row_mask:0xf bank_mask:0xf
    v_and_b32_dpp v17, v37, v5 row_newbcast:2 row_mask:0xf bank_mask:0xf
    v_and_b32_dpp v18, v37, v6 row_newbcast:2 row_mask:0xf bank_mask:0xf
    v_and_b32_dpp v19, v37, v7 row_newbcast:2 row_mask:0xf bank_mask:0xf
    buffer_load_dwordx4 v[84:87], v2, s[12:15], s60 offen offset:1024 nt
    s_waitcnt vmcnt(5)
    v_mfma_f32_16x16x32_bf16 v[12:15], v[16:19], v[64:67], v[12:15]
    v_and_b32_dpp v20, v37, v4 row_newbcast:10 row_mask:0xf bank_mask:0xf
    v_and_b32_dpp v21, v37, v5 row_newbcast:10 row_mask:0xf bank_mask:0xf
    v_and_b32_dpp v22, v37, v6 row_newbcast:10 row_mask:0xf bank_mask:0xf
    v_and_b32_dpp v23, v37, v7 row_newbcast:10 row_mask:0xf bank_mask:0xf
    buffer_load_dwordx4 v[88:91], v2, s[12:15], s60 offen offset:2048 nt
    v_fma_f32 v38, v38, s91, -v50
    v_exp_f32 v38, v38
    s_nop 0
    v_mul_f32 v38, v38, v44
    v_cvt_pk_bf16_f32 v38, v38, v38
    s_waitcnt vmcnt(5)
    v_mfma_f32_16x16x32_bf16 v[12:15], v[20:23], v[68:71], v[12:15]
    v_and_b32_dpp v16, v37, v4 row_newbcast:6 row_mask:0xf bank_mask:0xf
    v_and_b32_dpp v17, v37, v5 row_newbcast:6 row_mask:0xf bank_mask:0xf
    v_and_b32_dpp v18, v37, v6 row_newbcast:6 row_mask:0xf bank_mask:0xf
    v_and_b32_dpp v19, v37, v7 row_newbcast:6 row_mask:0xf bank_mask:0xf
    buffer_load_dwordx4 v[92:95], v2, s[12:15], s60 offen offset:3072 nt
    s_waitcnt vmcnt(5)
    v_mfma_f32_16x16x32_bf16 v[12:15], v[16:19], v[72:75], v[12:15]
    v_and_b32_dpp v20, v37, v4 row_newbcast:14 row_mask:0xf bank_mask:0xf
    v_and_b32_dpp v21, v37, v5 row_newbcast:14 row_mask:0xf bank_mask:0xf
    v_and_b32_dpp v22, v37, v6 row_newbcast:14 row_mask:0xf bank_mask:0xf
    v_and_b32_dpp v23, v37, v7 row_newbcast:14 row_mask:0xf bank_mask:0xf
    s_xor_b32 s60, s63, 901120
    buffer_load_dwordx4 v[96:99], v2, s[12:15], s60 offen offset:0 nt
    s_waitcnt vmcnt(5)
    v_mfma_f32_16x16x32_bf16 v[12:15], v[20:23], v[76:79], v[12:15]
    v_and_b32_dpp v16, v37, v4 row_newbcast:1 row_mask:0xf bank_mask:0xf
    v_and_b32_dpp v17, v37, v5 row_newbcast:1 row_mask:0xf bank_mask:0xf
    v_and_b32_dpp v18, v37, v6 row_newbcast:1 row_mask:0xf bank_mask:0xf
    v_and_b32_dpp v19, v37, v7 row_newbcast:1 row_mask:0xf bank_mask:0xf
    buffer_load_dwordx4 v[100:103], v2, s[12:15], s60 offen offset:1024 nt
    s_waitcnt vmcnt(5)
    v_mfma_f32_16x16x32_bf16 v[12:15], v[16:19], v[80:83], v[12:15]
    v_and_b32_dpp v20, v37, v4 row_newbcast:9 row_mask:0xf bank_mask:0xf
    v_and_b32_dpp v21, v37, v5 row_newbcast:9 row_mask:0xf bank_mask:0xf
    v_and_b32_dpp v22, v37, v6 row_newbcast:9 row_mask:0xf bank_mask:0xf
    v_and_b32_dpp v23, v37, v7 row_newbcast:9 row_mask:0xf bank_mask:0xf
    buffer_load_dwordx4 v[104:107], v2, s[12:15], s60 offen offset:2048 nt
    s_waitcnt vmcnt(5)
    v_mfma_f32_16x16x32_bf16 v[12:15], v[20:23], v[84:87], v[12:15]
    v_and_b32_dpp v16, v37, v4 row_newbcast:5 row_mask:0xf bank_mask:0xf
    v_and_b32_dpp v17, v37, v5 row_newbcast:5 row_mask:0xf bank_mask:0xf
    v_and_b32_dpp v18, v37, v6 row_newbcast:5 row_mask:0xf bank_mask:0xf
    v_and_b32_dpp v19, v37, v7 row_newbcast:5 row_mask:0xf bank_mask:0xf
    buffer_load_dwordx4 v[108:111], v2, s[12:15], s60 offen offset:3072 nt
    s_waitcnt vmcnt(5)
    v_mfma_f32_16x16x32_bf16 v[12:15], v[16:19], v[88:91], v[12:15]
    v_and_b32_dpp v20, v37, v4 row_newbcast:13 row_mask:0xf bank_mask:0xf
    v_and_b32_dpp v21, v37, v5 row_newbcast:13 row_mask:0xf bank_mask:0xf
    v_and_b32_dpp v22, v37, v6 row_newbcast:13 row_mask:0xf bank_mask:0xf
    v_and_b32_dpp v23, v37, v7 row_newbcast:13 row_mask:0xf bank_mask:0xf
    s_xor_b32 s60, s63, 917504
    buffer_load_dwordx4 v[112:115], v2, s[12:15], s60 offen offset:0 nt
    s_waitcnt vmcnt(5)
    v_mfma_f32_16x16x32_bf16 v[12:15], v[20:23], v[92:95], v[12:15]
    v_and_b32_dpp v16, v37, v4 row_newbcast:3 row_mask:0xf bank_mask:0xf
    v_and_b32_dpp v17, v37, v5 row_newbcast:3 row_mask:0xf bank_mask:0xf
    v_and_b32_dpp v18, v37, v6 row_newbcast:3 row_mask:0xf bank_mask:0xf
    v_and_b32_dpp v19, v37, v7 row_newbcast:3 row_mask:0xf bank_mask:0xf
    buffer_load_dwordx4 v[116:119], v2, s[12:15], s60 offen offset:1024 nt
    s_waitcnt vmcnt(5)
    v_mfma_f32_16x16x32_bf16 v[12:15], v[16:19], v[96:99], v[12:15]
    v_and_b32_dpp v20, v37, v4 row_newbcast:11 row_mask:0xf bank_mask:0xf
    v_and_b32_dpp v21, v37, v5 row_newbcast:11 row_mask:0xf bank_mask:0xf
    v_and_b32_dpp v22, v37, v6 row_newbcast:11 row_mask:0xf bank_mask:0xf
    v_and_b32_dpp v23, v37, v7 row_newbcast:11 row_mask:0xf bank_mask:0xf
    buffer_load_dwordx4 v[120:123], v2, s[12:15], s60 offen offset:2048 nt
    s_waitcnt vmcnt(5)
    v_mfma_f32_16x16x32_bf16 v[12:15], v[20:23], v[100:103], v[12:15]
    v_and_b32_dpp v16, v37, v4 row_newbcast:7 row_mask:0xf bank_mask:0xf
    v_and_b32_dpp v17, v37, v5 row_newbcast:7 row_mask:0xf bank_mask:0xf
    v_and_b32_dpp v18, v37, v6 row_newbcast:7 row_mask:0xf bank_mask:0xf
    v_and_b32_dpp v19, v37, v7 row_newbcast:7 row_mask:0xf bank_mask:0xf
    buffer_load_dwordx4 v[124:127], v2, s[12:15], s60 offen offset:3072 nt
    s_waitcnt vmcnt(5)
    v_mfma_f32_16x16x32_bf16 v[12:15], v[16:19], v[104:107], v[12:15]
    v_and_b32_dpp v20, v37, v4 row_newbcast:15 row_mask:0xf bank_mask:0xf
    v_and_b32_dpp v21, v37, v5 row_newbcast:15 row_mask:0xf bank_mask:0xf
    v_and_b32_dpp v22, v37, v6 row_newbcast:15 row_mask:0xf bank_mask:0xf
    v_and_b32_dpp v23, v37, v7 row_newbcast:15 row_mask:0xf bank_mask:0xf
    s_xor_b32 s60, s63, 933888
    buffer_load_dwordx4 v[144:147], v2, s[12:15], s60 offen offset:0 nt
    s_waitcnt vmcnt(5)
    v_mfma_f32_16x16x32_bf16 v[12:15], v[20:23], v[108:111], v[12:15]
    v_and_b32_dpp v16, v38, v4 row_newbcast:0 row_mask:0xf bank_mask:0xf
    v_and_b32_dpp v17, v38, v5 row_newbcast:0 row_mask:0xf bank_mask:0xf
    v_and_b32_dpp v18, v38, v6 row_newbcast:0 row_mask:0xf bank_mask:0xf
    v_and_b32_dpp v19, v38, v7 row_newbcast:0 row_mask:0xf bank_mask:0xf
    buffer_load_dwordx4 v[164:167], v2, s[12:15], s60 offen offset:1024 nt
    s_waitcnt vmcnt(5)
    v_mfma_f32_16x16x32_bf16 v[12:15], v[16:19], v[112:115], v[12:15]
    v_and_b32_dpp v20, v38, v4 row_newbcast:8 row_mask:0xf bank_mask:0xf
    v_and_b32_dpp v21, v38, v5 row_newbcast:8 row_mask:0xf bank_mask:0xf
    v_and_b32_dpp v22, v38, v6 row_newbcast:8 row_mask:0xf bank_mask:0xf
    v_and_b32_dpp v23, v38, v7 row_newbcast:8 row_mask:0xf bank_mask:0xf
    buffer_load_dwordx4 v[184:187], v2, s[12:15], s60 offen offset:2048 nt
    buffer_load_dwordx4 v[204:207], v2, s[12:15], s60 offen offset:3072 nt
    s_waitcnt vmcnt(6)
    v_mfma_f32_16x16x32_bf16 v[12:15], v[20:23], v[116:119], v[12:15]
    v_and_b32_dpp v16, v38, v4 row_newbcast:4 row_mask:0xf bank_mask:0xf
    v_and_b32_dpp v17, v38, v5 row_newbcast:4 row_mask:0xf bank_mask:0xf
    v_and_b32_dpp v18, v38, v6 row_newbcast:4 row_mask:0xf bank_mask:0xf
    v_and_b32_dpp v19, v38, v7 row_newbcast:4 row_mask:0xf bank_mask:0xf
    s_xor_b32 s60, s63, 950272
    buffer_load_dwordx4 v[224:227], v2, s[12:15], s60 offen offset:0 nt
    buffer_load_dwordx4 v[244:247], v2, s[12:15], s60 offen offset:1024 nt
    s_waitcnt vmcnt(7)
    v_mfma_f32_16x16x32_bf16 v[12:15], v[16:19], v[120:123], v[12:15]
    v_and_b32_dpp v20, v38, v4 row_newbcast:12 row_mask:0xf bank_mask:0xf
    v_and_b32_dpp v21, v38, v5 row_newbcast:12 row_mask:0xf bank_mask:0xf
    v_and_b32_dpp v22, v38, v6 row_newbcast:12 row_mask:0xf bank_mask:0xf
    v_and_b32_dpp v23, v38, v7 row_newbcast:12 row_mask:0xf bank_mask:0xf
    buffer_load_dwordx4 v[136:139], v2, s[12:15], s60 offen offset:2048 nt
    s_waitcnt vmcnt(7)
    v_mfma_f32_16x16x32_bf16 v[12:15], v[20:23], v[124:127], v[12:15]
    v_and_b32_dpp v16, v38, v4 row_newbcast:2 row_mask:0xf bank_mask:0xf
    v_and_b32_dpp v17, v38, v5 row_newbcast:2 row_mask:0xf bank_mask:0xf
    v_and_b32_dpp v18, v38, v6 row_newbcast:2 row_mask:0xf bank_mask:0xf
    v_and_b32_dpp v19, v38, v7 row_newbcast:2 row_mask:0xf bank_mask:0xf
    buffer_load_dwordx4 v[160:163], v2, s[12:15], s60 offen offset:3072 nt
    s_waitcnt vmcnt(7)
    v_mfma_f32_16x16x32_bf16 v[12:15], v[16:19], v[144:147], v[12:15]
    v_and_b32_dpp v20, v38, v4 row_newbcast:10 row_mask:0xf bank_mask:0xf
    v_and_b32_dpp v21, v38, v5 row_newbcast:10 row_mask:0xf bank_mask:0xf
    v_and_b32_dpp v22, v38, v6 row_newbcast:10 row_mask:0xf bank_mask:0xf
    v_and_b32_dpp v23, v38, v7 row_newbcast:10 row_mask:0xf bank_mask:0xf
    s_xor_b32 s60, s63, 966656
    buffer_load_dwordx4 v[188:191], v2, s[12:15], s60 offen offset:0 nt
    v_fma_f32 v39, v39, s91, -v50
    v_exp_f32 v39, v39
    s_nop 0
    v_mul_f32 v39, v39, v44
    v_cvt_pk_bf16_f32 v39, v39, v39
    s_waitcnt vmcnt(7)
    v_mfma_f32_16x16x32_bf16 v[12:15], v[20:23], v[164:167], v[12:15]
    v_and_b32_dpp v16, v38, v4 row_newbcast:6 row_mask:0xf bank_mask:0xf
    v_and_b32_dpp v17, v38, v5 row_newbcast:6 row_mask:0xf bank_mask:0xf
    v_and_b32_dpp v18, v38, v6 row_newbcast:6 row_mask:0xf bank_mask:0xf
    v_and_b32_dpp v19, v38, v7 row_newbcast:6 row_mask:0xf bank_mask:0xf
    buffer_load_dwordx4 v[192:195], v2, s[12:15], s60 offen offset:1024 nt
    s_waitcnt vmcnt(7)
    v_mfma_f32_16x16x32_bf16 v[12:15], v[16:19], v[184:187], v[12:15]
    v_and_b32_dpp v20, v38, v4 row_newbcast:14 row_mask:0xf bank_mask:0xf
    v_and_b32_dpp v21, v38, v5 row_newbcast:14 row_mask:0xf bank_mask:0xf
    v_and_b32_dpp v22, v38, v6 row_newbcast:14 row_mask:0xf bank_mask:0xf
    v_and_b32_dpp v23, v38, v7 row_newbcast:14 row_mask:0xf bank_mask:0xf
    buffer_load_dwordx4 v[196:199], v2, s[12:15], s60 offen offset:2048 nt
    s_waitcnt vmcnt(7)
    v_mfma_f32_16x16x32_bf16 v[12:15], v[20:23], v[204:207], v[12:15]
    v_and_b32_dpp v16, v38, v4 row_newbcast:1 row_mask:0xf bank_mask:0xf
    v_and_b32_dpp v17, v38, v5 row_newbcast:1 row_mask:0xf bank_mask:0xf
    v_and_b32_dpp v18, v38, v6 row_newbcast:1 row_mask:0xf bank_mask:0xf
    v_and_b32_dpp v19, v38, v7 row_newbcast:1 row_mask:0xf bank_mask:0xf
    buffer_load_dwordx4 v[200:203], v2, s[12:15], s60 offen offset:3072 nt
    s_waitcnt vmcnt(7)
    v_mfma_f32_16x16x32_bf16 v[12:15], v[16:19], v[224:227], v[12:15]
    v_and_b32_dpp v20, v38, v4 row_newbcast:9 row_mask:0xf bank_mask:0xf
    v_and_b32_dpp v21, v38, v5 row_newbcast:9 row_mask:0xf bank_mask:0xf
    v_and_b32_dpp v22, v38, v6 row_newbcast:9 row_mask:0xf bank_mask:0xf
    v_and_b32_dpp v23, v38, v7 row_newbcast:9 row_mask:0xf bank_mask:0xf
    s_xor_b32 s60, s63, 983040
    buffer_load_dwordx4 v[208:211], v2, s[12:15], s60 offen offset:0 nt
    s_waitcnt vmcnt(7)
    v_mfma_f32_16x16x32_bf16 v[12:15], v[20:23], v[244:247], v[12:15]
    v_and_b32_dpp v16, v38, v4 row_newbcast:5 row_mask:0xf bank_mask:0xf
    v_and_b32_dpp v17, v38, v5 row_newbcast:5 row_mask:0xf bank_mask:0xf
    v_and_b32_dpp v18, v38, v6 row_newbcast:5 row_mask:0xf bank_mask:0xf
    v_and_b32_dpp v19, v38, v7 row_newbcast:5 row_mask:0xf bank_mask:0xf
    buffer_load_dwordx4 v[212:215], v2, s[12:15], s60 offen offset:1024 nt
    s_waitcnt vmcnt(7)
    v_mfma_f32_16x16x32_bf16 v[12:15], v[16:19], v[136:139], v[12:15]
    v_and_b32_dpp v20, v38, v4 row_newbcast:13 row_mask:0xf bank_mask:0xf
    v_and_b32_dpp v21, v38, v5 row_newbcast:13 row_mask:0xf bank_mask:0xf
    v_and_b32_dpp v22, v38, v6 row_newbcast:13 row_mask:0xf bank_mask:0xf
    v_and_b32_dpp v23, v38, v7 row_newbcast:13 row_mask:0xf bank_mask:0xf
    buffer_load_dwordx4 v[216:219], v2, s[12:15], s60 offen offset:2048 nt
    s_waitcnt vmcnt(7)
    v_mfma_f32_16x16x32_bf16 v[12:15], v[20:23], v[160:163], v[12:15]
    v_and_b32_dpp v16, v38, v4 row_newbcast:3 row_mask:0xf bank_mask:0xf
    v_and_b32_dpp v17, v38, v5 row_newbcast:3 row_mask:0xf bank_mask:0xf
    v_and_b32_dpp v18, v38, v6 row_newbcast:3 row_mask:0xf bank_mask:0xf
    v_and_b32_dpp v19, v38, v7 row_newbcast:3 row_mask:0xf bank_mask:0xf
    buffer_load_dwordx4 v[220:223], v2, s[12:15], s60 offen offset:3072 nt
    s_waitcnt vmcnt(7)
    v_mfma_f32_16x16x32_bf16 v[12:15], v[16:19], v[188:191], v[12:15]
    v_and_b32_dpp v20, v38, v4 row_newbcast:11 row_mask:0xf bank_mask:0xf
    v_and_b32_dpp v21, v38, v5 row_newbcast:11 row_mask:0xf bank_mask:0xf
    v_and_b32_dpp v22, v38, v6 row_newbcast:11 row_mask:0xf bank_mask:0xf
    v_and_b32_dpp v23, v38, v7 row_newbcast:11 row_mask:0xf bank_mask:0xf
    s_xor_b32 s60, s63, 999424
    buffer_load_dwordx4 v[228:231], v2, s[12:15], s60 offen offset:0 nt
    s_waitcnt vmcnt(7)
    v_mfma_f32_16x16x32_bf16 v[12:15], v[20:23], v[192:195], v[12:15]
    v_and_b32_dpp v16, v38, v4 row_newbcast:7 row_mask:0xf bank_mask:0xf
    v_and_b32_dpp v17, v38, v5 row_newbcast:7 row_mask:0xf bank_mask:0xf
    v_and_b32_dpp v18, v38, v6 row_newbcast:7 row_mask:0xf bank_mask:0xf
    v_and_b32_dpp v19, v38, v7 row_newbcast:7 row_mask:0xf bank_mask:0xf
    buffer_load_dwordx4 v[232:235], v2, s[12:15], s60 offen offset:1024 nt
    s_waitcnt vmcnt(7)
    v_mfma_f32_16x16x32_bf16 v[12:15], v[16:19], v[196:199], v[12:15]
    v_and_b32_dpp v20, v38, v4 row_newbcast:15 row_mask:0xf bank_mask:0xf
    v_and_b32_dpp v21, v38, v5 row_newbcast:15 row_mask:0xf bank_mask:0xf
    v_and_b32_dpp v22, v38, v6 row_newbcast:15 row_mask:0xf bank_mask:0xf
    v_and_b32_dpp v23, v38, v7 row_newbcast:15 row_mask:0xf bank_mask:0xf
    buffer_load_dwordx4 v[236:239], v2, s[12:15], s60 offen offset:2048 nt
    s_waitcnt vmcnt(7)
    v_mfma_f32_16x16x32_bf16 v[12:15], v[20:23], v[200:203], v[12:15]
    v_and_b32_dpp v16, v39, v4 row_newbcast:0 row_mask:0xf bank_mask:0xf
    v_and_b32_dpp v17, v39, v5 row_newbcast:0 row_mask:0xf bank_mask:0xf
    v_and_b32_dpp v18, v39, v6 row_newbcast:0 row_mask:0xf bank_mask:0xf
    v_and_b32_dpp v19, v39, v7 row_newbcast:0 row_mask:0xf bank_mask:0xf
    buffer_load_dwordx4 v[240:243], v2, s[12:15], s60 offen offset:3072 nt
    s_waitcnt vmcnt(7)
    v_mfma_f32_16x16x32_bf16 v[12:15], v[16:19], v[208:211], v[12:15]
    v_and_b32_dpp v20, v39, v4 row_newbcast:8 row_mask:0xf bank_mask:0xf
    v_and_b32_dpp v21, v39, v5 row_newbcast:8 row_mask:0xf bank_mask:0xf
    v_and_b32_dpp v22, v39, v6 row_newbcast:8 row_mask:0xf bank_mask:0xf
    v_and_b32_dpp v23, v39, v7 row_newbcast:8 row_mask:0xf bank_mask:0xf
    s_xor_b32 s60, s63, 1015808
    buffer_load_dwordx4 v[248:251], v2, s[12:15], s60 offen offset:0 nt
    s_waitcnt vmcnt(7)
    v_mfma_f32_16x16x32_bf16 v[12:15], v[20:23], v[212:215], v[12:15]
    v_and_b32_dpp v16, v39, v4 row_newbcast:4 row_mask:0xf bank_mask:0xf
    v_and_b32_dpp v17, v39, v5 row_newbcast:4 row_mask:0xf bank_mask:0xf
    v_and_b32_dpp v18, v39, v6 row_newbcast:4 row_mask:0xf bank_mask:0xf
    v_and_b32_dpp v19, v39, v7 row_newbcast:4 row_mask:0xf bank_mask:0xf
    buffer_load_dwordx4 v[252:255], v2, s[12:15], s60 offen offset:1024 nt
    s_waitcnt vmcnt(7)
    v_mfma_f32_16x16x32_bf16 v[12:15], v[16:19], v[216:219], v[12:15]
    v_and_b32_dpp v20, v39, v4 row_newbcast:12 row_mask:0xf bank_mask:0xf
    v_and_b32_dpp v21, v39, v5 row_newbcast:12 row_mask:0xf bank_mask:0xf
    v_and_b32_dpp v22, v39, v6 row_newbcast:12 row_mask:0xf bank_mask:0xf
    v_and_b32_dpp v23, v39, v7 row_newbcast:12 row_mask:0xf bank_mask:0xf
    buffer_load_dwordx4 v[128:131], v2, s[12:15], s60 offen offset:2048 nt
    s_waitcnt vmcnt(7)
    v_mfma_f32_16x16x32_bf16 v[12:15], v[20:23], v[220:223], v[12:15]
    v_and_b32_dpp v16, v39, v4 row_newbcast:2 row_mask:0xf bank_mask:0xf
    v_and_b32_dpp v17, v39, v5 row_newbcast:2 row_mask:0xf bank_mask:0xf
    v_and_b32_dpp v18, v39, v6 row_newbcast:2 row_mask:0xf bank_mask:0xf
    v_and_b32_dpp v19, v39, v7 row_newbcast:2 row_mask:0xf bank_mask:0xf
    buffer_load_dwordx4 v[132:135], v2, s[12:15], s60 offen offset:3072 nt
    s_waitcnt vmcnt(7)
    v_mfma_f32_16x16x32_bf16 v[12:15], v[16:19], v[228:231], v[12:15]
    v_and_b32_dpp v20, v39, v4 row_newbcast:10 row_mask:0xf bank_mask:0xf
    v_and_b32_dpp v21, v39, v5 row_newbcast:10 row_mask:0xf bank_mask:0xf
    v_and_b32_dpp v22, v39, v6 row_newbcast:10 row_mask:0xf bank_mask:0xf
    v_and_b32_dpp v23, v39, v7 row_newbcast:10 row_mask:0xf bank_mask:0xf
    s_xor_b32 s60, s63, 1032192
    buffer_load_dwordx4 v[140:143], v2, s[12:15], s60 offen offset:0 nt
    s_waitcnt vmcnt(7)
    v_mfma_f32_16x16x32_bf16 v[12:15], v[20:23], v[232:235], v[12:15]
    v_and_b32_dpp v16, v39, v4 row_newbcast:6 row_mask:0xf bank_mask:0xf
    v_and_b32_dpp v17, v39, v5 row_newbcast:6 row_mask:0xf bank_mask:0xf
    v_and_b32_dpp v18, v39, v6 row_newbcast:6 row_mask:0xf bank_mask:0xf
    v_and_b32_dpp v19, v39, v7 row_newbcast:6 row_mask:0xf bank_mask:0xf
    buffer_load_dwordx4 v[148:151], v2, s[12:15], s60 offen offset:1024 nt
    s_waitcnt vmcnt(7)
    v_mfma_f32_16x16x32_bf16 v[12:15], v[16:19], v[236:239], v[12:15]
    v_and_b32_dpp v20, v39, v4 row_newbcast:14 row_mask:0xf bank_mask:0xf
    v_and_b32_dpp v21, v39, v5 row_newbcast:14 row_mask:0xf bank_mask:0xf
    v_and_b32_dpp v22, v39, v6 row_newbcast:14 row_mask:0xf bank_mask:0xf
    v_and_b32_dpp v23, v39, v7 row_newbcast:14 row_mask:0xf bank_mask:0xf
    buffer_load_dwordx4 v[152:155], v2, s[12:15], s60 offen offset:2048 nt
    s_waitcnt vmcnt(7)
    v_mfma_f32_16x16x32_bf16 v[12:15], v[20:23], v[240:243], v[12:15]
    v_and_b32_dpp v16, v39, v4 row_newbcast:1 row_mask:0xf bank_mask:0xf
    v_and_b32_dpp v17, v39, v5 row_newbcast:1 row_mask:0xf bank_mask:0xf
    v_and_b32_dpp v18, v39, v6 row_newbcast:1 row_mask:0xf bank_mask:0xf
    v_and_b32_dpp v19, v39, v7 row_newbcast:1 row_mask:0xf bank_mask:0xf
    buffer_load_dwordx4 v[156:159], v2, s[12:15], s60 offen offset:3072 nt
    s_waitcnt vmcnt(7)
    v_mfma_f32_16x16x32_bf16 v[12:15], v[16:19], v[248:251], v[12:15]
    v_and_b32_dpp v20, v39, v4 row_newbcast:9 row_mask:0xf bank_mask:0xf
    v_and_b32_dpp v21, v39, v5 row_newbcast:9 row_mask:0xf bank_mask:0xf
    v_and_b32_dpp v22, v39, v6 row_newbcast:9 row_mask:0xf bank_mask:0xf
    v_and_b32_dpp v23, v39, v7 row_newbcast:9 row_mask:0xf bank_mask:0xf
    s_waitcnt vmcnt(6)
    s_nop 0
    v_mfma_f32_16x16x32_bf16 v[12:15], v[20:23], v[252:255], v[12:15]
    v_and_b32_dpp v16, v39, v4 row_newbcast:5 row_mask:0xf bank_mask:0xf
    v_and_b32_dpp v17, v39, v5 row_newbcast:5 row_mask:0xf bank_mask:0xf
    v_and_b32_dpp v18, v39, v6 row_newbcast:5 row_mask:0xf bank_mask:0xf
    v_and_b32_dpp v19, v39, v7 row_newbcast:5 row_mask:0xf bank_mask:0xf
    s_waitcnt vmcnt(5)
    s_nop 0
    v_mfma_f32_16x16x32_bf16 v[12:15], v[16:19], v[128:131], v[12:15]
    v_and_b32_dpp v20, v39, v4 row_newbcast:13 row_mask:0xf bank_mask:0xf
    v_and_b32_dpp v21, v39, v5 row_newbcast:13 row_mask:0xf bank_mask:0xf
    v_and_b32_dpp v22, v39, v6 row_newbcast:13 row_mask:0xf bank_mask:0xf
    v_and_b32_dpp v23, v39, v7 row_newbcast:13 row_mask:0xf bank_mask:0xf
    s_waitcnt vmcnt(4)
    s_nop 0
    v_mfma_f32_16x16x32_bf16 v[12:15], v[20:23], v[132:135], v[12:15]
    v_and_b32_dpp v16, v39, v4 row_newbcast:3 row_mask:0xf bank_mask:0xf
    v_and_b32_dpp v17, v39, v5 row_newbcast:3 row_mask:0xf bank_mask:0xf
    v_and_b32_dpp v18, v39, v6 row_newbcast:3 row_mask:0xf bank_mask:0xf
    v_and_b32_dpp v19, v39, v7 row_newbcast:3 row_mask:0xf bank_mask:0xf
    s_waitcnt vmcnt(3)
    s_nop 0
    v_mfma_f32_16x16x32_bf16 v[12:15], v[16:19], v[140:143], v[12:15]
    v_and_b32_dpp v20, v39, v4 row_newbcast:11 row_mask:0xf bank_mask:0xf
    v_and_b32_dpp v21, v39, v5 row_newbcast:11 row_mask:0xf bank_mask:0xf
    v_and_b32_dpp v22, v39, v6 row_newbcast:11 row_mask:0xf bank_mask:0xf
    v_and_b32_dpp v23, v39, v7 row_newbcast:11 row_mask:0xf bank_mask:0xf
    s_waitcnt vmcnt(2)
    s_nop 0
    v_mfma_f32_16x16x32_bf16 v[12:15], v[20:23], v[148:151], v[12:15]
    v_and_b32_dpp v16, v39, v4 row_newbcast:7 row_mask:0xf bank_mask:0xf
    v_and_b32_dpp v17, v39, v5 row_newbcast:7 row_mask:0xf bank_mask:0xf
    v_and_b32_dpp v18, v39, v6 row_newbcast:7 row_mask:0xf bank_mask:0xf
    v_and_b32_dpp v19, v39, v7 row_newbcast:7 row_mask:0xf bank_mask:0xf
    s_waitcnt vmcnt(1)
    s_nop 0
    v_mfma_f32_16x16x32_bf16 v[12:15], v[16:19], v[152:155], v[12:15]
    v_and_b32_dpp v20, v39, v4 row_newbcast:15 row_mask:0xf bank_mask:0xf
    v_and_b32_dpp v21, v39, v5 row_newbcast:15 row_mask:0xf bank_mask:0xf
    v_and_b32_dpp v22, v39, v6 row_newbcast:15 row_mask:0xf bank_mask:0xf
    v_and_b32_dpp v23, v39, v7 row_newbcast:15 row_mask:0xf bank_mask:0xf
    s_waitcnt vmcnt(0)
    s_nop 0
    v_mfma_f32_16x16x32_bf16 v[12:15], v[20:23], v[156:159], v[12:15]
    s_mov_b32 exec_hi, 0
    s_nop 6
    ds_write_b128 v52, v[12:15] offset:0
    s_mov_b32 exec_hi, -1
    s_waitcnt lgkmcnt(0)
    s_barrier
    s_cmp_eq_u32 s3, 2
    s_cselect_b32 s55, 0, -1
    s_cmp_eq_u32 s3, 3
    s_barrier
    s_cbranch_scc1 L_send
    s_mov_b32 exec_hi, s55
    ds_read_b128 v[64:67], v54 offset:3584
    ds_read_b128 v[68:71], v54 offset:6144
    ds_read_b128 v[72:75], v54 offset:8704
    ds_read_b128 v[76:79], v54 offset:11264
    s_waitcnt lgkmcnt(2)
    v_add_f32 v64, v64, v68
    v_add_f32 v65, v65, v69
    v_add_f32 v66, v66, v70
    v_add_f32 v67, v67, v71
    s_waitcnt lgkmcnt(0)
    v_add_f32 v72, v72, v76
    v_add_f32 v73, v73, v77
    v_add_f32 v74, v74, v78
    v_add_f32 v75, v75, v79
    v_add_f32 v64, v64, v72
    v_add_f32 v65, v65, v73
    v_add_f32 v66, v66, v74
    v_add_f32 v67, v67, v75
    v_min_u32 v64, -2, v64
    v_min_u32 v65, -2, v65
    v_min_u32 v66, -2, v66
    v_min_u32 v67, -2, v67
    buffer_store_dwordx4 v[64:67], v55, s[48:51], s94 offen sc1
    s_nop 1
L_send:
    s_endpgm
.section .rodata,"a"
.p2align 6
.amdhsa_kernel recurrent_scan__gqa_block_cached__mixer_token_mlp__decode_kernel
  .amdhsa_next_free_vgpr 256
  .amdhsa_next_free_sgpr 98
  .amdhsa_accum_offset 256
  .amdhsa_group_segment_fixed_size 0
  .amdhsa_kernarg_size 104
  .amdhsa_user_sgpr_count 2
  .amdhsa_user_sgpr_kernarg_segment_ptr 1
  .amdhsa_system_sgpr_workgroup_id_x 1
  .amdhsa_float_denorm_mode_32 3
.end_amdhsa_kernel
```
